```python
import torch

def _softmax(x, axis=-1):
    return torch.softmax(x, dim=axis)
def _gelu(x):
    return torch.nn.functional.gelu(x, approximate="tanh")
def _silu(x):
    return torch.nn.functional.silu(x)
def _sigmoid(x):
    return torch.sigmoid(x)
def _layernorm(x, axis=-1, eps=1e-5):
    m = x.mean(dim=axis, keepdim=True)
    v = x.var(dim=axis, keepdim=True, unbiased=False)
    return (x - m) / torch.sqrt(v + eps)
def _scatter_add(tgt, idx, src, axis=0):
    return tgt.clone().index_add_(axis, idx, src)
def _segment_sum(src, seg, n):
    out = torch.zeros((n,) + src.shape[1:], dtype=src.dtype)
    return out.index_add_(0, seg, src)
def _pad(x, pw):
    flat = tuple(v for pair in reversed(pw) for v in pair)
    return torch.nn.functional.pad(x, flat)

kernel_name = 'interleave_layers__sliding_block__glu_gated_geglu__prompt'

def setup_inputs():

    _w = (lambda a: (lambda t: t.to(torch.bfloat16) if t.is_floating_point() else t)(torch.as_tensor(a)))
    def _A_setup():
        B, S, D = 1, 2048, 576
        return {
            "x": _w((lambda *s: torch.randn(*s, dtype=torch.bfloat16) * 0.05)(B, S, D)),
            "wqkv": _w((lambda *s: torch.randn(*s, dtype=torch.bfloat16) * 0.05)(D, 3 * D)),
            "wo": _w((lambda *s: torch.randn(*s, dtype=torch.bfloat16) * 0.05)(D, D)),
        }
    _A_in = _A_setup()

    def _B_setup():
        B, S, Dm, Df = 1, 2048, 576, 4608
        return {
            "x": _w((lambda *s: torch.randn(*s, dtype=torch.bfloat16) * 0.05)(B, S, Dm)),
            "w_gate": _w((lambda *s: torch.randn(*s, dtype=torch.bfloat16) * 0.8)(Dm, Df) * (Dm ** -0.5)),
            "w_up": _w((lambda *s: torch.randn(*s, dtype=torch.bfloat16) * 0.8)(Dm, Df) * (Dm ** -0.5)),
            "w_down": _w((lambda *s: torch.randn(*s, dtype=torch.bfloat16) * 0.8)(Df, Dm) * (Df ** -0.5)),
        }
    _B_in = _B_setup()

    return {
        "A_x": _A_in["x"],
        "A_wqkv": _A_in["wqkv"],
        "A_wo": _A_in["wo"],
        "B_x": _B_in["x"],
        "B_w_gate": _B_in["w_gate"],
        "B_w_up": _B_in["w_up"],
        "B_w_down": _B_in["w_down"],
    }

def reference(A_x, A_wqkv, A_wo, B_x, B_w_gate, B_w_up, B_w_down):
    def _A_ref(x, wqkv, wo):
        B, S, D = x.shape
        H = 32; Dh = D // H; W = 256
        qkv = (lambda x, *d: x.permute(*d))((x @ wqkv).reshape(B, S, 3, H, Dh), 2, 0, 3, 1, 4)
        q, k, v = qkv[0], qkv[1], qkv[2]
        scores = torch.einsum("bhqd,bhkd->bhqk", q, k) * (Dh ** -0.5)
        idx = torch.arange(S)
        mask = (idx[:, None] - idx[None, :] >= 0) & (idx[:, None] - idx[None, :] < W)
        scores = torch.where(mask[None, None], scores, -1e9)
        p = _softmax(scores, axis=-1)
        o = torch.einsum("bhqk,bhkd->bhqd", p, v)
        return (lambda x, *d: x.permute(*d))(o, 0, 2, 1, 3).reshape(B, S, D) @ wo

    def _B_ref(x, w_gate, w_up, w_down):
        g = torch.einsum("bsd,df->bsf", x, w_gate)
        u = torch.einsum("bsd,df->bsf", x, w_up)
        h = _gelu(g) * u
        return torch.einsum("bsf,fd->bsd", h, w_down)

    x = A_x
    x = x + _A_ref(_layernorm(x, axis=-1), A_wqkv, A_wo)
    x = x + _B_ref(_layernorm(x, axis=-1), B_w_gate, B_w_up, B_w_down)
    x = x + _A_ref(_layernorm(x, axis=-1), A_wqkv, A_wo)
    x = x + _B_ref(_layernorm(x, axis=-1), B_w_gate, B_w_up, B_w_down)
    return x
```

```asm
; @launch grid=(256,1,1) block=(256,1,1) lds=163840
.amdgcn_target "amdgcn-amd-amdhsa--gfx950"
.text
.globl interleave_layers__sliding_block__glu_gated_geglu__prompt_kernel
.p2align 8
.type interleave_layers__sliding_block__glu_gated_geglu__prompt_kernel,@function
interleave_layers__sliding_block__glu_gated_geglu__prompt_kernel:
  s_cmp_ge_u32 s2, 256
  s_cbranch_scc1 mega_done
  s_memrealtime s[56:57]
  s_load_dwordx4 s[28:31], s[0:1], 0
  s_load_dwordx2 s[32:33], s[0:1], 16
  s_load_dwordx4 s[60:63], s[0:1], 32
  s_load_dwordx4 s[48:51], s[0:1], 48
  s_load_dwordx4 s[52:55], s[0:1], 64
  v_lshrrev_b32 v1, 6, v0
  v_and_b32 v0, 63, v0
  v_readfirstlane_b32 s20, v1
  v_lshlrev_b32 v1, 4, v0
  s_mov_b32 s3, 0
  s_cmp_lg_u32 s20, 3
  s_cbranch_scc1 no_cpf
  s_getpc_b64 s[34:35]
cpf_base:
  s_lshr_b32 s36, s2, 3
  s_mul_i32 s36, s36, 18
  v_add_u32 v4, s36, v0
  v_and_b32 v4, 1023, v4
  v_lshlrev_b32 v4, 7, v4
  v_mov_b32 v7, s35
  v_min_u32 v6, mega_done-cpf_base, v4
  v_add_co_u32 v2, vcc, s34, v6
  s_nop 1
  v_addc_co_u32 v3, vcc, 0, v7, vcc
  global_load_dword v5, v[2:3], off
no_cpf:
  s_and_b32 s45, s2, 7
  s_lshr_b32 s46, s2, 3
  s_and_b32 s22, s45, 1
  s_lshl_b32 s22, s22, 2
  s_and_b32 s47, s46, 3
  s_add_u32 s22, s22, s47
  s_lshr_b32 s44, s46, 2
  s_lshr_b32 s21, s45, 1
  s_lshl_b32 s21, s21, 3
  s_add_u32 s21, s21, s44
  v_lshrrev_b32 v16, 4, v0
  v_and_b32 v17, 15, v0
  s_lshl_b32 s38, s20, 4
  v_add_u32 v18, s38, v17
  v_lshrrev_b32 v19, 3, v0
  v_add_u32 v19, s38, v19
  v_mul_u32_u24 v2, 1152, v19
  v_and_b32 v19, 7, v0
  v_lshl_add_u32 v2, v19, 4, v2
  s_movk_i32 s26, 9216
  v_lshrrev_b32 v19, 5, v0
  v_and_b32 v20, 31, v0
  v_lshlrev_b32 v24, 1, v19
  v_sub_u32 v20, v20, v24
  v_mul_u32_u24 v21, 57, v20
  v_lshrrev_b32 v21, 9, v21
  v_mul_u32_u24 v21, 1008, v21
  v_lshl_add_u32 v23, v20, 4, v21
  v_mul_u32_u24 v24, 3456, v19
  s_mul_i32 s42, s20, 27648
  v_add3_u32 v23, v23, v24, s42
  v_mov_b32 v25, 0x80000000
  v_cmp_gt_u32 vcc, 27, v20
  s_nop 1
  v_cndmask_b32 v32, v25, v23, vcc
  v_add_u32 v33, 5824, v32
  v_add_u32 v34, 11648, v32
  v_add_u32 v35, 17472, v32
  s_sub_u32 s34, s2, 112
  s_lshr_b32 s35, s34, 3
  s_and_b32 s34, s34, 7
  s_movk_i32 s40, 6554
  s_lshl_b32 s41, s20, 6
  v_add_u32 v19, s41, v0
  v_mul_u32_u24 v20, s40, v19
  v_lshrrev_b32 v20, 16, v20
  v_mul_u32_u24 v21, 10, v20
  v_sub_u32 v21, v19, v21
  v_lshrrev_b32 v22, 4, v20
  v_lshl_add_u32 v19, v22, 1, v20
  v_bfe_u32 v23, v20, 2, 1
  v_lshl_add_u32 v22, v22, 1, v23
  v_mul_u32_u24 v22, 72, v22
  v_bfe_u32 v23, v20, 3, 1
  v_mul_u32_u24 v23, 36, v23
  v_add3_u32 v22, v22, v23, 16
  v_and_b32 v23, 1, v20
  v_add_u32 v22, v22, v23
  v_bfe_u32 v23, v20, 1, 1
  v_mul_u32_u24 v23, 18, v23
  v_add_u32 v22, v22, v23
  s_cmp_lt_u32 s35, 16
  s_cselect_b64 vcc, -1, 0
  v_cndmask_b32 v22, v22, v19, vcc
  v_mul_u32_u24 v22, 1152, v22
  v_lshl_add_u32 v22, v21, 4, v22
  v_cmp_gt_u32 vcc, 9, v21
  s_nop 1
  v_cndmask_b32 v36, v25, v22, vcc
  v_add_u32 v19, 256, v0
  v_mul_u32_u24 v20, s40, v19
  v_lshrrev_b32 v20, 16, v20
  v_mul_u32_u24 v21, 10, v20
  v_sub_u32 v21, v19, v21
  v_lshrrev_b32 v22, 4, v20
  v_lshl_add_u32 v19, v22, 1, v20
  v_bfe_u32 v23, v20, 2, 1
  v_lshl_add_u32 v22, v22, 1, v23
  v_mul_u32_u24 v22, 72, v22
  v_bfe_u32 v23, v20, 3, 1
  v_mul_u32_u24 v23, 36, v23
  v_add3_u32 v22, v22, v23, 16
  v_and_b32 v23, 1, v20
  v_add_u32 v22, v22, v23
  v_bfe_u32 v23, v20, 1, 1
  v_mul_u32_u24 v23, 18, v23
  v_add_u32 v22, v22, v23
  s_cmp_lt_u32 s35, 16
  s_cselect_b64 vcc, -1, 0
  v_cndmask_b32 v22, v22, v19, vcc
  v_mul_u32_u24 v22, 1152, v22
  v_lshl_add_u32 v22, v21, 4, v22
  v_cmp_gt_u32 vcc, 9, v21
  s_nop 1
  v_cndmask_b32 v37, v25, v22, vcc
  s_cmp_eq_u32 s20, 0
  s_cselect_b64 vcc, -1, 0
  v_cndmask_b32 v37, v25, v37, vcc
  s_mul_i32 s36, s35, 41472
  s_sub_u32 s37, s35, 16
  s_mul_i32 s37, s37, 331776
  s_cmp_lt_u32 s35, 16
  s_cselect_b32 s36, s36, s37
  s_mul_i32 s37, s34, 144
  s_add_u32 s36, s36, s37
  s_and_b32 s37, s2, 7
  s_mul_i32 s37, s37, 144
  s_lshr_b32 s39, s2, 3
  s_mul_i32 s39, s39, 110592
  s_add_u32 s37, s37, s39
  s_mov_b32 s14, 0x00012000
  s_mov_b32 s15, 0x00020000
  s_mul_i32 s39, s21, 73728
  s_waitcnt lgkmcnt(0)
  s_sub_u32 s89, s56, 5000
  s_mov_b32 s96, s54
  s_mov_b32 s97, s55
  s_mov_b32 s98, s28
  s_mov_b32 s99, s29
  s_mov_b32 s100, s50
  s_mov_b32 s101, s51
  s_mov_b32 s4, s30
  s_mov_b32 s5, s31
  s_cmp_lt_u32 s2, 144
  s_cselect_b32 s6, 1990656, 0
  s_mov_b32 s7, 0x00020000
  s_mov_b32 s8, s32
  s_mov_b32 s9, s33
  s_cmp_ge_u32 s2, 112
  s_cselect_b32 s10, 663552, 0
  s_mov_b32 s11, 0x00020000
  s_mul_i32 s40, s20, 4480
  s_add_u32 m0, s40, 73728
  s_nop 0
  buffer_load_dwordx4 v32, s[4:7], s37 offen offset:0 lds
  buffer_load_dwordx4 v33, s[4:7], s37 offen offset:1088 lds
  buffer_load_dwordx4 v34, s[4:7], s37 offen offset:2176 lds
  buffer_load_dwordx4 v35, s[4:7], s37 offen offset:3264 lds
  s_lshl_b32 s40, s20, 10
  s_add_u32 m0, s40, 91648
  s_nop 0
  buffer_load_dwordx4 v36, s[8:11], s36 offen lds
  s_cmp_eq_u32 s20, 0
  s_mov_b32 m0, 145920
  s_cselect_b32 m0, 95744, m0
  s_nop 0
  buffer_load_dwordx4 v37, s[8:11], s36 offen lds
  s_add_u32 s12, s98, s39
  s_addc_u32 s13, s99, 0
  buffer_load_dwordx4 v[184:187], v2, s[12:15], 0 offen offset:0
  buffer_load_dwordx4 v[188:191], v2, s[12:15], 0 offen offset:128
  buffer_load_dwordx4 v[192:195], v2, s[12:15], 0 offen offset:256
  buffer_load_dwordx4 v[196:199], v2, s[12:15], 0 offen offset:384
  buffer_load_dwordx4 v[200:203], v2, s[12:15], 0 offen offset:512
  buffer_load_dwordx4 v[204:207], v2, s[12:15], 0 offen offset:640
  buffer_load_dwordx4 v[208:211], v2, s[12:15], 0 offen offset:768
  buffer_load_dwordx4 v[212:215], v2, s[12:15], 0 offen offset:896
  buffer_load_dwordx4 v[216:219], v2, s[12:15], 0 offen offset:1024
  buffer_load_dwordx4 v[220:223], v2, s[12:15], s26 offen offset:0
  buffer_load_dwordx4 v[224:227], v2, s[12:15], s26 offen offset:128
  buffer_load_dwordx4 v[228:231], v2, s[12:15], s26 offen offset:256
  buffer_load_dwordx4 v[232:235], v2, s[12:15], s26 offen offset:384
  buffer_load_dwordx4 v[236:239], v2, s[12:15], s26 offen offset:512
  buffer_load_dwordx4 v[240:243], v2, s[12:15], s26 offen offset:640
  buffer_load_dwordx4 v[244:247], v2, s[12:15], s26 offen offset:768
  buffer_load_dwordx4 v[248:251], v2, s[12:15], s26 offen offset:896
  buffer_load_dwordx4 v[252:255], v2, s[12:15], s26 offen offset:1024
  s_mov_b32 s56, s52
  s_mov_b32 s57, s53
  s_mov_b32 s58, 0x00000100
  s_mov_b32 s59, 0x00020000
  s_or_b32 s38, s2, s20
  s_cmp_lg_u32 s38, 0
  s_cbranch_scc1 no_nonce
  s_memrealtime s[38:39]
  s_waitcnt lgkmcnt(0)
  s_or_b32 s38, s38, 1
  s_mov_b64 exec, 1
  v_mov_b32 v9, 0
  v_mov_b32 v10, s38
  v_mov_b32 v11, s39
  buffer_store_dwordx2 v[10:11], v9, s[56:59], 0 offen sc1
  s_waitcnt vmcnt(0)
  s_mov_b64 exec, -1
no_nonce:
  s_add_u32 s92, s96, 0x06400000
  s_addc_u32 s93, s97, 0
  s_mov_b32 s94, 0x0003a000
  s_mov_b32 s95, 0x00020000
  v_bfe_u32 v19, v0, 2, 2
  v_and_b32 v20, 3, v0
  v_mul_u32_u24 v21, 4480, v16
  v_mul_u32_u24 v22, 544, v19
  v_add3_u32 v21, v21, v22, 0
  v_add_u32 v21, 73728, v21
  v_lshl_add_u32 v21, v20, 3, v21
  s_cmp_eq_u32 s20, 3
  s_cselect_b32 s40, 4, s20
  s_cselect_b64 vcc, -1, 0
  s_lshl_b32 s40, s40, 5
  s_add_u32 s40, s40, 288
  v_add_u32 v38, s40, v21
  s_mul_i32 s40, s20, 72
  s_add_u32 s40, s40, 144
  s_add_u32 s41, s40, 40
  s_cmp_eq_u32 s20, 2
  s_cselect_b32 s40, 384, s40
  v_add_u32 v39, s40, v21
  v_add_u32 v40, s41, v21
  v_lshl_add_u32 v22, v20, 6, v21
  v_add_u32 v22, 32, v22
  v_cndmask_b32 v39, v39, v22, vcc
  s_mul_i32 s40, s20, 36
  s_and_b32 s41, s20, 1
  s_lshl_b32 s41, s41, 2
  s_add_u32 s40, s40, s41
  v_add_u32 v41, s40, v21
  s_cmp_ge_u32 s20, 2
  s_cselect_b64 vcc, -1, 0
  v_cndmask_b32 v40, v40, v41, vcc
  v_lshrrev_b32 v22, 1, v16
  v_and_b32 v23, 1, v16
  v_lshl_add_u32 v24, v23, 2, v19
  v_lshl_add_u32 v24, v22, 4, v24
  v_mul_u32_u24 v24, 160, v24
  v_lshl_add_u32 v24, v20, 3, v24
  v_add_u32 v43, 91776, v24
  s_lshl_b32 s40, s20, 5
  s_add_u32 s40, s40, 91648
  v_add_u32 v42, s40, v24
  s_and_b32 s40, s2, 7
  s_lshl_b32 s40, s40, 2
  s_add_u32 s40, s40, s20
  s_mul_i32 s40, s40, 73728
  s_add_u32 s40, s40, 0x06000000
  s_lshr_b32 s42, s2, 3
  s_mul_i32 s41, s42, 3072
  s_add_u32 s42, s42, 54
  s_lshl_b32 s42, s42, 10
  s_cmp_ge_u32 s20, 2
  s_cselect_b64 vcc, -1, 0
  v_cndmask_b32 v44, v1, v25, vcc
  s_mul_i32 s43, s34, 92160
  s_add_u32 s43, s43, 0x06300000
  s_mul_i32 s45, s35, 5120
  s_lshl_b32 s46, s20, 10
  s_add_u32 s46, s46, s45
  s_add_u32 s45, s45, 4096
  s_cmp_eq_u32 s20, 0
  s_cselect_b64 vcc, -1, 0
  v_cndmask_b32 v45, v25, v1, vcc
  s_mov_b32 s64, s62
  s_mov_b32 s65, s63
  s_mov_b64 s[72:73], s[48:49]
  s_lshr_b32 s74, s2, 3
  s_and_b32 s75, s2, 7
  s_mov_b32 s62, 0x00510000
  s_mov_b32 s63, 0x00020000
  s_mov_b32 s66, 0x00510000
  s_mov_b32 s67, 0x00020000
  s_lshl_b32 s76, s75, 2
  s_add_u32 s76, s76, s20
  s_mul_i32 s76, s76, 497664
  s_add_u32 s76, s76, 0x05000000
  s_add_u32 s68, s96, s76
  s_addc_u32 s69, s97, 0
  s_mov_b32 s70, 0x00079800
  s_mov_b32 s71, 0x00020000
  v_lshrrev_b32 v21, 3, v0
  v_and_b32 v22, 7, v0
  s_lshl_b32 s76, s20, 3
  v_add_u32 v21, s76, v21
  s_and_b32 s76, s20, 1
  s_lshl_b32 s76, s76, 1
  v_add_u32 v24, s76, v23
  v_lshlrev_b32 v24, 1, v24
  v_xor_b32 v24, v24, v22
  v_lshlrev_b32 v24, 4, v24
  v_mul_u32_u24 v21, 9216, v21
  v_add_u32 v12, v24, v21
  v_lshrrev_b32 v24, 1, v19
  v_lshl_add_u32 v24, v23, 1, v24
  v_xor_b32 v24, s20, v24
  v_lshlrev_b32 v24, 5, v24
  v_lshl_add_u32 v24, v20, 3, v24
  v_lshl_add_u32 v24, v19, 7, v24
  v_lshl_add_u32 v13, v16, 10, v24
  s_waitcnt vmcnt(18)
  s_barrier
  ds_read_b64_tr_b16 v[48:49], v38 offset:0
  ds_read_b64_tr_b16 v[50:51], v38 offset:2176
  ds_read_b64_tr_b16 v[52:53], v39 offset:0
  ds_read_b64_tr_b16 v[54:55], v39 offset:2176
  ds_read_b64_tr_b16 v[56:57], v40 offset:0
  ds_read_b64_tr_b16 v[58:59], v40 offset:2176
  ds_read_b64_tr_b16 v[60:61], v41 offset:0
  ds_read_b64_tr_b16 v[62:63], v41 offset:2176
  ds_read_b64_tr_b16 v[64:65], v42 offset:0
  ds_read_b64_tr_b16 v[66:67], v42 offset:1280
  ds_read_b64_tr_b16 v[68:69], v43 offset:0
  ds_read_b64_tr_b16 v[70:71], v43 offset:1280
  s_add_u32 s4, s96, s40
  s_addc_u32 s5, s97, 0
  s_cmp_lt_u32 s2, 144
  s_cselect_b32 s6, 73728, 0
  s_add_u32 s8, s96, s43
  s_addc_u32 s9, s97, 0
  s_cmp_ge_u32 s2, 112
  s_cselect_b32 s10, 92160, 0
  s_waitcnt lgkmcnt(0)
  buffer_store_dwordx4 v[48:51], v1, s[4:7], s41 offen offset:0 sc1
  buffer_store_dwordx4 v[52:55], v1, s[4:7], s41 offen offset:1024 sc1
  buffer_store_dwordx4 v[56:59], v1, s[4:7], s41 offen offset:2048 sc1
  buffer_store_dwordx4 v[60:63], v44, s[4:7], s42 offen offset:0 sc1
  buffer_store_dwordx4 v[64:67], v1, s[8:11], s46 offen sc1
  buffer_store_dwordx4 v[68:71], v45, s[8:11], s45 offen sc1
  v_lshrrev_b32 v161, 4, v0
  v_and_b32 v162, 15, v0
  v_and_b32 v163, 1, v161
  v_lshrrev_b32 v164, 1, v161
  s_lshl_b32 s38, s20, 10
  v_add_u32 v8, s38, v1
  v_add_u32 v7, 36864, v1
  v_lshlrev_b32 v165, 4, v162
  v_lshl_add_u32 v166, v164, 9, v165
  v_lshl_add_u32 v3, v163, 11, v166
  s_lshl_b32 s40, s20, 12
  s_add_u32 s40, s40, 8192
  s_add_u32 s41, s40, 0x400
  s_mul_i32 s39, s20, 4608
  s_add_u32 s39, s39, 73728
  v_mul_u32_u24 v166, 72, v162
  v_lshl_add_u32 v166, v161, 3, v166
  v_add_u32 v172, s39, v166
  v_bfe_u32 v166, v0, 2, 2
  v_lshl_add_u32 v166, v163, 2, v166
  v_lshl_add_u32 v166, v164, 4, v166
  v_mul_u32_u24 v166, 72, v166
  v_and_b32 v173, 3, v0
  v_lshl_add_u32 v166, v173, 3, v166
  v_add_u32 v173, s39, v166
  v_lshlrev_b32 v166, 4, v162
  v_lshl_add_u32 v166, v163, 8, v166
  v_lshl_add_u32 v166, v164, 9, v166
  s_cmp_eq_u32 s20, 3
  s_cselect_b32 s39, 4, s20
  s_lshl_b32 s39, s39, 11
  s_add_u32 s39, s39, 16384
  v_add_u32 v174, s39, v166
  v_lshlrev_b32 v166, 9, v163
  v_lshl_add_u32 v166, v162, 3, v166
  v_add_u32 v166, 27648, v166
  v_mov_b32 v163, 0x80000000
  v_cmp_gt_u32 vcc, 32, v0
  v_mov_b32 v164, 0x3eae1a93
  s_nop 0
  v_cndmask_b32 v6, 1.0, v164, vcc
  v_cndmask_b32 v5, v166, v163, vcc
  s_cmp_ge_u32 s20, 2
  s_cselect_b64 vcc, -1, 0
  v_cndmask_b32 v160, v1, v163, vcc
  s_lshl_b32 s38, s22, 2
  s_add_u32 s38, s38, s20
  s_mul_i32 s38, s38, 73728
  s_add_u32 s38, s38, 0x06000000
  s_add_u32 s4, s96, s38
  s_addc_u32 s5, s97, 0
  s_mov_b32 s6, 0x00012000
  s_mov_b32 s7, 0x00020000
  s_lshl_b32 s38, s21, 3
  s_add_u32 s38, s38, s22
  s_mul_i32 s38, s38, 28672
  s_add_u32 s38, s38, s3
  s_add_u32 s16, s96, s38
  s_addc_u32 s17, s97, 0
  s_mov_b32 s18, 0x00007000
  s_mov_b32 s19, 0x00020000
  s_mov_b32 s26, 0
  s_mov_b32 s29, 0x3f803f80
  s_mov_b32 s28, 0x3eae1a93
  v_mov_b32 v144, 0
  v_mov_b32 v145, 0
  v_mov_b32 v146, 0
  v_mov_b32 v147, 0
  v_mov_b32 v164, 0
  v_mov_b32 v165, 0
  v_mov_b32 v166, 0
  v_mov_b32 v167, 0
  v_and_b32 v168, 7, v0
  v_lshrrev_b32 v169, 3, v0
  v_xor_b32 v169, v169, v168
  v_lshlrev_b32 v169, 4, v169
  v_and_b32 v170, 3, v168
  v_lshl_add_u32 v169, v170, 8, v169
  v_lshrrev_b32 v168, 2, v168
  v_lshl_add_u32 v169, v168, 12, v169
  s_lshl_b32 s38, s20, 10
  v_add_u32 v8, s38, v169
  v_lshrrev_b32 v168, 4, v0
  v_xor_b32 v169, v0, v168
  v_lshlrev_b32 v178, 4, v169
  v_xor_b32 v179, 64, v178
  v_add_u32 v180, 36864, v178
  v_add_u32 v181, 36864, v179
  s_waitcnt vmcnt(23)
  v_dot2c_f32_bf16 v144, s29, v184
  v_dot2c_f32_bf16 v146, v184, v184
  v_dot2c_f32_bf16 v145, s29, v185
  v_dot2c_f32_bf16 v147, v185, v185
  v_dot2c_f32_bf16 v144, s29, v186
  v_dot2c_f32_bf16 v146, v186, v186
  v_dot2c_f32_bf16 v145, s29, v187
  v_dot2c_f32_bf16 v147, v187, v187
  s_waitcnt vmcnt(22)
  v_dot2c_f32_bf16 v144, s29, v188
  v_dot2c_f32_bf16 v146, v188, v188
  v_dot2c_f32_bf16 v145, s29, v189
  v_dot2c_f32_bf16 v147, v189, v189
  v_dot2c_f32_bf16 v144, s29, v190
  v_dot2c_f32_bf16 v146, v190, v190
  v_dot2c_f32_bf16 v145, s29, v191
  v_dot2c_f32_bf16 v147, v191, v191
  s_waitcnt vmcnt(21)
  v_dot2c_f32_bf16 v144, s29, v192
  v_dot2c_f32_bf16 v146, v192, v192
  v_dot2c_f32_bf16 v145, s29, v193
  v_dot2c_f32_bf16 v147, v193, v193
  v_dot2c_f32_bf16 v144, s29, v194
  v_dot2c_f32_bf16 v146, v194, v194
  v_dot2c_f32_bf16 v145, s29, v195
  v_dot2c_f32_bf16 v147, v195, v195
  s_waitcnt vmcnt(20)
  v_dot2c_f32_bf16 v144, s29, v196
  v_dot2c_f32_bf16 v146, v196, v196
  v_dot2c_f32_bf16 v145, s29, v197
  v_dot2c_f32_bf16 v147, v197, v197
  v_dot2c_f32_bf16 v144, s29, v198
  v_dot2c_f32_bf16 v146, v198, v198
  v_dot2c_f32_bf16 v145, s29, v199
  v_dot2c_f32_bf16 v147, v199, v199
  s_waitcnt vmcnt(19)
  v_dot2c_f32_bf16 v144, s29, v200
  v_dot2c_f32_bf16 v146, v200, v200
  v_dot2c_f32_bf16 v145, s29, v201
  v_dot2c_f32_bf16 v147, v201, v201
  v_dot2c_f32_bf16 v144, s29, v202
  v_dot2c_f32_bf16 v146, v202, v202
  v_dot2c_f32_bf16 v145, s29, v203
  v_dot2c_f32_bf16 v147, v203, v203
  s_waitcnt vmcnt(18)
  v_dot2c_f32_bf16 v144, s29, v204
  v_dot2c_f32_bf16 v146, v204, v204
  v_dot2c_f32_bf16 v145, s29, v205
  v_dot2c_f32_bf16 v147, v205, v205
  v_dot2c_f32_bf16 v144, s29, v206
  v_dot2c_f32_bf16 v146, v206, v206
  v_dot2c_f32_bf16 v145, s29, v207
  v_dot2c_f32_bf16 v147, v207, v207
  s_waitcnt vmcnt(17)
  v_dot2c_f32_bf16 v144, s29, v208
  v_dot2c_f32_bf16 v146, v208, v208
  v_dot2c_f32_bf16 v145, s29, v209
  v_dot2c_f32_bf16 v147, v209, v209
  v_dot2c_f32_bf16 v144, s29, v210
  v_dot2c_f32_bf16 v146, v210, v210
  v_dot2c_f32_bf16 v145, s29, v211
  v_dot2c_f32_bf16 v147, v211, v211
  s_waitcnt vmcnt(16)
  v_dot2c_f32_bf16 v144, s29, v212
  v_dot2c_f32_bf16 v146, v212, v212
  v_dot2c_f32_bf16 v145, s29, v213
  v_dot2c_f32_bf16 v147, v213, v213
  v_dot2c_f32_bf16 v144, s29, v214
  v_dot2c_f32_bf16 v146, v214, v214
  v_dot2c_f32_bf16 v145, s29, v215
  v_dot2c_f32_bf16 v147, v215, v215
  s_waitcnt vmcnt(15)
  v_dot2c_f32_bf16 v144, s29, v216
  v_dot2c_f32_bf16 v146, v216, v216
  v_dot2c_f32_bf16 v145, s29, v217
  v_dot2c_f32_bf16 v147, v217, v217
  v_dot2c_f32_bf16 v144, s29, v218
  v_dot2c_f32_bf16 v146, v218, v218
  v_dot2c_f32_bf16 v145, s29, v219
  v_dot2c_f32_bf16 v147, v219, v219
  s_waitcnt vmcnt(14)
  v_dot2c_f32_bf16 v164, s29, v220
  v_dot2c_f32_bf16 v166, v220, v220
  v_dot2c_f32_bf16 v165, s29, v221
  v_dot2c_f32_bf16 v167, v221, v221
  v_dot2c_f32_bf16 v164, s29, v222
  v_dot2c_f32_bf16 v166, v222, v222
  v_dot2c_f32_bf16 v165, s29, v223
  v_dot2c_f32_bf16 v167, v223, v223
  s_waitcnt vmcnt(13)
  v_dot2c_f32_bf16 v164, s29, v224
  v_dot2c_f32_bf16 v166, v224, v224
  v_dot2c_f32_bf16 v165, s29, v225
  v_dot2c_f32_bf16 v167, v225, v225
  v_dot2c_f32_bf16 v164, s29, v226
  v_dot2c_f32_bf16 v166, v226, v226
  v_dot2c_f32_bf16 v165, s29, v227
  v_dot2c_f32_bf16 v167, v227, v227
  s_waitcnt vmcnt(12)
  v_dot2c_f32_bf16 v164, s29, v228
  v_dot2c_f32_bf16 v166, v228, v228
  v_dot2c_f32_bf16 v165, s29, v229
  v_dot2c_f32_bf16 v167, v229, v229
  v_dot2c_f32_bf16 v164, s29, v230
  v_dot2c_f32_bf16 v166, v230, v230
  v_dot2c_f32_bf16 v165, s29, v231
  v_dot2c_f32_bf16 v167, v231, v231
  s_waitcnt vmcnt(11)
  v_dot2c_f32_bf16 v164, s29, v232
  v_dot2c_f32_bf16 v166, v232, v232
  v_dot2c_f32_bf16 v165, s29, v233
  v_dot2c_f32_bf16 v167, v233, v233
  v_dot2c_f32_bf16 v164, s29, v234
  v_dot2c_f32_bf16 v166, v234, v234
  v_dot2c_f32_bf16 v165, s29, v235
  v_dot2c_f32_bf16 v167, v235, v235
  s_waitcnt vmcnt(10)
  v_dot2c_f32_bf16 v164, s29, v236
  v_dot2c_f32_bf16 v166, v236, v236
  v_dot2c_f32_bf16 v165, s29, v237
  v_dot2c_f32_bf16 v167, v237, v237
  v_dot2c_f32_bf16 v164, s29, v238
  v_dot2c_f32_bf16 v166, v238, v238
  v_dot2c_f32_bf16 v165, s29, v239
  v_dot2c_f32_bf16 v167, v239, v239
  s_waitcnt vmcnt(9)
  v_dot2c_f32_bf16 v164, s29, v240
  v_dot2c_f32_bf16 v166, v240, v240
  v_dot2c_f32_bf16 v165, s29, v241
  v_dot2c_f32_bf16 v167, v241, v241
  v_dot2c_f32_bf16 v164, s29, v242
  v_dot2c_f32_bf16 v166, v242, v242
  v_dot2c_f32_bf16 v165, s29, v243
  v_dot2c_f32_bf16 v167, v243, v243
  s_waitcnt vmcnt(8)
  v_dot2c_f32_bf16 v164, s29, v244
  v_dot2c_f32_bf16 v166, v244, v244
  v_dot2c_f32_bf16 v165, s29, v245
  v_dot2c_f32_bf16 v167, v245, v245
  v_dot2c_f32_bf16 v164, s29, v246
  v_dot2c_f32_bf16 v166, v246, v246
  v_dot2c_f32_bf16 v165, s29, v247
  v_dot2c_f32_bf16 v167, v247, v247
  s_waitcnt vmcnt(7)
  v_dot2c_f32_bf16 v164, s29, v248
  v_dot2c_f32_bf16 v166, v248, v248
  v_dot2c_f32_bf16 v165, s29, v249
  v_dot2c_f32_bf16 v167, v249, v249
  v_dot2c_f32_bf16 v164, s29, v250
  v_dot2c_f32_bf16 v166, v250, v250
  v_dot2c_f32_bf16 v165, s29, v251
  v_dot2c_f32_bf16 v167, v251, v251
  s_waitcnt vmcnt(6)
  v_dot2c_f32_bf16 v164, s29, v252
  v_dot2c_f32_bf16 v166, v252, v252
  v_dot2c_f32_bf16 v165, s29, v253
  v_dot2c_f32_bf16 v167, v253, v253
  v_dot2c_f32_bf16 v164, s29, v254
  v_dot2c_f32_bf16 v166, v254, v254
  v_dot2c_f32_bf16 v165, s29, v255
  v_dot2c_f32_bf16 v167, v255, v255
  v_mov_b32 v9, 0
  s_mov_b32 s23, 0x10000
non_l:
  buffer_load_dwordx2 v[10:11], v9, s[56:59], 0 offen sc1
  s_waitcnt vmcnt(0)
  v_readfirstlane_b32 s90, v10
  v_readfirstlane_b32 s91, v11
  s_sub_u32 s23, s23, 1
  s_cbranch_scc1 non_d
  s_cmp_eq_u32 s90, 0
  s_cbranch_scc1 non_l
  s_sub_u32 s24, s90, s89
  s_cmp_lt_i32 s24, 0
  s_cbranch_scc1 non_l
non_d:
  s_waitcnt vmcnt(0)
  s_barrier
  s_cmp_lg_u32 s20, 0
  s_cbranch_scc1 pub1
  s_lshl_b32 s23, s2, 6
  s_add_u32 s23, s23, 0
  s_mov_b64 exec, 1
  v_mov_b32 v9, 0
  v_mov_b32 v10, s90
  v_mov_b32 v11, s91
  buffer_store_dwordx2 v[10:11], v9, s[92:95], s23 offen sc1
  s_mov_b64 exec, -1
pub1:
  s_lshl_b32 s88, s20, 10
  s_add_u32 s76, s74, 0
  s_mul_i32 s78, s76, 3641
  s_lshr_b32 s78, s78, 16
  s_mul_i32 s79, s78, 18
  s_sub_u32 s79, s76, s79
  s_mul_i32 s79, s79, 294912
  s_lshl_b32 s78, s78, 7
  s_add_u32 s78, s78, s79
  s_mul_i32 s79, s75, 1152
  s_add_u32 s78, s78, s79
  s_add_u32 m0, s88, 96768
  s_nop 0
  buffer_load_dwordx4 v12, s[60:63], s78 offen lds
  s_add_u32 m0, s88, 100864
  s_nop 0
  buffer_load_dwordx4 v12, s[64:67], s78 offen lds
  s_add_u32 s76, s74, 32
  s_mul_i32 s78, s76, 3641
  s_lshr_b32 s78, s78, 16
  s_mul_i32 s79, s78, 18
  s_sub_u32 s79, s76, s79
  s_mul_i32 s79, s79, 294912
  s_lshl_b32 s78, s78, 7
  s_add_u32 s78, s78, s79
  s_mul_i32 s79, s75, 1152
  s_add_u32 s78, s78, s79
  s_add_u32 m0, s88, 104960
  s_nop 0
  buffer_load_dwordx4 v12, s[60:63], s78 offen lds
  s_add_u32 m0, s88, 109056
  s_nop 0
  buffer_load_dwordx4 v12, s[64:67], s78 offen lds
  s_add_u32 s76, s74, 64
  s_mul_i32 s78, s76, 3641
  s_lshr_b32 s78, s78, 16
  s_mul_i32 s79, s78, 18
  s_sub_u32 s79, s76, s79
  s_mul_i32 s79, s79, 294912
  s_lshl_b32 s78, s78, 7
  s_add_u32 s78, s78, s79
  s_mul_i32 s79, s75, 1152
  s_add_u32 s78, s78, s79
  s_add_u32 m0, s88, 113152
  s_nop 0
  buffer_load_dwordx4 v12, s[60:63], s78 offen lds
  s_add_u32 m0, s88, 117248
  s_nop 0
  buffer_load_dwordx4 v12, s[64:67], s78 offen lds
  s_add_u32 s76, s74, 96
  s_mul_i32 s78, s76, 3641
  s_lshr_b32 s78, s78, 16
  s_mul_i32 s79, s78, 18
  s_sub_u32 s79, s76, s79
  s_mul_i32 s79, s79, 294912
  s_lshl_b32 s78, s78, 7
  s_add_u32 s78, s78, s79
  s_mul_i32 s79, s75, 1152
  s_add_u32 s78, s78, s79
  s_add_u32 m0, s88, 121344
  s_nop 0
  buffer_load_dwordx4 v12, s[60:63], s78 offen lds
  s_add_u32 m0, s88, 125440
  s_nop 0
  buffer_load_dwordx4 v12, s[64:67], s78 offen lds
  v_add_f32 v144, v144, v145
  v_add_f32 v146, v146, v147
  v_add_f32 v164, v164, v165
  v_add_f32 v166, v166, v167
  s_nop 1
  v_add_f32_dpp v144, v144, v144 quad_perm:[1,0,3,2] row_mask:0xf bank_mask:0xf
  v_add_f32_dpp v146, v146, v146 quad_perm:[1,0,3,2] row_mask:0xf bank_mask:0xf
  s_nop 1
  v_add_f32_dpp v144, v144, v144 quad_perm:[2,3,0,1] row_mask:0xf bank_mask:0xf
  v_add_f32_dpp v146, v146, v146 quad_perm:[2,3,0,1] row_mask:0xf bank_mask:0xf
  s_nop 1
  v_add_f32_dpp v144, v144, v144 row_half_mirror row_mask:0xf bank_mask:0xf
  v_add_f32_dpp v146, v146, v146 row_half_mirror row_mask:0xf bank_mask:0xf
  v_mul_f32 v144, 0x3ae38e39, v144
  v_mul_f32 v146, 0x3ae38e39, v146
  v_fma_f32 v146, -v144, v144, v146
  v_max_f32 v146, 0, v146
  v_add_f32 v146, 0x3727c5ac, v146
  v_rsq_f32 v148, v146
  s_nop 0
  v_mul_f32 v150, v144, v148
  v_sub_f32 v150, 0, v150
  s_nop 1
  v_add_f32_dpp v164, v164, v164 quad_perm:[1,0,3,2] row_mask:0xf bank_mask:0xf
  v_add_f32_dpp v166, v166, v166 quad_perm:[1,0,3,2] row_mask:0xf bank_mask:0xf
  s_nop 1
  v_add_f32_dpp v164, v164, v164 quad_perm:[2,3,0,1] row_mask:0xf bank_mask:0xf
  v_add_f32_dpp v166, v166, v166 quad_perm:[2,3,0,1] row_mask:0xf bank_mask:0xf
  s_nop 1
  v_add_f32_dpp v164, v164, v164 row_half_mirror row_mask:0xf bank_mask:0xf
  v_add_f32_dpp v166, v166, v166 row_half_mirror row_mask:0xf bank_mask:0xf
  v_mul_f32 v164, 0x3ae38e39, v164
  v_mul_f32 v166, 0x3ae38e39, v166
  v_fma_f32 v166, -v164, v164, v166
  v_max_f32 v166, 0, v166
  v_add_f32 v166, 0x3727c5ac, v166
  v_rsq_f32 v168, v166
  s_nop 0
  v_mul_f32 v170, v164, v168
  v_sub_f32 v170, 0, v170
  v_lshlrev_b32 v152, 16, v184
  v_and_b32 v153, 0xffff0000, v184
  v_lshlrev_b32 v154, 16, v185
  v_and_b32 v155, 0xffff0000, v185
  v_lshlrev_b32 v156, 16, v186
  v_and_b32 v157, 0xffff0000, v186
  v_lshlrev_b32 v158, 16, v187
  v_and_b32 v159, 0xffff0000, v187
  v_pk_fma_f32 v[152:153], v[152:153], v[148:149], v[150:151] op_sel_hi:[1,0,0]
  v_pk_fma_f32 v[154:155], v[154:155], v[148:149], v[150:151] op_sel_hi:[1,0,0]
  v_pk_fma_f32 v[156:157], v[156:157], v[148:149], v[150:151] op_sel_hi:[1,0,0]
  v_pk_fma_f32 v[158:159], v[158:159], v[148:149], v[150:151] op_sel_hi:[1,0,0]
  v_cvt_pk_bf16_f32 v184, v152, v153
  v_cvt_pk_bf16_f32 v185, v154, v155
  v_cvt_pk_bf16_f32 v186, v156, v157
  v_cvt_pk_bf16_f32 v187, v158, v159
  ds_write_b128 v8, v[184:187] offset:0
  v_lshlrev_b32 v152, 16, v188
  v_and_b32 v153, 0xffff0000, v188
  v_lshlrev_b32 v154, 16, v189
  v_and_b32 v155, 0xffff0000, v189
  v_lshlrev_b32 v156, 16, v190
  v_and_b32 v157, 0xffff0000, v190
  v_lshlrev_b32 v158, 16, v191
  v_and_b32 v159, 0xffff0000, v191
  v_pk_fma_f32 v[152:153], v[152:153], v[148:149], v[150:151] op_sel_hi:[1,0,0]
  v_pk_fma_f32 v[154:155], v[154:155], v[148:149], v[150:151] op_sel_hi:[1,0,0]
  v_pk_fma_f32 v[156:157], v[156:157], v[148:149], v[150:151] op_sel_hi:[1,0,0]
  v_pk_fma_f32 v[158:159], v[158:159], v[148:149], v[150:151] op_sel_hi:[1,0,0]
  v_cvt_pk_bf16_f32 v188, v152, v153
  v_cvt_pk_bf16_f32 v189, v154, v155
  v_cvt_pk_bf16_f32 v190, v156, v157
  v_cvt_pk_bf16_f32 v191, v158, v159
  ds_write_b128 v8, v[188:191] offset:8192
  v_lshlrev_b32 v152, 16, v192
  v_and_b32 v153, 0xffff0000, v192
  v_lshlrev_b32 v154, 16, v193
  v_and_b32 v155, 0xffff0000, v193
  v_lshlrev_b32 v156, 16, v194
  v_and_b32 v157, 0xffff0000, v194
  v_lshlrev_b32 v158, 16, v195
  v_and_b32 v159, 0xffff0000, v195
  v_pk_fma_f32 v[152:153], v[152:153], v[148:149], v[150:151] op_sel_hi:[1,0,0]
  v_pk_fma_f32 v[154:155], v[154:155], v[148:149], v[150:151] op_sel_hi:[1,0,0]
  v_pk_fma_f32 v[156:157], v[156:157], v[148:149], v[150:151] op_sel_hi:[1,0,0]
  v_pk_fma_f32 v[158:159], v[158:159], v[148:149], v[150:151] op_sel_hi:[1,0,0]
  v_cvt_pk_bf16_f32 v192, v152, v153
  v_cvt_pk_bf16_f32 v193, v154, v155
  v_cvt_pk_bf16_f32 v194, v156, v157
  v_cvt_pk_bf16_f32 v195, v158, v159
  ds_write_b128 v8, v[192:195] offset:16384
  v_lshlrev_b32 v152, 16, v196
  v_and_b32 v153, 0xffff0000, v196
  v_lshlrev_b32 v154, 16, v197
  v_and_b32 v155, 0xffff0000, v197
  v_lshlrev_b32 v156, 16, v198
  v_and_b32 v157, 0xffff0000, v198
  v_lshlrev_b32 v158, 16, v199
  v_and_b32 v159, 0xffff0000, v199
  v_pk_fma_f32 v[152:153], v[152:153], v[148:149], v[150:151] op_sel_hi:[1,0,0]
  v_pk_fma_f32 v[154:155], v[154:155], v[148:149], v[150:151] op_sel_hi:[1,0,0]
  v_pk_fma_f32 v[156:157], v[156:157], v[148:149], v[150:151] op_sel_hi:[1,0,0]
  v_pk_fma_f32 v[158:159], v[158:159], v[148:149], v[150:151] op_sel_hi:[1,0,0]
  v_cvt_pk_bf16_f32 v196, v152, v153
  v_cvt_pk_bf16_f32 v197, v154, v155
  v_cvt_pk_bf16_f32 v198, v156, v157
  v_cvt_pk_bf16_f32 v199, v158, v159
  ds_write_b128 v8, v[196:199] offset:24576
  v_lshlrev_b32 v152, 16, v200
  v_and_b32 v153, 0xffff0000, v200
  v_lshlrev_b32 v154, 16, v201
  v_and_b32 v155, 0xffff0000, v201
  v_lshlrev_b32 v156, 16, v202
  v_and_b32 v157, 0xffff0000, v202
  v_lshlrev_b32 v158, 16, v203
  v_and_b32 v159, 0xffff0000, v203
  v_pk_fma_f32 v[152:153], v[152:153], v[148:149], v[150:151] op_sel_hi:[1,0,0]
  v_pk_fma_f32 v[154:155], v[154:155], v[148:149], v[150:151] op_sel_hi:[1,0,0]
  v_pk_fma_f32 v[156:157], v[156:157], v[148:149], v[150:151] op_sel_hi:[1,0,0]
  v_pk_fma_f32 v[158:159], v[158:159], v[148:149], v[150:151] op_sel_hi:[1,0,0]
  v_cvt_pk_bf16_f32 v200, v152, v153
  v_cvt_pk_bf16_f32 v201, v154, v155
  v_cvt_pk_bf16_f32 v202, v156, v157
  v_cvt_pk_bf16_f32 v203, v158, v159
  ds_write_b128 v8, v[200:203] offset:32768
  v_lshlrev_b32 v152, 16, v204
  v_and_b32 v153, 0xffff0000, v204
  v_lshlrev_b32 v154, 16, v205
  v_and_b32 v155, 0xffff0000, v205
  v_lshlrev_b32 v156, 16, v206
  v_and_b32 v157, 0xffff0000, v206
  v_lshlrev_b32 v158, 16, v207
  v_and_b32 v159, 0xffff0000, v207
  v_pk_fma_f32 v[152:153], v[152:153], v[148:149], v[150:151] op_sel_hi:[1,0,0]
  v_pk_fma_f32 v[154:155], v[154:155], v[148:149], v[150:151] op_sel_hi:[1,0,0]
  v_pk_fma_f32 v[156:157], v[156:157], v[148:149], v[150:151] op_sel_hi:[1,0,0]
  v_pk_fma_f32 v[158:159], v[158:159], v[148:149], v[150:151] op_sel_hi:[1,0,0]
  v_cvt_pk_bf16_f32 v204, v152, v153
  v_cvt_pk_bf16_f32 v205, v154, v155
  v_cvt_pk_bf16_f32 v206, v156, v157
  v_cvt_pk_bf16_f32 v207, v158, v159
  ds_write_b128 v8, v[204:207] offset:40960
  v_lshlrev_b32 v152, 16, v208
  v_and_b32 v153, 0xffff0000, v208
  v_lshlrev_b32 v154, 16, v209
  v_and_b32 v155, 0xffff0000, v209
  v_lshlrev_b32 v156, 16, v210
  v_and_b32 v157, 0xffff0000, v210
  v_lshlrev_b32 v158, 16, v211
  v_and_b32 v159, 0xffff0000, v211
  v_pk_fma_f32 v[152:153], v[152:153], v[148:149], v[150:151] op_sel_hi:[1,0,0]
  v_pk_fma_f32 v[154:155], v[154:155], v[148:149], v[150:151] op_sel_hi:[1,0,0]
  v_pk_fma_f32 v[156:157], v[156:157], v[148:149], v[150:151] op_sel_hi:[1,0,0]
  v_pk_fma_f32 v[158:159], v[158:159], v[148:149], v[150:151] op_sel_hi:[1,0,0]
  v_cvt_pk_bf16_f32 v208, v152, v153
  v_cvt_pk_bf16_f32 v209, v154, v155
  v_cvt_pk_bf16_f32 v210, v156, v157
  v_cvt_pk_bf16_f32 v211, v158, v159
  ds_write_b128 v8, v[208:211] offset:49152
  v_lshlrev_b32 v152, 16, v212
  v_and_b32 v153, 0xffff0000, v212
  v_lshlrev_b32 v154, 16, v213
  v_and_b32 v155, 0xffff0000, v213
  v_lshlrev_b32 v156, 16, v214
  v_and_b32 v157, 0xffff0000, v214
  v_lshlrev_b32 v158, 16, v215
  v_and_b32 v159, 0xffff0000, v215
  v_pk_fma_f32 v[152:153], v[152:153], v[148:149], v[150:151] op_sel_hi:[1,0,0]
  v_pk_fma_f32 v[154:155], v[154:155], v[148:149], v[150:151] op_sel_hi:[1,0,0]
  v_pk_fma_f32 v[156:157], v[156:157], v[148:149], v[150:151] op_sel_hi:[1,0,0]
  v_pk_fma_f32 v[158:159], v[158:159], v[148:149], v[150:151] op_sel_hi:[1,0,0]
  v_cvt_pk_bf16_f32 v212, v152, v153
  v_cvt_pk_bf16_f32 v213, v154, v155
  v_cvt_pk_bf16_f32 v214, v156, v157
  v_cvt_pk_bf16_f32 v215, v158, v159
  ds_write_b128 v8, v[212:215] offset:57344
  v_lshlrev_b32 v152, 16, v220
  v_and_b32 v153, 0xffff0000, v220
  v_lshlrev_b32 v154, 16, v221
  v_and_b32 v155, 0xffff0000, v221
  v_lshlrev_b32 v156, 16, v222
  v_and_b32 v157, 0xffff0000, v222
  v_lshlrev_b32 v158, 16, v223
  v_and_b32 v159, 0xffff0000, v223
  v_pk_fma_f32 v[152:153], v[152:153], v[168:169], v[170:171] op_sel_hi:[1,0,0]
  v_pk_fma_f32 v[154:155], v[154:155], v[168:169], v[170:171] op_sel_hi:[1,0,0]
  v_pk_fma_f32 v[156:157], v[156:157], v[168:169], v[170:171] op_sel_hi:[1,0,0]
  v_pk_fma_f32 v[158:159], v[158:159], v[168:169], v[170:171] op_sel_hi:[1,0,0]
  v_cvt_pk_bf16_f32 v220, v152, v153
  v_cvt_pk_bf16_f32 v221, v154, v155
  v_cvt_pk_bf16_f32 v222, v156, v157
  v_cvt_pk_bf16_f32 v223, v158, v159
  ds_write_b128 v8, v[220:223] offset:128
  v_lshlrev_b32 v152, 16, v224
  v_and_b32 v153, 0xffff0000, v224
  v_lshlrev_b32 v154, 16, v225
  v_and_b32 v155, 0xffff0000, v225
  v_lshlrev_b32 v156, 16, v226
  v_and_b32 v157, 0xffff0000, v226
  v_lshlrev_b32 v158, 16, v227
  v_and_b32 v159, 0xffff0000, v227
  v_pk_fma_f32 v[152:153], v[152:153], v[168:169], v[170:171] op_sel_hi:[1,0,0]
  v_pk_fma_f32 v[154:155], v[154:155], v[168:169], v[170:171] op_sel_hi:[1,0,0]
  v_pk_fma_f32 v[156:157], v[156:157], v[168:169], v[170:171] op_sel_hi:[1,0,0]
  v_pk_fma_f32 v[158:159], v[158:159], v[168:169], v[170:171] op_sel_hi:[1,0,0]
  v_cvt_pk_bf16_f32 v224, v152, v153
  v_cvt_pk_bf16_f32 v225, v154, v155
  v_cvt_pk_bf16_f32 v226, v156, v157
  v_cvt_pk_bf16_f32 v227, v158, v159
  ds_write_b128 v8, v[224:227] offset:8320
  v_lshlrev_b32 v152, 16, v228
  v_and_b32 v153, 0xffff0000, v228
  v_lshlrev_b32 v154, 16, v229
  v_and_b32 v155, 0xffff0000, v229
  v_lshlrev_b32 v156, 16, v230
  v_and_b32 v157, 0xffff0000, v230
  v_lshlrev_b32 v158, 16, v231
  v_and_b32 v159, 0xffff0000, v231
  v_pk_fma_f32 v[152:153], v[152:153], v[168:169], v[170:171] op_sel_hi:[1,0,0]
  v_pk_fma_f32 v[154:155], v[154:155], v[168:169], v[170:171] op_sel_hi:[1,0,0]
  v_pk_fma_f32 v[156:157], v[156:157], v[168:169], v[170:171] op_sel_hi:[1,0,0]
  v_pk_fma_f32 v[158:159], v[158:159], v[168:169], v[170:171] op_sel_hi:[1,0,0]
  v_cvt_pk_bf16_f32 v228, v152, v153
  v_cvt_pk_bf16_f32 v229, v154, v155
  v_cvt_pk_bf16_f32 v230, v156, v157
  v_cvt_pk_bf16_f32 v231, v158, v159
  ds_write_b128 v8, v[228:231] offset:16512
  v_lshlrev_b32 v152, 16, v232
  v_and_b32 v153, 0xffff0000, v232
  v_lshlrev_b32 v154, 16, v233
  v_and_b32 v155, 0xffff0000, v233
  v_lshlrev_b32 v156, 16, v234
  v_and_b32 v157, 0xffff0000, v234
  v_lshlrev_b32 v158, 16, v235
  v_and_b32 v159, 0xffff0000, v235
  v_pk_fma_f32 v[152:153], v[152:153], v[168:169], v[170:171] op_sel_hi:[1,0,0]
  v_pk_fma_f32 v[154:155], v[154:155], v[168:169], v[170:171] op_sel_hi:[1,0,0]
  v_pk_fma_f32 v[156:157], v[156:157], v[168:169], v[170:171] op_sel_hi:[1,0,0]
  v_pk_fma_f32 v[158:159], v[158:159], v[168:169], v[170:171] op_sel_hi:[1,0,0]
  v_cvt_pk_bf16_f32 v232, v152, v153
  v_cvt_pk_bf16_f32 v233, v154, v155
  v_cvt_pk_bf16_f32 v234, v156, v157
  v_cvt_pk_bf16_f32 v235, v158, v159
  ds_write_b128 v8, v[232:235] offset:24704
  v_lshlrev_b32 v152, 16, v236
  v_and_b32 v153, 0xffff0000, v236
  v_lshlrev_b32 v154, 16, v237
  v_and_b32 v155, 0xffff0000, v237
  v_lshlrev_b32 v156, 16, v238
  v_and_b32 v157, 0xffff0000, v238
  v_lshlrev_b32 v158, 16, v239
  v_and_b32 v159, 0xffff0000, v239
  v_pk_fma_f32 v[152:153], v[152:153], v[168:169], v[170:171] op_sel_hi:[1,0,0]
  v_pk_fma_f32 v[154:155], v[154:155], v[168:169], v[170:171] op_sel_hi:[1,0,0]
  v_pk_fma_f32 v[156:157], v[156:157], v[168:169], v[170:171] op_sel_hi:[1,0,0]
  v_pk_fma_f32 v[158:159], v[158:159], v[168:169], v[170:171] op_sel_hi:[1,0,0]
  v_cvt_pk_bf16_f32 v236, v152, v153
  v_cvt_pk_bf16_f32 v237, v154, v155
  v_cvt_pk_bf16_f32 v238, v156, v157
  v_cvt_pk_bf16_f32 v239, v158, v159
  ds_write_b128 v8, v[236:239] offset:32896
  v_lshlrev_b32 v152, 16, v240
  v_and_b32 v153, 0xffff0000, v240
  v_lshlrev_b32 v154, 16, v241
  v_and_b32 v155, 0xffff0000, v241
  v_lshlrev_b32 v156, 16, v242
  v_and_b32 v157, 0xffff0000, v242
  v_lshlrev_b32 v158, 16, v243
  v_and_b32 v159, 0xffff0000, v243
  v_pk_fma_f32 v[152:153], v[152:153], v[168:169], v[170:171] op_sel_hi:[1,0,0]
  v_pk_fma_f32 v[154:155], v[154:155], v[168:169], v[170:171] op_sel_hi:[1,0,0]
  v_pk_fma_f32 v[156:157], v[156:157], v[168:169], v[170:171] op_sel_hi:[1,0,0]
  v_pk_fma_f32 v[158:159], v[158:159], v[168:169], v[170:171] op_sel_hi:[1,0,0]
  v_cvt_pk_bf16_f32 v240, v152, v153
  v_cvt_pk_bf16_f32 v241, v154, v155
  v_cvt_pk_bf16_f32 v242, v156, v157
  v_cvt_pk_bf16_f32 v243, v158, v159
  ds_write_b128 v8, v[240:243] offset:41088
  v_lshlrev_b32 v152, 16, v244
  v_and_b32 v153, 0xffff0000, v244
  v_lshlrev_b32 v154, 16, v245
  v_and_b32 v155, 0xffff0000, v245
  v_lshlrev_b32 v156, 16, v246
  v_and_b32 v157, 0xffff0000, v246
  v_lshlrev_b32 v158, 16, v247
  v_and_b32 v159, 0xffff0000, v247
  v_pk_fma_f32 v[152:153], v[152:153], v[168:169], v[170:171] op_sel_hi:[1,0,0]
  v_pk_fma_f32 v[154:155], v[154:155], v[168:169], v[170:171] op_sel_hi:[1,0,0]
  v_pk_fma_f32 v[156:157], v[156:157], v[168:169], v[170:171] op_sel_hi:[1,0,0]
  v_pk_fma_f32 v[158:159], v[158:159], v[168:169], v[170:171] op_sel_hi:[1,0,0]
  v_cvt_pk_bf16_f32 v244, v152, v153
  v_cvt_pk_bf16_f32 v245, v154, v155
  v_cvt_pk_bf16_f32 v246, v156, v157
  v_cvt_pk_bf16_f32 v247, v158, v159
  ds_write_b128 v8, v[244:247] offset:49280
  v_lshlrev_b32 v152, 16, v248
  v_and_b32 v153, 0xffff0000, v248
  v_lshlrev_b32 v154, 16, v249
  v_and_b32 v155, 0xffff0000, v249
  v_lshlrev_b32 v156, 16, v250
  v_and_b32 v157, 0xffff0000, v250
  v_lshlrev_b32 v158, 16, v251
  v_and_b32 v159, 0xffff0000, v251
  v_pk_fma_f32 v[152:153], v[152:153], v[168:169], v[170:171] op_sel_hi:[1,0,0]
  v_pk_fma_f32 v[154:155], v[154:155], v[168:169], v[170:171] op_sel_hi:[1,0,0]
  v_pk_fma_f32 v[156:157], v[156:157], v[168:169], v[170:171] op_sel_hi:[1,0,0]
  v_pk_fma_f32 v[158:159], v[158:159], v[168:169], v[170:171] op_sel_hi:[1,0,0]
  v_cvt_pk_bf16_f32 v248, v152, v153
  v_cvt_pk_bf16_f32 v249, v154, v155
  v_cvt_pk_bf16_f32 v250, v156, v157
  v_cvt_pk_bf16_f32 v251, v158, v159
  ds_write_b128 v8, v[248:251] offset:57472
  v_lshlrev_b32 v152, 16, v216
  v_and_b32 v153, 0xffff0000, v216
  v_lshlrev_b32 v154, 16, v217
  v_and_b32 v155, 0xffff0000, v217
  v_lshlrev_b32 v156, 16, v218
  v_and_b32 v157, 0xffff0000, v218
  v_lshlrev_b32 v158, 16, v219
  v_and_b32 v159, 0xffff0000, v219
  v_pk_fma_f32 v[152:153], v[152:153], v[148:149], v[150:151] op_sel_hi:[1,0,0]
  v_pk_fma_f32 v[154:155], v[154:155], v[148:149], v[150:151] op_sel_hi:[1,0,0]
  v_pk_fma_f32 v[156:157], v[156:157], v[148:149], v[150:151] op_sel_hi:[1,0,0]
  v_pk_fma_f32 v[158:159], v[158:159], v[148:149], v[150:151] op_sel_hi:[1,0,0]
  v_cvt_pk_bf16_f32 v216, v152, v153
  v_cvt_pk_bf16_f32 v217, v154, v155
  v_cvt_pk_bf16_f32 v218, v156, v157
  v_cvt_pk_bf16_f32 v219, v158, v159
  v_add_u32 v8, 0x10000, v8
  ds_write_b128 v8, v[216:219] offset:0
  v_lshlrev_b32 v152, 16, v252
  v_and_b32 v153, 0xffff0000, v252
  v_lshlrev_b32 v154, 16, v253
  v_and_b32 v155, 0xffff0000, v253
  v_lshlrev_b32 v156, 16, v254
  v_and_b32 v157, 0xffff0000, v254
  v_lshlrev_b32 v158, 16, v255
  v_and_b32 v159, 0xffff0000, v255
  v_pk_fma_f32 v[152:153], v[152:153], v[168:169], v[170:171] op_sel_hi:[1,0,0]
  v_pk_fma_f32 v[154:155], v[154:155], v[168:169], v[170:171] op_sel_hi:[1,0,0]
  v_pk_fma_f32 v[156:157], v[156:157], v[168:169], v[170:171] op_sel_hi:[1,0,0]
  v_pk_fma_f32 v[158:159], v[158:159], v[168:169], v[170:171] op_sel_hi:[1,0,0]
  v_cvt_pk_bf16_f32 v252, v152, v153
  v_cvt_pk_bf16_f32 v253, v154, v155
  v_cvt_pk_bf16_f32 v254, v156, v157
  v_cvt_pk_bf16_f32 v255, v158, v159
  ds_write_b128 v8, v[252:255] offset:128
  s_waitcnt vmcnt(0) lgkmcnt(0)
  s_cmp_lg_u32 s20, 0
  s_cbranch_scc1 wt2_d
  v_and_b32 v9, 31, v0
  v_min_u32 v9, 17, v9
  v_lshlrev_b32 v9, 3, v9
  s_bfe_u32 s23, s2, 0x30003
  s_add_u32 s23, s23, 112
  v_add_u32 v10, s23, v9
  v_add_u32 v9, s22, v9
  v_cmp_gt_u32 vcc, 32, v0
  s_nop 1
  v_cndmask_b32 v9, v10, v9, vcc
  v_lshlrev_b32 v9, 6, v9
  s_mov_b32 s23, 0x10000
wt2_l:
  buffer_load_dwordx2 v[10:11], v9, s[92:95], 0 offen sc1
  s_waitcnt vmcnt(0)
  v_cmp_ne_u64 vcc, s[90:91], v[10:11]
  s_sub_u32 s23, s23, 1
  s_cselect_b64 s[24:25], 0, -1
  s_nop 1
  s_and_b64 vcc, vcc, s[24:25]
  s_cbranch_vccnz wt2_l
wt2_d:
  s_barrier
  buffer_load_dwordx4 a[0:3], v1, s[4:7], s26 offen sc1
  buffer_load_dwordx4 a[4:7], v1, s[4:7], s26 offen offset:1024 sc1
  buffer_load_dwordx4 a[8:11], v1, s[4:7], s26 offen offset:2048 sc1
  buffer_load_dwordx4 a[12:15], v1, s[4:7], s26 offen offset:3072 sc1
  s_add_u32 s26, s26, 0x1000
  buffer_load_dwordx4 a[16:19], v1, s[4:7], s26 offen sc1
  buffer_load_dwordx4 a[20:23], v1, s[4:7], s26 offen offset:1024 sc1
  buffer_load_dwordx4 a[24:27], v1, s[4:7], s26 offen offset:2048 sc1
  buffer_load_dwordx4 a[28:31], v1, s[4:7], s26 offen offset:3072 sc1
  s_add_u32 s26, s26, 0x1000
  buffer_load_dwordx4 a[32:35], v1, s[4:7], s26 offen sc1
  buffer_load_dwordx4 a[36:39], v1, s[4:7], s26 offen offset:1024 sc1
  buffer_load_dwordx4 a[40:43], v1, s[4:7], s26 offen offset:2048 sc1
  buffer_load_dwordx4 a[44:47], v1, s[4:7], s26 offen offset:3072 sc1
  s_add_u32 s26, s26, 0x1000
  s_mov_b32 s14, 0
  ds_read_b128 v[112:115], v178 offset:0
  ds_read_b128 v[116:119], v178 offset:1024
  ds_read_b128 v[120:123], v178 offset:2048
  ds_read_b128 v[124:127], v178 offset:3072
  s_waitcnt vmcnt(9) lgkmcnt(0)
  v_mfma_f32_16x16x32_bf16 v[48:51], a[0:3], v[112:115], 0
  ds_read_b128 v[128:131], v179 offset:4096
  v_mfma_f32_16x16x32_bf16 v[64:67], a[4:7], v[112:115], 0
  ds_read_b128 v[132:135], v179 offset:5120
  v_mfma_f32_16x16x32_bf16 v[80:83], a[8:11], v[112:115], 0
  buffer_load_dwordx4 a[48:51], v1, s[4:7], s26 offen sc1
  v_mfma_f32_16x16x32_bf16 v[52:55], a[0:3], v[116:119], 0
  ds_read_b128 v[136:139], v179 offset:6144
  v_mfma_f32_16x16x32_bf16 v[68:71], a[4:7], v[116:119], 0
  ds_read_b128 v[140:143], v179 offset:7168
  v_mfma_f32_16x16x32_bf16 v[84:87], a[8:11], v[116:119], 0
  buffer_load_dwordx4 a[52:55], v1, s[4:7], s26 offen offset:1024 sc1
  v_mfma_f32_16x16x32_bf16 v[56:59], a[0:3], v[120:123], 0
  v_mfma_f32_16x16x32_bf16 v[72:75], a[4:7], v[120:123], 0
  v_mfma_f32_16x16x32_bf16 v[88:91], a[8:11], v[120:123], 0
  buffer_load_dwordx4 a[56:59], v1, s[4:7], s26 offen offset:2048 sc1
  v_mfma_f32_16x16x32_bf16 v[60:63], a[0:3], v[124:127], 0
  v_mfma_f32_16x16x32_bf16 v[76:79], a[4:7], v[124:127], 0
  v_mfma_f32_16x16x32_bf16 v[92:95], a[8:11], v[124:127], 0
  buffer_load_dwordx4 a[60:63], v1, s[4:7], s26 offen offset:3072 sc1
  s_add_u32 s26, s26, 0x1000
  s_waitcnt vmcnt(10) lgkmcnt(0)
  v_mfma_f32_16x16x32_bf16 v[48:51], a[12:15], v[128:131], v[48:51]
  ds_read_b128 v[112:115], v178 offset:8192
  v_mfma_f32_16x16x32_bf16 v[64:67], a[16:19], v[128:131], v[64:67]
  ds_read_b128 v[116:119], v178 offset:9216
  v_mfma_f32_16x16x32_bf16 v[80:83], a[20:23], v[128:131], v[80:83]
  buffer_load_dwordx4 a[64:67], v1, s[4:7], s26 offen sc1
  v_mfma_f32_16x16x32_bf16 v[52:55], a[12:15], v[132:135], v[52:55]
  ds_read_b128 v[120:123], v178 offset:10240
  v_mfma_f32_16x16x32_bf16 v[68:71], a[16:19], v[132:135], v[68:71]
  ds_read_b128 v[124:127], v178 offset:11264
  v_mfma_f32_16x16x32_bf16 v[84:87], a[20:23], v[132:135], v[84:87]
  buffer_load_dwordx4 a[68:71], v1, s[4:7], s26 offen offset:1024 sc1
  v_mfma_f32_16x16x32_bf16 v[56:59], a[12:15], v[136:139], v[56:59]
  v_mfma_f32_16x16x32_bf16 v[72:75], a[16:19], v[136:139], v[72:75]
  v_mfma_f32_16x16x32_bf16 v[88:91], a[20:23], v[136:139], v[88:91]
  buffer_load_dwordx4 a[72:75], v1, s[4:7], s26 offen offset:2048 sc1
  v_mfma_f32_16x16x32_bf16 v[60:63], a[12:15], v[140:143], v[60:63]
  v_mfma_f32_16x16x32_bf16 v[76:79], a[16:19], v[140:143], v[76:79]
  v_mfma_f32_16x16x32_bf16 v[92:95], a[20:23], v[140:143], v[92:95]
  buffer_load_dwordx4 a[76:79], v1, s[4:7], s26 offen offset:3072 sc1
  s_add_u32 s26, s26, 0x1000
  s_waitcnt vmcnt(11) lgkmcnt(0)
  v_mfma_f32_16x16x32_bf16 v[48:51], a[24:27], v[112:115], v[48:51]
  ds_read_b128 v[128:131], v179 offset:12288
  v_mfma_f32_16x16x32_bf16 v[64:67], a[28:31], v[112:115], v[64:67]
  ds_read_b128 v[132:135], v179 offset:13312
  v_mfma_f32_16x16x32_bf16 v[80:83], a[32:35], v[112:115], v[80:83]
  buffer_load_dwordx4 a[80:83], v1, s[4:7], s26 offen sc1
  v_mfma_f32_16x16x32_bf16 v[52:55], a[24:27], v[116:119], v[52:55]
  ds_read_b128 v[136:139], v179 offset:14336
  v_mfma_f32_16x16x32_bf16 v[68:71], a[28:31], v[116:119], v[68:71]
  ds_read_b128 v[140:143], v179 offset:15360
  v_mfma_f32_16x16x32_bf16 v[84:87], a[32:35], v[116:119], v[84:87]
  buffer_load_dwordx4 a[84:87], v1, s[4:7], s26 offen offset:1024 sc1
  v_mfma_f32_16x16x32_bf16 v[56:59], a[24:27], v[120:123], v[56:59]
  v_mfma_f32_16x16x32_bf16 v[72:75], a[28:31], v[120:123], v[72:75]
  v_mfma_f32_16x16x32_bf16 v[88:91], a[32:35], v[120:123], v[88:91]
  buffer_load_dwordx4 a[88:91], v1, s[4:7], s26 offen offset:2048 sc1
  v_mfma_f32_16x16x32_bf16 v[60:63], a[24:27], v[124:127], v[60:63]
  v_mfma_f32_16x16x32_bf16 v[76:79], a[28:31], v[124:127], v[76:79]
  v_mfma_f32_16x16x32_bf16 v[92:95], a[32:35], v[124:127], v[92:95]
  buffer_load_dwordx4 a[92:95], v1, s[4:7], s26 offen offset:3072 sc1
  s_add_u32 s26, s26, 0x1000
  s_waitcnt vmcnt(12) lgkmcnt(0)
  v_mfma_f32_16x16x32_bf16 v[48:51], a[36:39], v[128:131], v[48:51]
  ds_read_b128 v[112:115], v178 offset:16384
  v_mfma_f32_16x16x32_bf16 v[64:67], a[40:43], v[128:131], v[64:67]
  ds_read_b128 v[116:119], v178 offset:17408
  v_mfma_f32_16x16x32_bf16 v[80:83], a[44:47], v[128:131], v[80:83]
  buffer_load_dwordx4 a[96:99], v1, s[4:7], s26 offen sc1
  v_mfma_f32_16x16x32_bf16 v[52:55], a[36:39], v[132:135], v[52:55]
  ds_read_b128 v[120:123], v178 offset:18432
  v_mfma_f32_16x16x32_bf16 v[68:71], a[40:43], v[132:135], v[68:71]
  ds_read_b128 v[124:127], v178 offset:19456
  v_mfma_f32_16x16x32_bf16 v[84:87], a[44:47], v[132:135], v[84:87]
  buffer_load_dwordx4 a[100:103], v1, s[4:7], s26 offen offset:1024 sc1
  v_mfma_f32_16x16x32_bf16 v[56:59], a[36:39], v[136:139], v[56:59]
  v_mfma_f32_16x16x32_bf16 v[72:75], a[40:43], v[136:139], v[72:75]
  v_mfma_f32_16x16x32_bf16 v[88:91], a[44:47], v[136:139], v[88:91]
  buffer_load_dwordx4 a[104:107], v1, s[4:7], s26 offen offset:2048 sc1
  v_mfma_f32_16x16x32_bf16 v[60:63], a[36:39], v[140:143], v[60:63]
  v_mfma_f32_16x16x32_bf16 v[76:79], a[40:43], v[140:143], v[76:79]
  v_mfma_f32_16x16x32_bf16 v[92:95], a[44:47], v[140:143], v[92:95]
  buffer_load_dwordx4 a[108:111], v1, s[4:7], s26 offen offset:3072 sc1
  s_add_u32 s26, s26, 0x1000
  s_waitcnt vmcnt(13) lgkmcnt(0)
  v_mfma_f32_16x16x32_bf16 v[48:51], a[48:51], v[112:115], v[48:51]
  ds_read_b128 v[128:131], v179 offset:20480
  v_mfma_f32_16x16x32_bf16 v[64:67], a[52:55], v[112:115], v[64:67]
  ds_read_b128 v[132:135], v179 offset:21504
  v_mfma_f32_16x16x32_bf16 v[80:83], a[56:59], v[112:115], v[80:83]
  buffer_load_dwordx4 a[112:115], v1, s[4:7], s26 offen sc1
  v_mfma_f32_16x16x32_bf16 v[52:55], a[48:51], v[116:119], v[52:55]
  ds_read_b128 v[136:139], v179 offset:22528
  v_mfma_f32_16x16x32_bf16 v[68:71], a[52:55], v[116:119], v[68:71]
  ds_read_b128 v[140:143], v179 offset:23552
  v_mfma_f32_16x16x32_bf16 v[84:87], a[56:59], v[116:119], v[84:87]
  buffer_load_dwordx4 a[116:119], v1, s[4:7], s26 offen offset:1024 sc1
  v_mfma_f32_16x16x32_bf16 v[56:59], a[48:51], v[120:123], v[56:59]
  v_mfma_f32_16x16x32_bf16 v[72:75], a[52:55], v[120:123], v[72:75]
  v_mfma_f32_16x16x32_bf16 v[88:91], a[56:59], v[120:123], v[88:91]
  buffer_load_dwordx4 a[120:123], v1, s[4:7], s26 offen offset:2048 sc1
  v_mfma_f32_16x16x32_bf16 v[60:63], a[48:51], v[124:127], v[60:63]
  v_mfma_f32_16x16x32_bf16 v[76:79], a[52:55], v[124:127], v[76:79]
  v_mfma_f32_16x16x32_bf16 v[92:95], a[56:59], v[124:127], v[92:95]
  buffer_load_dwordx4 a[124:127], v1, s[4:7], s26 offen offset:3072 sc1
  s_add_u32 s26, s26, 0x1000
  s_waitcnt vmcnt(14) lgkmcnt(0)
  v_mfma_f32_16x16x32_bf16 v[48:51], a[60:63], v[128:131], v[48:51]
  ds_read_b128 v[112:115], v178 offset:24576
  v_mfma_f32_16x16x32_bf16 v[64:67], a[64:67], v[128:131], v[64:67]
  ds_read_b128 v[116:119], v178 offset:25600
  v_mfma_f32_16x16x32_bf16 v[80:83], a[68:71], v[128:131], v[80:83]
  buffer_load_dwordx4 a[128:131], v1, s[4:7], s26 offen sc1
  v_mfma_f32_16x16x32_bf16 v[52:55], a[60:63], v[132:135], v[52:55]
  ds_read_b128 v[120:123], v178 offset:26624
  v_mfma_f32_16x16x32_bf16 v[68:71], a[64:67], v[132:135], v[68:71]
  ds_read_b128 v[124:127], v178 offset:27648
  v_mfma_f32_16x16x32_bf16 v[84:87], a[68:71], v[132:135], v[84:87]
  buffer_load_dwordx4 a[132:135], v1, s[4:7], s26 offen offset:1024 sc1
  v_mfma_f32_16x16x32_bf16 v[56:59], a[60:63], v[136:139], v[56:59]
  v_mfma_f32_16x16x32_bf16 v[72:75], a[64:67], v[136:139], v[72:75]
  v_mfma_f32_16x16x32_bf16 v[88:91], a[68:71], v[136:139], v[88:91]
  buffer_load_dwordx4 a[136:139], v1, s[4:7], s26 offen offset:2048 sc1
  v_mfma_f32_16x16x32_bf16 v[60:63], a[60:63], v[140:143], v[60:63]
  v_mfma_f32_16x16x32_bf16 v[76:79], a[64:67], v[140:143], v[76:79]
  v_mfma_f32_16x16x32_bf16 v[92:95], a[68:71], v[140:143], v[92:95]
  buffer_load_dwordx4 a[140:143], v1, s[4:7], s26 offen offset:3072 sc1
  s_add_u32 s26, s26, 0x1000
  s_waitcnt vmcnt(15) lgkmcnt(0)
  v_mfma_f32_16x16x32_bf16 v[48:51], a[72:75], v[112:115], v[48:51]
  ds_read_b128 v[128:131], v179 offset:28672
  v_mfma_f32_16x16x32_bf16 v[64:67], a[76:79], v[112:115], v[64:67]
  ds_read_b128 v[132:135], v179 offset:29696
  v_mfma_f32_16x16x32_bf16 v[80:83], a[80:83], v[112:115], v[80:83]
  buffer_load_dwordx4 a[144:147], v1, s[4:7], s26 offen sc1
  v_mfma_f32_16x16x32_bf16 v[52:55], a[72:75], v[116:119], v[52:55]
  ds_read_b128 v[136:139], v179 offset:30720
  v_mfma_f32_16x16x32_bf16 v[68:71], a[76:79], v[116:119], v[68:71]
  ds_read_b128 v[140:143], v179 offset:31744
  v_mfma_f32_16x16x32_bf16 v[84:87], a[80:83], v[116:119], v[84:87]
  buffer_load_dwordx4 a[148:151], v1, s[4:7], s26 offen offset:1024 sc1
  v_mfma_f32_16x16x32_bf16 v[56:59], a[72:75], v[120:123], v[56:59]
  v_mfma_f32_16x16x32_bf16 v[72:75], a[76:79], v[120:123], v[72:75]
  v_mfma_f32_16x16x32_bf16 v[88:91], a[80:83], v[120:123], v[88:91]
  buffer_load_dwordx4 a[152:155], v1, s[4:7], s26 offen offset:2048 sc1
  v_mfma_f32_16x16x32_bf16 v[60:63], a[72:75], v[124:127], v[60:63]
  v_mfma_f32_16x16x32_bf16 v[76:79], a[76:79], v[124:127], v[76:79]
  v_mfma_f32_16x16x32_bf16 v[92:95], a[80:83], v[124:127], v[92:95]
  buffer_load_dwordx4 a[156:159], v1, s[4:7], s26 offen offset:3072 sc1
  s_add_u32 s26, s26, 0x1000
  s_waitcnt vmcnt(16) lgkmcnt(0)
  v_mfma_f32_16x16x32_bf16 v[48:51], a[84:87], v[128:131], v[48:51]
  ds_read_b128 v[112:115], v178 offset:32768
  v_mfma_f32_16x16x32_bf16 v[64:67], a[88:91], v[128:131], v[64:67]
  ds_read_b128 v[116:119], v178 offset:33792
  v_mfma_f32_16x16x32_bf16 v[80:83], a[92:95], v[128:131], v[80:83]
  buffer_load_dwordx4 a[160:163], v1, s[4:7], s26 offen sc1
  v_mfma_f32_16x16x32_bf16 v[52:55], a[84:87], v[132:135], v[52:55]
  ds_read_b128 v[120:123], v178 offset:34816
  v_mfma_f32_16x16x32_bf16 v[68:71], a[88:91], v[132:135], v[68:71]
  ds_read_b128 v[124:127], v178 offset:35840
  v_mfma_f32_16x16x32_bf16 v[84:87], a[92:95], v[132:135], v[84:87]
  buffer_load_dwordx4 a[164:167], v1, s[4:7], s26 offen offset:1024 sc1
  v_mfma_f32_16x16x32_bf16 v[56:59], a[84:87], v[136:139], v[56:59]
  v_mfma_f32_16x16x32_bf16 v[72:75], a[88:91], v[136:139], v[72:75]
  v_mfma_f32_16x16x32_bf16 v[88:91], a[92:95], v[136:139], v[88:91]
  buffer_load_dwordx4 a[168:171], v1, s[4:7], s26 offen offset:2048 sc1
  v_mfma_f32_16x16x32_bf16 v[60:63], a[84:87], v[140:143], v[60:63]
  v_mfma_f32_16x16x32_bf16 v[76:79], a[88:91], v[140:143], v[76:79]
  v_mfma_f32_16x16x32_bf16 v[92:95], a[92:95], v[140:143], v[92:95]
  buffer_load_dwordx4 a[172:175], v1, s[4:7], s26 offen offset:3072 sc1
  s_add_u32 s26, s26, 0x1000
  s_waitcnt vmcnt(17) lgkmcnt(0)
  v_mfma_f32_16x16x32_bf16 v[48:51], a[96:99], v[112:115], v[48:51]
  ds_read_b128 v[128:131], v181 offset:0
  v_mfma_f32_16x16x32_bf16 v[64:67], a[100:103], v[112:115], v[64:67]
  ds_read_b128 v[132:135], v181 offset:1024
  v_mfma_f32_16x16x32_bf16 v[80:83], a[104:107], v[112:115], v[80:83]
  buffer_load_dwordx4 a[176:179], v1, s[4:7], s26 offen sc1
  v_mfma_f32_16x16x32_bf16 v[52:55], a[96:99], v[116:119], v[52:55]
  ds_read_b128 v[136:139], v181 offset:2048
  v_mfma_f32_16x16x32_bf16 v[68:71], a[100:103], v[116:119], v[68:71]
  ds_read_b128 v[140:143], v181 offset:3072
  v_mfma_f32_16x16x32_bf16 v[84:87], a[104:107], v[116:119], v[84:87]
  buffer_load_dwordx4 a[180:183], v1, s[4:7], s26 offen offset:1024 sc1
  v_mfma_f32_16x16x32_bf16 v[56:59], a[96:99], v[120:123], v[56:59]
  v_mfma_f32_16x16x32_bf16 v[72:75], a[100:103], v[120:123], v[72:75]
  v_mfma_f32_16x16x32_bf16 v[88:91], a[104:107], v[120:123], v[88:91]
  buffer_load_dwordx4 a[184:187], v1, s[4:7], s26 offen offset:2048 sc1
  v_mfma_f32_16x16x32_bf16 v[60:63], a[96:99], v[124:127], v[60:63]
  v_mfma_f32_16x16x32_bf16 v[76:79], a[100:103], v[124:127], v[76:79]
  v_mfma_f32_16x16x32_bf16 v[92:95], a[104:107], v[124:127], v[92:95]
  buffer_load_dwordx4 a[188:191], v1, s[4:7], s26 offen offset:3072 sc1
  s_add_u32 s26, s26, 0x1000
  s_waitcnt vmcnt(18) lgkmcnt(0)
  v_mfma_f32_16x16x32_bf16 v[48:51], a[108:111], v[128:131], v[48:51]
  ds_read_b128 v[112:115], v180 offset:4096
  v_mfma_f32_16x16x32_bf16 v[64:67], a[112:115], v[128:131], v[64:67]
  ds_read_b128 v[116:119], v180 offset:5120
  v_mfma_f32_16x16x32_bf16 v[80:83], a[116:119], v[128:131], v[80:83]
  buffer_load_dwordx4 a[192:195], v1, s[4:7], s26 offen sc1
  v_mfma_f32_16x16x32_bf16 v[52:55], a[108:111], v[132:135], v[52:55]
  ds_read_b128 v[120:123], v180 offset:6144
  v_mfma_f32_16x16x32_bf16 v[68:71], a[112:115], v[132:135], v[68:71]
  ds_read_b128 v[124:127], v180 offset:7168
  v_mfma_f32_16x16x32_bf16 v[84:87], a[116:119], v[132:135], v[84:87]
  buffer_load_dwordx4 a[196:199], v1, s[4:7], s26 offen offset:1024 sc1
  v_mfma_f32_16x16x32_bf16 v[56:59], a[108:111], v[136:139], v[56:59]
  v_mfma_f32_16x16x32_bf16 v[72:75], a[112:115], v[136:139], v[72:75]
  v_mfma_f32_16x16x32_bf16 v[88:91], a[116:119], v[136:139], v[88:91]
  buffer_load_dwordx4 a[200:203], v1, s[4:7], s26 offen offset:2048 sc1
  v_mfma_f32_16x16x32_bf16 v[60:63], a[108:111], v[140:143], v[60:63]
  v_mfma_f32_16x16x32_bf16 v[76:79], a[112:115], v[140:143], v[76:79]
  v_mfma_f32_16x16x32_bf16 v[92:95], a[116:119], v[140:143], v[92:95]
  buffer_load_dwordx4 a[204:207], v1, s[4:7], s26 offen offset:3072 sc1
  s_add_u32 s26, s26, 0x1000
  s_waitcnt vmcnt(19) lgkmcnt(0)
  v_mfma_f32_16x16x32_bf16 v[48:51], a[120:123], v[112:115], v[48:51]
  ds_read_b128 v[128:131], v181 offset:8192
  v_mfma_f32_16x16x32_bf16 v[64:67], a[124:127], v[112:115], v[64:67]
  ds_read_b128 v[132:135], v181 offset:9216
  v_mfma_f32_16x16x32_bf16 v[80:83], a[128:131], v[112:115], v[80:83]
  buffer_load_dwordx4 a[208:211], v1, s[4:7], s26 offen sc1
  v_mfma_f32_16x16x32_bf16 v[52:55], a[120:123], v[116:119], v[52:55]
  ds_read_b128 v[136:139], v181 offset:10240
  v_mfma_f32_16x16x32_bf16 v[68:71], a[124:127], v[116:119], v[68:71]
  ds_read_b128 v[140:143], v181 offset:11264
  v_mfma_f32_16x16x32_bf16 v[84:87], a[128:131], v[116:119], v[84:87]
  buffer_load_dwordx4 a[212:215], v1, s[4:7], s26 offen offset:1024 sc1
  v_mfma_f32_16x16x32_bf16 v[56:59], a[120:123], v[120:123], v[56:59]
  v_mfma_f32_16x16x32_bf16 v[72:75], a[124:127], v[120:123], v[72:75]
  v_mfma_f32_16x16x32_bf16 v[88:91], a[128:131], v[120:123], v[88:91]
  buffer_load_dwordx4 a[216:219], v160, s[4:7], s26 offen offset:2048 sc1
  v_mfma_f32_16x16x32_bf16 v[60:63], a[120:123], v[124:127], v[60:63]
  v_mfma_f32_16x16x32_bf16 v[76:79], a[124:127], v[124:127], v[76:79]
  v_mfma_f32_16x16x32_bf16 v[92:95], a[128:131], v[124:127], v[92:95]
  buffer_load_dwordx4 a[220:223], v160, s[4:7], s26 offen offset:3072 sc1
  s_add_u32 s26, s26, 0x1000
  s_waitcnt vmcnt(20) lgkmcnt(0)
  v_mfma_f32_16x16x32_bf16 v[48:51], a[132:135], v[128:131], v[48:51]
  ds_read_b128 v[112:115], v180 offset:12288
  v_mfma_f32_16x16x32_bf16 v[64:67], a[136:139], v[128:131], v[64:67]
  ds_read_b128 v[116:119], v180 offset:13312
  v_mfma_f32_16x16x32_bf16 v[80:83], a[140:143], v[128:131], v[80:83]
  buffer_load_dwordx4 a[224:227], v160, s[4:7], s26 offen sc1
  v_mfma_f32_16x16x32_bf16 v[52:55], a[132:135], v[132:135], v[52:55]
  ds_read_b128 v[120:123], v180 offset:14336
  v_mfma_f32_16x16x32_bf16 v[68:71], a[136:139], v[132:135], v[68:71]
  ds_read_b128 v[124:127], v180 offset:15360
  v_mfma_f32_16x16x32_bf16 v[84:87], a[140:143], v[132:135], v[84:87]
  buffer_load_dwordx4 a[228:231], v160, s[4:7], s26 offen offset:1024 sc1
  v_mfma_f32_16x16x32_bf16 v[56:59], a[132:135], v[136:139], v[56:59]
  v_mfma_f32_16x16x32_bf16 v[72:75], a[136:139], v[136:139], v[72:75]
  v_mfma_f32_16x16x32_bf16 v[88:91], a[140:143], v[136:139], v[88:91]
  buffer_load_dwordx4 a[232:235], v160, s[4:7], s26 offen offset:2048 sc1
  v_mfma_f32_16x16x32_bf16 v[60:63], a[132:135], v[140:143], v[60:63]
  v_mfma_f32_16x16x32_bf16 v[76:79], a[136:139], v[140:143], v[76:79]
  v_mfma_f32_16x16x32_bf16 v[92:95], a[140:143], v[140:143], v[92:95]
  buffer_load_dwordx4 a[236:239], v160, s[4:7], s26 offen offset:3072 sc1
  s_add_u32 s26, s26, 0x1000
  s_waitcnt vmcnt(21) lgkmcnt(0)
  v_mfma_f32_16x16x32_bf16 v[48:51], a[144:147], v[112:115], v[48:51]
  ds_read_b128 v[128:131], v181 offset:16384
  v_mfma_f32_16x16x32_bf16 v[64:67], a[148:151], v[112:115], v[64:67]
  ds_read_b128 v[132:135], v181 offset:17408
  v_mfma_f32_16x16x32_bf16 v[80:83], a[152:155], v[112:115], v[80:83]
  buffer_load_dwordx4 a[240:243], v160, s[4:7], s26 offen sc1
  v_mfma_f32_16x16x32_bf16 v[52:55], a[144:147], v[116:119], v[52:55]
  ds_read_b128 v[136:139], v181 offset:18432
  v_mfma_f32_16x16x32_bf16 v[68:71], a[148:151], v[116:119], v[68:71]
  ds_read_b128 v[140:143], v181 offset:19456
  v_mfma_f32_16x16x32_bf16 v[84:87], a[152:155], v[116:119], v[84:87]
  buffer_load_dwordx4 a[244:247], v160, s[4:7], s26 offen offset:1024 sc1
  v_mfma_f32_16x16x32_bf16 v[56:59], a[144:147], v[120:123], v[56:59]
  v_mfma_f32_16x16x32_bf16 v[72:75], a[148:151], v[120:123], v[72:75]
  v_mfma_f32_16x16x32_bf16 v[88:91], a[152:155], v[120:123], v[88:91]
  buffer_load_dwordx4 a[248:251], v160, s[4:7], s26 offen offset:2048 sc1
  v_mfma_f32_16x16x32_bf16 v[60:63], a[144:147], v[124:127], v[60:63]
  v_mfma_f32_16x16x32_bf16 v[76:79], a[148:151], v[124:127], v[76:79]
  v_mfma_f32_16x16x32_bf16 v[92:95], a[152:155], v[124:127], v[92:95]
  buffer_load_dwordx4 a[252:255], v160, s[4:7], s26 offen offset:3072 sc1
  s_add_u32 s26, s26, 0x1000
  v_add_u32 v161, 96768, v13
  v_add_u32 v162, 512, v161
  ds_read_b64_tr_b16 v[216:217], v161 offset:0
  ds_read_b64_tr_b16 v[218:219], v162 offset:0
  ds_read_b64_tr_b16 v[220:221], v161 offset:4096
  ds_read_b64_tr_b16 v[222:223], v162 offset:4096
  ds_read_b64_tr_b16 v[224:225], v161 offset:8192
  ds_read_b64_tr_b16 v[226:227], v162 offset:8192
  ds_read_b64_tr_b16 v[228:229], v161 offset:12288
  ds_read_b64_tr_b16 v[230:231], v162 offset:12288
  s_waitcnt lgkmcnt(4)
  ds_read_b64_tr_b16 v[232:233], v161 offset:16384
  ds_read_b64_tr_b16 v[234:235], v162 offset:16384
  ds_read_b64_tr_b16 v[236:237], v161 offset:20480
  ds_read_b64_tr_b16 v[238:239], v162 offset:20480
  ds_read_b64_tr_b16 v[240:241], v161 offset:24576
  ds_read_b64_tr_b16 v[242:243], v162 offset:24576
  ds_read_b64_tr_b16 v[244:245], v161 offset:28672
  ds_read_b64_tr_b16 v[246:247], v162 offset:28672
  s_waitcnt vmcnt(22) lgkmcnt(0)
  v_mfma_f32_16x16x32_bf16 v[48:51], a[156:159], v[128:131], v[48:51]
  ds_read_b128 v[112:115], v180 offset:20480
  v_mfma_f32_16x16x32_bf16 v[64:67], a[160:163], v[128:131], v[64:67]
  ds_read_b128 v[116:119], v180 offset:21504
  v_mfma_f32_16x16x32_bf16 v[80:83], a[164:167], v[128:131], v[80:83]
  buffer_load_dwordx4 v[16:19], v160, s[4:7], s26 offen sc1
  v_mfma_f32_16x16x32_bf16 v[52:55], a[156:159], v[132:135], v[52:55]
  ds_read_b128 v[120:123], v180 offset:22528
  v_mfma_f32_16x16x32_bf16 v[68:71], a[160:163], v[132:135], v[68:71]
  ds_read_b128 v[124:127], v180 offset:23552
  v_mfma_f32_16x16x32_bf16 v[84:87], a[164:167], v[132:135], v[84:87]
  buffer_load_dwordx4 v[20:23], v160, s[4:7], s26 offen offset:1024 sc1
  v_mfma_f32_16x16x32_bf16 v[56:59], a[156:159], v[136:139], v[56:59]
  v_mfma_f32_16x16x32_bf16 v[72:75], a[160:163], v[136:139], v[72:75]
  v_mfma_f32_16x16x32_bf16 v[88:91], a[164:167], v[136:139], v[88:91]
  buffer_load_dwordx4 v[24:27], v160, s[4:7], s26 offen offset:2048 sc1
  v_mfma_f32_16x16x32_bf16 v[60:63], a[156:159], v[140:143], v[60:63]
  v_mfma_f32_16x16x32_bf16 v[76:79], a[160:163], v[140:143], v[76:79]
  v_mfma_f32_16x16x32_bf16 v[92:95], a[164:167], v[140:143], v[92:95]
  buffer_load_dwordx4 v[28:31], v160, s[4:7], s26 offen offset:3072 sc1
  s_add_u32 s26, s26, 0x1000
  s_waitcnt vmcnt(23) lgkmcnt(0)
  v_mfma_f32_16x16x32_bf16 v[48:51], a[168:171], v[112:115], v[48:51]
  ds_read_b128 v[128:131], v181 offset:24576
  v_mfma_f32_16x16x32_bf16 v[64:67], a[172:175], v[112:115], v[64:67]
  ds_read_b128 v[132:135], v181 offset:25600
  v_mfma_f32_16x16x32_bf16 v[80:83], a[176:179], v[112:115], v[80:83]
  buffer_load_dwordx4 v[32:35], v160, s[4:7], s26 offen sc1
  v_mfma_f32_16x16x32_bf16 v[52:55], a[168:171], v[116:119], v[52:55]
  ds_read_b128 v[136:139], v181 offset:26624
  v_mfma_f32_16x16x32_bf16 v[68:71], a[172:175], v[116:119], v[68:71]
  ds_read_b128 v[140:143], v181 offset:27648
  v_mfma_f32_16x16x32_bf16 v[84:87], a[176:179], v[116:119], v[84:87]
  buffer_load_dwordx4 v[36:39], v160, s[4:7], s26 offen offset:1024 sc1
  v_mfma_f32_16x16x32_bf16 v[56:59], a[168:171], v[120:123], v[56:59]
  v_mfma_f32_16x16x32_bf16 v[72:75], a[172:175], v[120:123], v[72:75]
  v_mfma_f32_16x16x32_bf16 v[88:91], a[176:179], v[120:123], v[88:91]
  buffer_load_dwordx4 v[40:43], v160, s[4:7], s26 offen offset:2048 sc1
  v_mfma_f32_16x16x32_bf16 v[60:63], a[168:171], v[124:127], v[60:63]
  v_mfma_f32_16x16x32_bf16 v[76:79], a[172:175], v[124:127], v[76:79]
  v_mfma_f32_16x16x32_bf16 v[92:95], a[176:179], v[124:127], v[92:95]
  buffer_load_dwordx4 v[44:47], v160, s[4:7], s26 offen offset:3072 sc1
  s_add_u32 s26, s26, 0x1000
  s_add_u32 s76, s74, 0
  s_lshl_b32 s78, s76, 11
  buffer_store_dwordx4 v[216:219], v1, s[68:71], s78 offen sc1
  buffer_store_dwordx4 v[220:223], v1, s[68:71], s78 offen offset:1024 sc1
  s_waitcnt vmcnt(26) lgkmcnt(0)
  v_mfma_f32_16x16x32_bf16 v[48:51], a[180:183], v[128:131], v[48:51]
  ds_read_b128 v[112:115], v180 offset:28672
  v_mfma_f32_16x16x32_bf16 v[64:67], a[184:187], v[128:131], v[64:67]
  ds_read_b128 v[116:119], v180 offset:29696
  v_mfma_f32_16x16x32_bf16 v[80:83], a[188:191], v[128:131], v[80:83]
  v_mfma_f32_16x16x32_bf16 v[52:55], a[180:183], v[132:135], v[52:55]
  ds_read_b128 v[120:123], v180 offset:30720
  v_mfma_f32_16x16x32_bf16 v[68:71], a[184:187], v[132:135], v[68:71]
  ds_read_b128 v[124:127], v180 offset:31744
  v_mfma_f32_16x16x32_bf16 v[84:87], a[188:191], v[132:135], v[84:87]
  v_mfma_f32_16x16x32_bf16 v[56:59], a[180:183], v[136:139], v[56:59]
  v_mfma_f32_16x16x32_bf16 v[72:75], a[184:187], v[136:139], v[72:75]
  v_mfma_f32_16x16x32_bf16 v[88:91], a[188:191], v[136:139], v[88:91]
  v_mfma_f32_16x16x32_bf16 v[60:63], a[180:183], v[140:143], v[60:63]
  v_mfma_f32_16x16x32_bf16 v[76:79], a[184:187], v[140:143], v[76:79]
  v_mfma_f32_16x16x32_bf16 v[92:95], a[188:191], v[140:143], v[92:95]
  s_add_u32 s76, s74, 32
  s_lshl_b32 s78, s76, 11
  buffer_store_dwordx4 v[224:227], v1, s[68:71], s78 offen sc1
  buffer_store_dwordx4 v[228:231], v1, s[68:71], s78 offen offset:1024 sc1
  s_waitcnt vmcnt(25) lgkmcnt(0)
  v_mfma_f32_16x16x32_bf16 v[48:51], a[192:195], v[112:115], v[48:51]
  ds_read_b128 v[128:131], v181 offset:32768
  v_mfma_f32_16x16x32_bf16 v[64:67], a[196:199], v[112:115], v[64:67]
  ds_read_b128 v[132:135], v181 offset:33792
  v_mfma_f32_16x16x32_bf16 v[80:83], a[200:203], v[112:115], v[80:83]
  v_mfma_f32_16x16x32_bf16 v[52:55], a[192:195], v[116:119], v[52:55]
  ds_read_b128 v[136:139], v181 offset:34816
  v_mfma_f32_16x16x32_bf16 v[68:71], a[196:199], v[116:119], v[68:71]
  ds_read_b128 v[140:143], v181 offset:35840
  v_mfma_f32_16x16x32_bf16 v[84:87], a[200:203], v[116:119], v[84:87]
  v_mfma_f32_16x16x32_bf16 v[56:59], a[192:195], v[120:123], v[56:59]
  v_mfma_f32_16x16x32_bf16 v[72:75], a[196:199], v[120:123], v[72:75]
  v_mfma_f32_16x16x32_bf16 v[88:91], a[200:203], v[120:123], v[88:91]
  v_mfma_f32_16x16x32_bf16 v[60:63], a[192:195], v[124:127], v[60:63]
  v_mfma_f32_16x16x32_bf16 v[76:79], a[196:199], v[124:127], v[76:79]
  v_mfma_f32_16x16x32_bf16 v[92:95], a[200:203], v[124:127], v[92:95]
  s_add_u32 s76, s74, 64
  s_lshl_b32 s78, s76, 11
  buffer_store_dwordx4 v[232:235], v1, s[68:71], s78 offen sc1
  buffer_store_dwordx4 v[236:239], v1, s[68:71], s78 offen offset:1024 sc1
  s_waitcnt vmcnt(6) lgkmcnt(0)
  v_mfma_f32_16x16x32_bf16 v[48:51], a[204:207], v[128:131], v[48:51]
  ds_read_b128 v[112:115], v178 offset:0
  v_mfma_f32_16x16x32_bf16 v[64:67], a[208:211], v[128:131], v[64:67]
  ds_read_b128 v[116:119], v178 offset:1024
  v_mfma_f32_16x16x32_bf16 v[80:83], a[212:215], v[128:131], v[80:83]
  v_mfma_f32_16x16x32_bf16 v[52:55], a[204:207], v[132:135], v[52:55]
  ds_read_b128 v[120:123], v178 offset:2048
  v_mfma_f32_16x16x32_bf16 v[68:71], a[208:211], v[132:135], v[68:71]
  ds_read_b128 v[124:127], v178 offset:3072
  v_mfma_f32_16x16x32_bf16 v[84:87], a[212:215], v[132:135], v[84:87]
  v_mfma_f32_16x16x32_bf16 v[56:59], a[204:207], v[136:139], v[56:59]
  v_mfma_f32_16x16x32_bf16 v[72:75], a[208:211], v[136:139], v[72:75]
  v_mfma_f32_16x16x32_bf16 v[88:91], a[212:215], v[136:139], v[88:91]
  v_mfma_f32_16x16x32_bf16 v[60:63], a[204:207], v[140:143], v[60:63]
  v_mfma_f32_16x16x32_bf16 v[76:79], a[208:211], v[140:143], v[76:79]
  v_mfma_f32_16x16x32_bf16 v[92:95], a[212:215], v[140:143], v[92:95]
  s_add_u32 s76, s74, 96
  s_lshl_b32 s78, s76, 11
  buffer_store_dwordx4 v[240:243], v1, s[68:71], s78 offen sc1
  buffer_store_dwordx4 v[244:247], v1, s[68:71], s78 offen offset:1024 sc1
  s_branch q_epi
layer1:
  s_and_b32 s45, s2, 7
  s_lshr_b32 s46, s2, 3
  s_and_b32 s22, s45, 1
  s_lshl_b32 s22, s22, 2
  s_and_b32 s47, s46, 3
  s_add_u32 s22, s22, s47
  s_lshr_b32 s44, s46, 2
  s_lshr_b32 s21, s45, 1
  s_lshl_b32 s21, s21, 3
  s_add_u32 s21, s21, s44
  v_lshrrev_b32 v161, 4, v0
  v_and_b32 v162, 15, v0
  v_and_b32 v163, 1, v161
  v_lshrrev_b32 v164, 1, v161
  s_lshl_b32 s38, s20, 10
  v_add_u32 v8, s38, v1
  v_add_u32 v7, 36864, v1
  v_lshlrev_b32 v165, 4, v162
  v_lshl_add_u32 v166, v164, 9, v165
  v_lshl_add_u32 v3, v163, 11, v166
  s_lshl_b32 s40, s20, 12
  s_add_u32 s40, s40, 8192
  s_add_u32 s41, s40, 0x400
  s_mul_i32 s39, s20, 4608
  s_add_u32 s39, s39, 73728
  v_mul_u32_u24 v166, 72, v162
  v_lshl_add_u32 v166, v161, 3, v166
  v_add_u32 v172, s39, v166
  v_bfe_u32 v166, v0, 2, 2
  v_lshl_add_u32 v166, v163, 2, v166
  v_lshl_add_u32 v166, v164, 4, v166
  v_mul_u32_u24 v166, 72, v166
  v_and_b32 v173, 3, v0
  v_lshl_add_u32 v166, v173, 3, v166
  v_add_u32 v173, s39, v166
  v_lshlrev_b32 v166, 4, v162
  v_lshl_add_u32 v166, v163, 8, v166
  v_lshl_add_u32 v166, v164, 9, v166
  s_cmp_eq_u32 s20, 3
  s_cselect_b32 s39, 4, s20
  s_lshl_b32 s39, s39, 11
  s_add_u32 s39, s39, 16384
  v_add_u32 v174, s39, v166
  v_lshlrev_b32 v166, 9, v163
  v_lshl_add_u32 v166, v162, 3, v166
  v_add_u32 v166, 27648, v166
  v_mov_b32 v163, 0x80000000
  v_cmp_gt_u32 vcc, 32, v0
  v_mov_b32 v164, 0x3eae1a93
  s_nop 0
  v_cndmask_b32 v6, 1.0, v164, vcc
  v_cndmask_b32 v5, v166, v163, vcc
  s_cmp_ge_u32 s20, 2
  s_cselect_b64 vcc, -1, 0
  v_cndmask_b32 v160, v1, v163, vcc
  s_lshl_b32 s38, s22, 2
  s_add_u32 s38, s38, s20
  s_mul_i32 s38, s38, 73728
  s_add_u32 s38, s38, 0x06000000
  s_add_u32 s4, s96, s38
  s_addc_u32 s5, s97, 0
  s_mov_b32 s6, 0x00012000
  s_mov_b32 s7, 0x00020000
  s_lshl_b32 s38, s21, 3
  s_add_u32 s38, s38, s22
  s_mul_i32 s38, s38, 28672
  s_add_u32 s38, s38, s3
  s_add_u32 s16, s96, s38
  s_addc_u32 s17, s97, 0
  s_mov_b32 s18, 0x00007000
  s_mov_b32 s19, 0x00020000
  s_mov_b32 s26, 0
  s_mov_b32 s29, 0x3f803f80
  s_mov_b32 s28, 0x3eae1a93
  s_lshl_b32 s38, s20, 8
  v_lshlrev_b32 v2, 10, v161
  v_lshl_add_u32 v2, v162, 4, v2
  v_add_u32 v2, s38, v2
  s_mul_i32 s38, s21, 73728
  s_add_u32 s38, s38, 0x02400000
  s_add_u32 s8, s96, s38
  s_addc_u32 s9, s97, 0
  s_mov_b32 s10, 0x00012000
  s_mov_b32 s11, 0x00020000
  s_mov_b32 s27, 0
  s_lshl_b32 s38, s20, 10
  s_mov_b32 s26, 28672
  buffer_load_dwordx4 a[112:115], v1, s[4:7], s26 offen sc1
  buffer_load_dwordx4 a[116:119], v1, s[4:7], s26 offen offset:1024 sc1
  buffer_load_dwordx4 a[120:123], v1, s[4:7], s26 offen offset:2048 sc1
  buffer_load_dwordx4 a[124:127], v1, s[4:7], s26 offen offset:3072 sc1
  s_add_u32 s26, s26, 0x1000
  buffer_load_dwordx4 a[128:131], v1, s[4:7], s26 offen sc1
  buffer_load_dwordx4 a[132:135], v1, s[4:7], s26 offen offset:1024 sc1
  buffer_load_dwordx4 a[136:139], v1, s[4:7], s26 offen offset:2048 sc1
  buffer_load_dwordx4 a[140:143], v1, s[4:7], s26 offen offset:3072 sc1
  s_add_u32 s26, s26, 0x1000
  buffer_load_dwordx4 a[144:147], v1, s[4:7], s26 offen sc1
  buffer_load_dwordx4 a[148:151], v1, s[4:7], s26 offen offset:1024 sc1
  buffer_load_dwordx4 a[152:155], v1, s[4:7], s26 offen offset:2048 sc1
  buffer_load_dwordx4 a[156:159], v1, s[4:7], s26 offen offset:3072 sc1
  s_add_u32 s26, s26, 0x1000
  s_cmp_lg_u32 s20, 3
  s_cbranch_scc1 wt3_d
  v_and_b32 v9, 7, v0
  s_lshl_b32 s23, s21, 3
  v_add_u32 v9, s23, v9
  v_lshlrev_b32 v9, 6, v9
  s_add_u32 s23, s14, 0x00000000
  v_add_u32 v9, s23, v9
  s_mov_b32 s23, 0x10000
wt3_l:
  buffer_load_dwordx2 v[10:11], v9, s[92:95], 0 offen sc1
  s_waitcnt vmcnt(0)
  v_cmp_ne_u64 vcc, s[90:91], v[10:11]
  s_sub_u32 s23, s23, 1
  s_cselect_b64 s[24:25], 0, -1
  s_nop 1
  s_and_b64 vcc, vcc, s[24:25]
  s_cbranch_vccnz wt3_l
wt3_d:
  s_barrier
  s_add_u32 m0, s38, 0
  s_nop 0
  buffer_load_dwordx4 v2, s[8:11], s27 offen sc1 lds
  s_add_u32 m0, s38, 4096
  s_add_u32 s27, s27, 0x1000
  buffer_load_dwordx4 v2, s[8:11], s27 offen sc1 lds
  s_add_u32 m0, s38, 8192
  s_add_u32 s27, s27, 0x1000
  buffer_load_dwordx4 v2, s[8:11], s27 offen sc1 lds
  s_add_u32 m0, s38, 12288
  s_add_u32 s27, s27, 0x1000
  buffer_load_dwordx4 v2, s[8:11], s27 offen sc1 lds
  s_add_u32 m0, s38, 16384
  s_add_u32 s27, s27, 0x1000
  buffer_load_dwordx4 v2, s[8:11], s27 offen sc1 lds
  s_add_u32 m0, s38, 20480
  s_add_u32 s27, s27, 0x1000
  buffer_load_dwordx4 v2, s[8:11], s27 offen sc1 lds
  s_add_u32 m0, s38, 24576
  s_add_u32 s27, s27, 0x1000
  buffer_load_dwordx4 v2, s[8:11], s27 offen sc1 lds
  s_add_u32 m0, s38, 28672
  s_add_u32 s27, s27, 0x1000
  buffer_load_dwordx4 v2, s[8:11], s27 offen sc1 lds
  s_add_u32 m0, s38, 32768
  s_add_u32 s27, s27, 0x1000
  buffer_load_dwordx4 v2, s[8:11], s27 offen sc1 lds
  s_add_u32 m0, s38, 36864
  s_add_u32 s27, s27, 0x1000
  buffer_load_dwordx4 v2, s[8:11], s27 offen sc1 lds
  s_add_u32 m0, s38, 40960
  s_add_u32 s27, s27, 0x1000
  buffer_load_dwordx4 v2, s[8:11], s27 offen sc1 lds
  s_add_u32 m0, s38, 45056
  s_add_u32 s27, s27, 0x1000
  buffer_load_dwordx4 v2, s[8:11], s27 offen sc1 lds
  s_add_u32 m0, s38, 49152
  s_add_u32 s27, s27, 0x1000
  buffer_load_dwordx4 v2, s[8:11], s27 offen sc1 lds
  s_add_u32 m0, s38, 53248
  s_add_u32 s27, s27, 0x1000
  buffer_load_dwordx4 v2, s[8:11], s27 offen sc1 lds
  s_add_u32 m0, s38, 57344
  s_add_u32 s27, s27, 0x1000
  buffer_load_dwordx4 v2, s[8:11], s27 offen sc1 lds
  s_add_u32 m0, s38, 61440
  s_add_u32 s27, s27, 0x1000
  buffer_load_dwordx4 v2, s[8:11], s27 offen sc1 lds
  s_add_u32 m0, s38, 65536
  s_add_u32 s27, s27, 0x1000
  buffer_load_dwordx4 v2, s[8:11], s27 offen sc1 lds
  s_add_u32 m0, s38, 69632
  s_add_u32 s27, s27, 0x1000
  buffer_load_dwordx4 v2, s[8:11], s27 offen sc1 lds
  s_waitcnt vmcnt(12)
  s_barrier
  ds_read_b128 v[112:115], v1 offset:0
  ds_read_b128 v[116:119], v1 offset:1024
  ds_read_b128 v[120:123], v1 offset:2048
  ds_read_b128 v[124:127], v1 offset:3072
  s_waitcnt lgkmcnt(0)
  v_mfma_f32_16x16x32_bf16 v[48:51], a[0:3], v[112:115], 0
  ds_read_b128 v[128:131], v1 offset:4096
  v_mfma_f32_16x16x32_bf16 v[64:67], a[4:7], v[112:115], 0
  ds_read_b128 v[132:135], v1 offset:5120
  v_mfma_f32_16x16x32_bf16 v[80:83], a[8:11], v[112:115], 0
  buffer_load_dwordx4 a[160:163], v1, s[4:7], s26 offen sc1
  v_mfma_f32_16x16x32_bf16 v[52:55], a[0:3], v[116:119], 0
  ds_read_b128 v[136:139], v1 offset:6144
  v_mfma_f32_16x16x32_bf16 v[68:71], a[4:7], v[116:119], 0
  ds_read_b128 v[140:143], v1 offset:7168
  v_mfma_f32_16x16x32_bf16 v[84:87], a[8:11], v[116:119], 0
  buffer_load_dwordx4 a[164:167], v1, s[4:7], s26 offen offset:1024 sc1
  v_mfma_f32_16x16x32_bf16 v[56:59], a[0:3], v[120:123], 0
  v_mfma_f32_16x16x32_bf16 v[72:75], a[4:7], v[120:123], 0
  v_mfma_f32_16x16x32_bf16 v[88:91], a[8:11], v[120:123], 0
  buffer_load_dwordx4 a[168:171], v1, s[4:7], s26 offen offset:2048 sc1
  v_mfma_f32_16x16x32_bf16 v[60:63], a[0:3], v[124:127], 0
  v_mfma_f32_16x16x32_bf16 v[76:79], a[4:7], v[124:127], 0
  v_mfma_f32_16x16x32_bf16 v[92:95], a[8:11], v[124:127], 0
  buffer_load_dwordx4 a[172:175], v1, s[4:7], s26 offen offset:3072 sc1
  s_add_u32 s26, s26, 0x1000
  s_waitcnt lgkmcnt(0)
  v_mfma_f32_16x16x32_bf16 v[48:51], a[12:15], v[128:131], v[48:51]
  ds_read_b128 v[112:115], v1 offset:8192
  v_mfma_f32_16x16x32_bf16 v[64:67], a[16:19], v[128:131], v[64:67]
  ds_read_b128 v[116:119], v1 offset:9216
  v_mfma_f32_16x16x32_bf16 v[80:83], a[20:23], v[128:131], v[80:83]
  buffer_load_dwordx4 a[176:179], v1, s[4:7], s26 offen sc1
  v_mfma_f32_16x16x32_bf16 v[52:55], a[12:15], v[132:135], v[52:55]
  ds_read_b128 v[120:123], v1 offset:10240
  v_mfma_f32_16x16x32_bf16 v[68:71], a[16:19], v[132:135], v[68:71]
  ds_read_b128 v[124:127], v1 offset:11264
  v_mfma_f32_16x16x32_bf16 v[84:87], a[20:23], v[132:135], v[84:87]
  buffer_load_dwordx4 a[180:183], v1, s[4:7], s26 offen offset:1024 sc1
  v_mfma_f32_16x16x32_bf16 v[56:59], a[12:15], v[136:139], v[56:59]
  v_mfma_f32_16x16x32_bf16 v[72:75], a[16:19], v[136:139], v[72:75]
  v_mfma_f32_16x16x32_bf16 v[88:91], a[20:23], v[136:139], v[88:91]
  buffer_load_dwordx4 a[184:187], v1, s[4:7], s26 offen offset:2048 sc1
  v_mfma_f32_16x16x32_bf16 v[60:63], a[12:15], v[140:143], v[60:63]
  v_mfma_f32_16x16x32_bf16 v[76:79], a[16:19], v[140:143], v[76:79]
  v_mfma_f32_16x16x32_bf16 v[92:95], a[20:23], v[140:143], v[92:95]
  buffer_load_dwordx4 a[188:191], v1, s[4:7], s26 offen offset:3072 sc1
  s_add_u32 s26, s26, 0x1000
  s_waitcnt lgkmcnt(0)
  v_mfma_f32_16x16x32_bf16 v[48:51], a[24:27], v[112:115], v[48:51]
  ds_read_b128 v[128:131], v1 offset:12288
  v_mfma_f32_16x16x32_bf16 v[64:67], a[28:31], v[112:115], v[64:67]
  ds_read_b128 v[132:135], v1 offset:13312
  v_mfma_f32_16x16x32_bf16 v[80:83], a[32:35], v[112:115], v[80:83]
  buffer_load_dwordx4 a[192:195], v1, s[4:7], s26 offen sc1
  v_mfma_f32_16x16x32_bf16 v[52:55], a[24:27], v[116:119], v[52:55]
  ds_read_b128 v[136:139], v1 offset:14336
  v_mfma_f32_16x16x32_bf16 v[68:71], a[28:31], v[116:119], v[68:71]
  ds_read_b128 v[140:143], v1 offset:15360
  v_mfma_f32_16x16x32_bf16 v[84:87], a[32:35], v[116:119], v[84:87]
  buffer_load_dwordx4 a[196:199], v1, s[4:7], s26 offen offset:1024 sc1
  v_mfma_f32_16x16x32_bf16 v[56:59], a[24:27], v[120:123], v[56:59]
  v_mfma_f32_16x16x32_bf16 v[72:75], a[28:31], v[120:123], v[72:75]
  v_mfma_f32_16x16x32_bf16 v[88:91], a[32:35], v[120:123], v[88:91]
  buffer_load_dwordx4 a[200:203], v1, s[4:7], s26 offen offset:2048 sc1
  v_mfma_f32_16x16x32_bf16 v[60:63], a[24:27], v[124:127], v[60:63]
  v_mfma_f32_16x16x32_bf16 v[76:79], a[28:31], v[124:127], v[76:79]
  v_mfma_f32_16x16x32_bf16 v[92:95], a[32:35], v[124:127], v[92:95]
  buffer_load_dwordx4 a[204:207], v1, s[4:7], s26 offen offset:3072 sc1
  s_add_u32 s26, s26, 0x1000
  s_waitcnt lgkmcnt(0)
  v_mfma_f32_16x16x32_bf16 v[48:51], a[36:39], v[128:131], v[48:51]
  ds_read_b128 v[112:115], v1 offset:16384
  v_mfma_f32_16x16x32_bf16 v[64:67], a[40:43], v[128:131], v[64:67]
  ds_read_b128 v[116:119], v1 offset:17408
  v_mfma_f32_16x16x32_bf16 v[80:83], a[44:47], v[128:131], v[80:83]
  buffer_load_dwordx4 a[208:211], v1, s[4:7], s26 offen sc1
  v_mfma_f32_16x16x32_bf16 v[52:55], a[36:39], v[132:135], v[52:55]
  ds_read_b128 v[120:123], v1 offset:18432
  v_mfma_f32_16x16x32_bf16 v[68:71], a[40:43], v[132:135], v[68:71]
  ds_read_b128 v[124:127], v1 offset:19456
  v_mfma_f32_16x16x32_bf16 v[84:87], a[44:47], v[132:135], v[84:87]
  buffer_load_dwordx4 a[212:215], v1, s[4:7], s26 offen offset:1024 sc1
  v_mfma_f32_16x16x32_bf16 v[56:59], a[36:39], v[136:139], v[56:59]
  v_mfma_f32_16x16x32_bf16 v[72:75], a[40:43], v[136:139], v[72:75]
  v_mfma_f32_16x16x32_bf16 v[88:91], a[44:47], v[136:139], v[88:91]
  buffer_load_dwordx4 a[216:219], v160, s[4:7], s26 offen offset:2048 sc1
  v_mfma_f32_16x16x32_bf16 v[60:63], a[36:39], v[140:143], v[60:63]
  v_mfma_f32_16x16x32_bf16 v[76:79], a[40:43], v[140:143], v[76:79]
  v_mfma_f32_16x16x32_bf16 v[92:95], a[44:47], v[140:143], v[92:95]
  buffer_load_dwordx4 a[220:223], v160, s[4:7], s26 offen offset:3072 sc1
  s_add_u32 s26, s26, 0x1000
  s_waitcnt lgkmcnt(0)
  v_mfma_f32_16x16x32_bf16 v[48:51], a[48:51], v[112:115], v[48:51]
  ds_read_b128 v[128:131], v1 offset:20480
  v_mfma_f32_16x16x32_bf16 v[64:67], a[52:55], v[112:115], v[64:67]
  ds_read_b128 v[132:135], v1 offset:21504
  v_mfma_f32_16x16x32_bf16 v[80:83], a[56:59], v[112:115], v[80:83]
  buffer_load_dwordx4 a[224:227], v160, s[4:7], s26 offen sc1
  v_mfma_f32_16x16x32_bf16 v[52:55], a[48:51], v[116:119], v[52:55]
  ds_read_b128 v[136:139], v1 offset:22528
  v_mfma_f32_16x16x32_bf16 v[68:71], a[52:55], v[116:119], v[68:71]
  ds_read_b128 v[140:143], v1 offset:23552
  v_mfma_f32_16x16x32_bf16 v[84:87], a[56:59], v[116:119], v[84:87]
  buffer_load_dwordx4 a[228:231], v160, s[4:7], s26 offen offset:1024 sc1
  v_mfma_f32_16x16x32_bf16 v[56:59], a[48:51], v[120:123], v[56:59]
  v_mfma_f32_16x16x32_bf16 v[72:75], a[52:55], v[120:123], v[72:75]
  v_mfma_f32_16x16x32_bf16 v[88:91], a[56:59], v[120:123], v[88:91]
  buffer_load_dwordx4 a[232:235], v160, s[4:7], s26 offen offset:2048 sc1
  v_mfma_f32_16x16x32_bf16 v[60:63], a[48:51], v[124:127], v[60:63]
  v_mfma_f32_16x16x32_bf16 v[76:79], a[52:55], v[124:127], v[76:79]
  v_mfma_f32_16x16x32_bf16 v[92:95], a[56:59], v[124:127], v[92:95]
  buffer_load_dwordx4 a[236:239], v160, s[4:7], s26 offen offset:3072 sc1
  s_add_u32 s26, s26, 0x1000
  s_waitcnt vmcnt(26) lgkmcnt(0)
  s_barrier
  v_mfma_f32_16x16x32_bf16 v[48:51], a[60:63], v[128:131], v[48:51]
  ds_read_b128 v[112:115], v1 offset:24576
  v_mfma_f32_16x16x32_bf16 v[64:67], a[64:67], v[128:131], v[64:67]
  ds_read_b128 v[116:119], v1 offset:25600
  v_mfma_f32_16x16x32_bf16 v[80:83], a[68:71], v[128:131], v[80:83]
  buffer_load_dwordx4 a[240:243], v160, s[4:7], s26 offen sc1
  v_mfma_f32_16x16x32_bf16 v[52:55], a[60:63], v[132:135], v[52:55]
  ds_read_b128 v[120:123], v1 offset:26624
  v_mfma_f32_16x16x32_bf16 v[68:71], a[64:67], v[132:135], v[68:71]
  ds_read_b128 v[124:127], v1 offset:27648
  v_mfma_f32_16x16x32_bf16 v[84:87], a[68:71], v[132:135], v[84:87]
  buffer_load_dwordx4 a[244:247], v160, s[4:7], s26 offen offset:1024 sc1
  v_mfma_f32_16x16x32_bf16 v[56:59], a[60:63], v[136:139], v[56:59]
  v_mfma_f32_16x16x32_bf16 v[72:75], a[64:67], v[136:139], v[72:75]
  v_mfma_f32_16x16x32_bf16 v[88:91], a[68:71], v[136:139], v[88:91]
  buffer_load_dwordx4 a[248:251], v160, s[4:7], s26 offen offset:2048 sc1
  v_mfma_f32_16x16x32_bf16 v[60:63], a[60:63], v[140:143], v[60:63]
  v_mfma_f32_16x16x32_bf16 v[76:79], a[64:67], v[140:143], v[76:79]
  v_mfma_f32_16x16x32_bf16 v[92:95], a[68:71], v[140:143], v[92:95]
  buffer_load_dwordx4 a[252:255], v160, s[4:7], s26 offen offset:3072 sc1
  s_add_u32 s26, s26, 0x1000
  s_waitcnt lgkmcnt(0)
  v_mfma_f32_16x16x32_bf16 v[48:51], a[72:75], v[112:115], v[48:51]
  ds_read_b128 v[128:131], v1 offset:28672
  v_mfma_f32_16x16x32_bf16 v[64:67], a[76:79], v[112:115], v[64:67]
  ds_read_b128 v[132:135], v1 offset:29696
  v_mfma_f32_16x16x32_bf16 v[80:83], a[80:83], v[112:115], v[80:83]
  buffer_load_dwordx4 v[16:19], v160, s[4:7], s26 offen sc1
  v_mfma_f32_16x16x32_bf16 v[52:55], a[72:75], v[116:119], v[52:55]
  ds_read_b128 v[136:139], v1 offset:30720
  v_mfma_f32_16x16x32_bf16 v[68:71], a[76:79], v[116:119], v[68:71]
  ds_read_b128 v[140:143], v1 offset:31744
  v_mfma_f32_16x16x32_bf16 v[84:87], a[80:83], v[116:119], v[84:87]
  buffer_load_dwordx4 v[20:23], v160, s[4:7], s26 offen offset:1024 sc1
  v_mfma_f32_16x16x32_bf16 v[56:59], a[72:75], v[120:123], v[56:59]
  v_mfma_f32_16x16x32_bf16 v[72:75], a[76:79], v[120:123], v[72:75]
  v_mfma_f32_16x16x32_bf16 v[88:91], a[80:83], v[120:123], v[88:91]
  buffer_load_dwordx4 v[24:27], v160, s[4:7], s26 offen offset:2048 sc1
  v_mfma_f32_16x16x32_bf16 v[60:63], a[72:75], v[124:127], v[60:63]
  v_mfma_f32_16x16x32_bf16 v[76:79], a[76:79], v[124:127], v[76:79]
  v_mfma_f32_16x16x32_bf16 v[92:95], a[80:83], v[124:127], v[92:95]
  buffer_load_dwordx4 v[28:31], v160, s[4:7], s26 offen offset:3072 sc1
  s_add_u32 s26, s26, 0x1000
  s_waitcnt lgkmcnt(0)
  v_mfma_f32_16x16x32_bf16 v[48:51], a[84:87], v[128:131], v[48:51]
  ds_read_b128 v[112:115], v1 offset:32768
  v_mfma_f32_16x16x32_bf16 v[64:67], a[88:91], v[128:131], v[64:67]
  ds_read_b128 v[116:119], v1 offset:33792
  v_mfma_f32_16x16x32_bf16 v[80:83], a[92:95], v[128:131], v[80:83]
  buffer_load_dwordx4 v[32:35], v160, s[4:7], s26 offen sc1
  v_mfma_f32_16x16x32_bf16 v[52:55], a[84:87], v[132:135], v[52:55]
  ds_read_b128 v[120:123], v1 offset:34816
  v_mfma_f32_16x16x32_bf16 v[68:71], a[88:91], v[132:135], v[68:71]
  ds_read_b128 v[124:127], v1 offset:35840
  v_mfma_f32_16x16x32_bf16 v[84:87], a[92:95], v[132:135], v[84:87]
  buffer_load_dwordx4 v[36:39], v160, s[4:7], s26 offen offset:1024 sc1
  v_mfma_f32_16x16x32_bf16 v[56:59], a[84:87], v[136:139], v[56:59]
  v_mfma_f32_16x16x32_bf16 v[72:75], a[88:91], v[136:139], v[72:75]
  v_mfma_f32_16x16x32_bf16 v[88:91], a[92:95], v[136:139], v[88:91]
  buffer_load_dwordx4 v[40:43], v160, s[4:7], s26 offen offset:2048 sc1
  v_mfma_f32_16x16x32_bf16 v[60:63], a[84:87], v[140:143], v[60:63]
  v_mfma_f32_16x16x32_bf16 v[76:79], a[88:91], v[140:143], v[76:79]
  v_mfma_f32_16x16x32_bf16 v[92:95], a[92:95], v[140:143], v[92:95]
  buffer_load_dwordx4 v[44:47], v160, s[4:7], s26 offen offset:3072 sc1
  s_add_u32 s26, s26, 0x1000
  s_waitcnt lgkmcnt(0)
  v_mfma_f32_16x16x32_bf16 v[48:51], a[96:99], v[112:115], v[48:51]
  ds_read_b128 v[128:131], v7 offset:0
  v_mfma_f32_16x16x32_bf16 v[64:67], a[100:103], v[112:115], v[64:67]
  ds_read_b128 v[132:135], v7 offset:1024
  v_mfma_f32_16x16x32_bf16 v[80:83], a[104:107], v[112:115], v[80:83]
  v_mfma_f32_16x16x32_bf16 v[52:55], a[96:99], v[116:119], v[52:55]
  ds_read_b128 v[136:139], v7 offset:2048
  v_mfma_f32_16x16x32_bf16 v[68:71], a[100:103], v[116:119], v[68:71]
  ds_read_b128 v[140:143], v7 offset:3072
  v_mfma_f32_16x16x32_bf16 v[84:87], a[104:107], v[116:119], v[84:87]
  v_mfma_f32_16x16x32_bf16 v[56:59], a[96:99], v[120:123], v[56:59]
  v_mfma_f32_16x16x32_bf16 v[72:75], a[100:103], v[120:123], v[72:75]
  v_mfma_f32_16x16x32_bf16 v[88:91], a[104:107], v[120:123], v[88:91]
  v_mfma_f32_16x16x32_bf16 v[60:63], a[96:99], v[124:127], v[60:63]
  v_mfma_f32_16x16x32_bf16 v[76:79], a[100:103], v[124:127], v[76:79]
  v_mfma_f32_16x16x32_bf16 v[92:95], a[104:107], v[124:127], v[92:95]
  s_waitcnt lgkmcnt(0)
  v_mfma_f32_16x16x32_bf16 v[48:51], a[108:111], v[128:131], v[48:51]
  ds_read_b128 v[112:115], v7 offset:4096
  v_mfma_f32_16x16x32_bf16 v[64:67], a[112:115], v[128:131], v[64:67]
  ds_read_b128 v[116:119], v7 offset:5120
  v_mfma_f32_16x16x32_bf16 v[80:83], a[116:119], v[128:131], v[80:83]
  v_mfma_f32_16x16x32_bf16 v[52:55], a[108:111], v[132:135], v[52:55]
  ds_read_b128 v[120:123], v7 offset:6144
  v_mfma_f32_16x16x32_bf16 v[68:71], a[112:115], v[132:135], v[68:71]
  ds_read_b128 v[124:127], v7 offset:7168
  v_mfma_f32_16x16x32_bf16 v[84:87], a[116:119], v[132:135], v[84:87]
  v_mfma_f32_16x16x32_bf16 v[56:59], a[108:111], v[136:139], v[56:59]
  v_mfma_f32_16x16x32_bf16 v[72:75], a[112:115], v[136:139], v[72:75]
  v_mfma_f32_16x16x32_bf16 v[88:91], a[116:119], v[136:139], v[88:91]
  v_mfma_f32_16x16x32_bf16 v[60:63], a[108:111], v[140:143], v[60:63]
  v_mfma_f32_16x16x32_bf16 v[76:79], a[112:115], v[140:143], v[76:79]
  v_mfma_f32_16x16x32_bf16 v[92:95], a[116:119], v[140:143], v[92:95]
  s_waitcnt lgkmcnt(0)
  v_mfma_f32_16x16x32_bf16 v[48:51], a[120:123], v[112:115], v[48:51]
  ds_read_b128 v[128:131], v7 offset:8192
  v_mfma_f32_16x16x32_bf16 v[64:67], a[124:127], v[112:115], v[64:67]
  ds_read_b128 v[132:135], v7 offset:9216
  v_mfma_f32_16x16x32_bf16 v[80:83], a[128:131], v[112:115], v[80:83]
  v_mfma_f32_16x16x32_bf16 v[52:55], a[120:123], v[116:119], v[52:55]
  ds_read_b128 v[136:139], v7 offset:10240
  v_mfma_f32_16x16x32_bf16 v[68:71], a[124:127], v[116:119], v[68:71]
  ds_read_b128 v[140:143], v7 offset:11264
  v_mfma_f32_16x16x32_bf16 v[84:87], a[128:131], v[116:119], v[84:87]
  v_mfma_f32_16x16x32_bf16 v[56:59], a[120:123], v[120:123], v[56:59]
  v_mfma_f32_16x16x32_bf16 v[72:75], a[124:127], v[120:123], v[72:75]
  v_mfma_f32_16x16x32_bf16 v[88:91], a[128:131], v[120:123], v[88:91]
  v_mfma_f32_16x16x32_bf16 v[60:63], a[120:123], v[124:127], v[60:63]
  v_mfma_f32_16x16x32_bf16 v[76:79], a[124:127], v[124:127], v[76:79]
  v_mfma_f32_16x16x32_bf16 v[92:95], a[128:131], v[124:127], v[92:95]
  s_waitcnt vmcnt(32) lgkmcnt(0)
  s_barrier
  v_mfma_f32_16x16x32_bf16 v[48:51], a[132:135], v[128:131], v[48:51]
  ds_read_b128 v[112:115], v7 offset:12288
  v_mfma_f32_16x16x32_bf16 v[64:67], a[136:139], v[128:131], v[64:67]
  ds_read_b128 v[116:119], v7 offset:13312
  v_mfma_f32_16x16x32_bf16 v[80:83], a[140:143], v[128:131], v[80:83]
  v_mfma_f32_16x16x32_bf16 v[52:55], a[132:135], v[132:135], v[52:55]
  ds_read_b128 v[120:123], v7 offset:14336
  v_mfma_f32_16x16x32_bf16 v[68:71], a[136:139], v[132:135], v[68:71]
  ds_read_b128 v[124:127], v7 offset:15360
  v_mfma_f32_16x16x32_bf16 v[84:87], a[140:143], v[132:135], v[84:87]
  v_mfma_f32_16x16x32_bf16 v[56:59], a[132:135], v[136:139], v[56:59]
  v_mfma_f32_16x16x32_bf16 v[72:75], a[136:139], v[136:139], v[72:75]
  v_mfma_f32_16x16x32_bf16 v[88:91], a[140:143], v[136:139], v[88:91]
  v_mfma_f32_16x16x32_bf16 v[60:63], a[132:135], v[140:143], v[60:63]
  v_mfma_f32_16x16x32_bf16 v[76:79], a[136:139], v[140:143], v[76:79]
  v_mfma_f32_16x16x32_bf16 v[92:95], a[140:143], v[140:143], v[92:95]
  s_waitcnt lgkmcnt(0)
  v_mfma_f32_16x16x32_bf16 v[48:51], a[144:147], v[112:115], v[48:51]
  ds_read_b128 v[128:131], v7 offset:16384
  v_mfma_f32_16x16x32_bf16 v[64:67], a[148:151], v[112:115], v[64:67]
  ds_read_b128 v[132:135], v7 offset:17408
  v_mfma_f32_16x16x32_bf16 v[80:83], a[152:155], v[112:115], v[80:83]
  v_mfma_f32_16x16x32_bf16 v[52:55], a[144:147], v[116:119], v[52:55]
  ds_read_b128 v[136:139], v7 offset:18432
  v_mfma_f32_16x16x32_bf16 v[68:71], a[148:151], v[116:119], v[68:71]
  ds_read_b128 v[140:143], v7 offset:19456
  v_mfma_f32_16x16x32_bf16 v[84:87], a[152:155], v[116:119], v[84:87]
  v_mfma_f32_16x16x32_bf16 v[56:59], a[144:147], v[120:123], v[56:59]
  v_mfma_f32_16x16x32_bf16 v[72:75], a[148:151], v[120:123], v[72:75]
  v_mfma_f32_16x16x32_bf16 v[88:91], a[152:155], v[120:123], v[88:91]
  v_mfma_f32_16x16x32_bf16 v[60:63], a[144:147], v[124:127], v[60:63]
  v_mfma_f32_16x16x32_bf16 v[76:79], a[148:151], v[124:127], v[76:79]
  v_mfma_f32_16x16x32_bf16 v[92:95], a[152:155], v[124:127], v[92:95]
  s_waitcnt vmcnt(30) lgkmcnt(0)
  v_mfma_f32_16x16x32_bf16 v[48:51], a[156:159], v[128:131], v[48:51]
  ds_read_b128 v[112:115], v7 offset:20480
  v_mfma_f32_16x16x32_bf16 v[64:67], a[160:163], v[128:131], v[64:67]
  ds_read_b128 v[116:119], v7 offset:21504
  v_mfma_f32_16x16x32_bf16 v[80:83], a[164:167], v[128:131], v[80:83]
  v_mfma_f32_16x16x32_bf16 v[52:55], a[156:159], v[132:135], v[52:55]
  ds_read_b128 v[120:123], v7 offset:22528
  v_mfma_f32_16x16x32_bf16 v[68:71], a[160:163], v[132:135], v[68:71]
  ds_read_b128 v[124:127], v7 offset:23552
  v_mfma_f32_16x16x32_bf16 v[84:87], a[164:167], v[132:135], v[84:87]
  v_mfma_f32_16x16x32_bf16 v[56:59], a[156:159], v[136:139], v[56:59]
  v_mfma_f32_16x16x32_bf16 v[72:75], a[160:163], v[136:139], v[72:75]
  v_mfma_f32_16x16x32_bf16 v[88:91], a[164:167], v[136:139], v[88:91]
  v_mfma_f32_16x16x32_bf16 v[60:63], a[156:159], v[140:143], v[60:63]
  v_mfma_f32_16x16x32_bf16 v[76:79], a[160:163], v[140:143], v[76:79]
  v_mfma_f32_16x16x32_bf16 v[92:95], a[164:167], v[140:143], v[92:95]
  s_waitcnt vmcnt(27) lgkmcnt(0)
  v_mfma_f32_16x16x32_bf16 v[48:51], a[168:171], v[112:115], v[48:51]
  ds_read_b128 v[128:131], v7 offset:24576
  v_mfma_f32_16x16x32_bf16 v[64:67], a[172:175], v[112:115], v[64:67]
  ds_read_b128 v[132:135], v7 offset:25600
  v_mfma_f32_16x16x32_bf16 v[80:83], a[176:179], v[112:115], v[80:83]
  v_mfma_f32_16x16x32_bf16 v[52:55], a[168:171], v[116:119], v[52:55]
  ds_read_b128 v[136:139], v7 offset:26624
  v_mfma_f32_16x16x32_bf16 v[68:71], a[172:175], v[116:119], v[68:71]
  ds_read_b128 v[140:143], v7 offset:27648
  v_mfma_f32_16x16x32_bf16 v[84:87], a[176:179], v[116:119], v[84:87]
  v_mfma_f32_16x16x32_bf16 v[56:59], a[168:171], v[120:123], v[56:59]
  v_mfma_f32_16x16x32_bf16 v[72:75], a[172:175], v[120:123], v[72:75]
  v_mfma_f32_16x16x32_bf16 v[88:91], a[176:179], v[120:123], v[88:91]
  v_mfma_f32_16x16x32_bf16 v[60:63], a[168:171], v[124:127], v[60:63]
  v_mfma_f32_16x16x32_bf16 v[76:79], a[172:175], v[124:127], v[76:79]
  v_mfma_f32_16x16x32_bf16 v[92:95], a[176:179], v[124:127], v[92:95]
  s_waitcnt vmcnt(24) lgkmcnt(0)
  v_mfma_f32_16x16x32_bf16 v[48:51], a[180:183], v[128:131], v[48:51]
  ds_read_b128 v[112:115], v7 offset:28672
  v_mfma_f32_16x16x32_bf16 v[64:67], a[184:187], v[128:131], v[64:67]
  ds_read_b128 v[116:119], v7 offset:29696
  v_mfma_f32_16x16x32_bf16 v[80:83], a[188:191], v[128:131], v[80:83]
  v_mfma_f32_16x16x32_bf16 v[52:55], a[180:183], v[132:135], v[52:55]
  ds_read_b128 v[120:123], v7 offset:30720
  v_mfma_f32_16x16x32_bf16 v[68:71], a[184:187], v[132:135], v[68:71]
  ds_read_b128 v[124:127], v7 offset:31744
  v_mfma_f32_16x16x32_bf16 v[84:87], a[188:191], v[132:135], v[84:87]
  v_mfma_f32_16x16x32_bf16 v[56:59], a[180:183], v[136:139], v[56:59]
  v_mfma_f32_16x16x32_bf16 v[72:75], a[184:187], v[136:139], v[72:75]
  v_mfma_f32_16x16x32_bf16 v[88:91], a[188:191], v[136:139], v[88:91]
  v_mfma_f32_16x16x32_bf16 v[60:63], a[180:183], v[140:143], v[60:63]
  v_mfma_f32_16x16x32_bf16 v[76:79], a[184:187], v[140:143], v[76:79]
  v_mfma_f32_16x16x32_bf16 v[92:95], a[188:191], v[140:143], v[92:95]
  s_waitcnt vmcnt(21) lgkmcnt(0)
  v_mfma_f32_16x16x32_bf16 v[48:51], a[192:195], v[112:115], v[48:51]
  ds_read_b128 v[128:131], v7 offset:32768
  v_mfma_f32_16x16x32_bf16 v[64:67], a[196:199], v[112:115], v[64:67]
  ds_read_b128 v[132:135], v7 offset:33792
  v_mfma_f32_16x16x32_bf16 v[80:83], a[200:203], v[112:115], v[80:83]
  v_mfma_f32_16x16x32_bf16 v[52:55], a[192:195], v[116:119], v[52:55]
  ds_read_b128 v[136:139], v7 offset:34816
  v_mfma_f32_16x16x32_bf16 v[68:71], a[196:199], v[116:119], v[68:71]
  ds_read_b128 v[140:143], v7 offset:35840
  v_mfma_f32_16x16x32_bf16 v[84:87], a[200:203], v[116:119], v[84:87]
  v_mfma_f32_16x16x32_bf16 v[56:59], a[192:195], v[120:123], v[56:59]
  v_mfma_f32_16x16x32_bf16 v[72:75], a[196:199], v[120:123], v[72:75]
  v_mfma_f32_16x16x32_bf16 v[88:91], a[200:203], v[120:123], v[88:91]
  v_mfma_f32_16x16x32_bf16 v[60:63], a[192:195], v[124:127], v[60:63]
  v_mfma_f32_16x16x32_bf16 v[76:79], a[196:199], v[124:127], v[76:79]
  v_mfma_f32_16x16x32_bf16 v[92:95], a[200:203], v[124:127], v[92:95]
  s_waitcnt vmcnt(0) lgkmcnt(0)
  v_mfma_f32_16x16x32_bf16 v[48:51], a[204:207], v[128:131], v[48:51]
  ds_read_b128 v[112:115], v1 offset:0
  v_mfma_f32_16x16x32_bf16 v[64:67], a[208:211], v[128:131], v[64:67]
  ds_read_b128 v[116:119], v1 offset:1024
  v_mfma_f32_16x16x32_bf16 v[80:83], a[212:215], v[128:131], v[80:83]
  v_mfma_f32_16x16x32_bf16 v[52:55], a[204:207], v[132:135], v[52:55]
  ds_read_b128 v[120:123], v1 offset:2048
  v_mfma_f32_16x16x32_bf16 v[68:71], a[208:211], v[132:135], v[68:71]
  ds_read_b128 v[124:127], v1 offset:3072
  v_mfma_f32_16x16x32_bf16 v[84:87], a[212:215], v[132:135], v[84:87]
  v_mfma_f32_16x16x32_bf16 v[56:59], a[204:207], v[136:139], v[56:59]
  v_mfma_f32_16x16x32_bf16 v[72:75], a[208:211], v[136:139], v[72:75]
  v_mfma_f32_16x16x32_bf16 v[88:91], a[212:215], v[136:139], v[88:91]
  v_mfma_f32_16x16x32_bf16 v[60:63], a[204:207], v[140:143], v[60:63]
  v_mfma_f32_16x16x32_bf16 v[76:79], a[208:211], v[140:143], v[76:79]
  v_mfma_f32_16x16x32_bf16 v[92:95], a[212:215], v[140:143], v[92:95]
q_epi:
  s_nop 5
  v_cvt_pk_bf16_f32 v184, v48, v49
  v_cvt_pk_bf16_f32 v185, v50, v51
  ds_write_b64 v172, v[184:185] offset:0
  v_cvt_pk_bf16_f32 v186, v52, v53
  v_cvt_pk_bf16_f32 v187, v54, v55
  ds_write_b64 v172, v[186:187] offset:1152
  v_cvt_pk_bf16_f32 v188, v56, v57
  v_cvt_pk_bf16_f32 v189, v58, v59
  ds_write_b64 v172, v[188:189] offset:2304
  v_cvt_pk_bf16_f32 v190, v60, v61
  v_cvt_pk_bf16_f32 v191, v62, v63
  ds_write_b64 v172, v[190:191] offset:3456
  s_cmp_ge_u32 s20, 2
  s_cbranch_scc1 q_epi2
  v_cvt_pk_bf16_f32 v200, v64, v65
  v_cvt_pk_bf16_f32 v201, v66, v67
  v_cvt_pk_bf16_f32 v202, v80, v81
  v_cvt_pk_bf16_f32 v203, v82, v83
  v_cvt_pk_bf16_f32 v204, v68, v69
  v_cvt_pk_bf16_f32 v205, v70, v71
  v_cvt_pk_bf16_f32 v206, v84, v85
  v_cvt_pk_bf16_f32 v207, v86, v87
  v_cvt_pk_bf16_f32 v208, v72, v73
  v_cvt_pk_bf16_f32 v209, v74, v75
  v_cvt_pk_bf16_f32 v210, v88, v89
  v_cvt_pk_bf16_f32 v211, v90, v91
  v_cvt_pk_bf16_f32 v212, v76, v77
  v_cvt_pk_bf16_f32 v213, v78, v79
  v_cvt_pk_bf16_f32 v214, v92, v93
  v_cvt_pk_bf16_f32 v215, v94, v95
  s_waitcnt lgkmcnt(0)
  ds_read_b64_tr_b16 v[48:49], v173 offset:0
  ds_read_b64_tr_b16 v[50:51], v173 offset:576
  ds_read_b64_tr_b16 v[52:53], v173 offset:2304
  ds_read_b64_tr_b16 v[54:55], v173 offset:2880
  v_permlane16_swap_b32 v200, v202
  v_permlane16_swap_b32 v201, v203
  v_permlane16_swap_b32 v204, v206
  v_permlane16_swap_b32 v205, v207
  v_permlane16_swap_b32 v208, v210
  v_permlane16_swap_b32 v209, v211
  v_permlane16_swap_b32 v212, v214
  v_permlane16_swap_b32 v213, v215
  buffer_store_dwordx4 v[200:203], v3, s[16:19], s40 offen offset:0 sc1
  buffer_store_dwordx4 v[204:207], v3, s[16:19], s40 offen offset:256 sc1
  buffer_store_dwordx4 v[208:211], v3, s[16:19], s41 offen offset:0 sc1
  buffer_store_dwordx4 v[212:215], v3, s[16:19], s41 offen offset:256 sc1
  s_waitcnt lgkmcnt(0)
  buffer_store_dwordx4 v[48:51], v174, s[16:19], 0 offen offset:0 sc1
  buffer_store_dwordx4 v[52:55], v174, s[16:19], 0 offen offset:1024 sc1
  s_branch q_epid
q_epi2:
  s_cmp_eq_u32 s20, 3
  s_cbranch_scc1 q_epi3
  v_cvt_pk_bf16_f32 v192, v64, v65
  v_cvt_pk_bf16_f32 v193, v66, v67
  ds_write_b64 v172, v[192:193] offset:32
  v_cvt_pk_bf16_f32 v194, v68, v69
  v_cvt_pk_bf16_f32 v195, v70, v71
  ds_write_b64 v172, v[194:195] offset:1184
  v_cvt_pk_bf16_f32 v196, v72, v73
  v_cvt_pk_bf16_f32 v197, v74, v75
  ds_write_b64 v172, v[196:197] offset:2336
  v_cvt_pk_bf16_f32 v198, v76, v77
  v_cvt_pk_bf16_f32 v199, v78, v79
  ds_write_b64 v172, v[198:199] offset:3488
  s_waitcnt lgkmcnt(0)
  ds_read_b64_tr_b16 v[48:49], v173 offset:0
  ds_read_b64_tr_b16 v[50:51], v173 offset:576
  ds_read_b64_tr_b16 v[52:53], v173 offset:2304
  ds_read_b64_tr_b16 v[54:55], v173 offset:2880
  ds_read_b64_tr_b16 v[56:57], v173 offset:32
  ds_read_b64_tr_b16 v[58:59], v173 offset:608
  ds_read_b64_tr_b16 v[60:61], v173 offset:2336
  ds_read_b64_tr_b16 v[62:63], v173 offset:2912
  s_waitcnt lgkmcnt(4)
  buffer_store_dwordx4 v[48:51], v174, s[16:19], 0 offen offset:0 sc1
  buffer_store_dwordx4 v[52:55], v174, s[16:19], 0 offen offset:1024 sc1
  s_waitcnt lgkmcnt(0)
  buffer_store_dwordx4 v[56:59], v174, s[16:19], 0 offen offset:2048 sc1
  buffer_store_dwordx4 v[60:63], v174, s[16:19], 0 offen offset:3072 sc1
  s_branch q_epid
q_epi3:
  v_mul_f32 v64, v6, v64
  v_mul_f32 v65, v6, v65
  v_mul_f32 v66, v6, v66
  v_mul_f32 v67, v6, v67
  v_mul_f32 v68, v6, v68
  v_mul_f32 v69, v6, v69
  v_mul_f32 v70, v6, v70
  v_mul_f32 v71, v6, v71
  v_mul_f32 v72, v6, v72
  v_mul_f32 v73, v6, v73
  v_mul_f32 v74, v6, v74
  v_mul_f32 v75, v6, v75
  v_mul_f32 v76, v6, v76
  v_mul_f32 v77, v6, v77
  v_mul_f32 v78, v6, v78
  v_mul_f32 v79, v6, v79
  v_cvt_pk_bf16_f32 v200, v64, v65
  v_cvt_pk_bf16_f32 v201, v72, v73
  v_cvt_pk_bf16_f32 v202, v66, v67
  v_cvt_pk_bf16_f32 v203, v74, v75
  v_cvt_pk_bf16_f32 v204, v68, v69
  v_cvt_pk_bf16_f32 v205, v76, v77
  v_cvt_pk_bf16_f32 v206, v70, v71
  v_cvt_pk_bf16_f32 v207, v78, v79
  v_cvt_pk_bf16_f32 v192, v64, v65
  v_cvt_pk_bf16_f32 v193, v66, v67
  ds_write_b64 v172, v[192:193] offset:32
  v_cvt_pk_bf16_f32 v194, v68, v69
  v_cvt_pk_bf16_f32 v195, v70, v71
  ds_write_b64 v172, v[194:195] offset:1184
  v_cvt_pk_bf16_f32 v196, v72, v73
  v_cvt_pk_bf16_f32 v197, v74, v75
  ds_write_b64 v172, v[196:197] offset:2336
  v_cvt_pk_bf16_f32 v198, v76, v77
  v_cvt_pk_bf16_f32 v199, v78, v79
  ds_write_b64 v172, v[198:199] offset:3488
  s_waitcnt lgkmcnt(4)
  ds_read_b64_tr_b16 v[48:49], v173 offset:0
  ds_read_b64_tr_b16 v[50:51], v173 offset:576
  ds_read_b64_tr_b16 v[52:53], v173 offset:2304
  ds_read_b64_tr_b16 v[54:55], v173 offset:2880
  v_mov_b32 v208, 0x3f803f80
  v_and_b32 v209, 8, v0
  v_cmp_eq_u32 vcc, 0, v209
  buffer_store_dwordx2 v[200:201], v5, s[16:19], 0 offen offset:0 sc1
  buffer_store_dwordx2 v[202:203], v5, s[16:19], 0 offen offset:256 sc1
  buffer_store_dwordx2 v[204:205], v5, s[16:19], 0 offen offset:128 sc1
  buffer_store_dwordx2 v[206:207], v5, s[16:19], 0 offen offset:384 sc1
  s_waitcnt lgkmcnt(0)
  v_cndmask_b32 v48, v208, v48, vcc
  v_cndmask_b32 v49, v208, v49, vcc
  v_cndmask_b32 v50, v208, v50, vcc
  v_cndmask_b32 v51, v208, v51, vcc
  v_cndmask_b32 v52, v208, v52, vcc
  v_cndmask_b32 v53, v208, v53, vcc
  v_cndmask_b32 v54, v208, v54, vcc
  v_cndmask_b32 v55, v208, v55, vcc
  buffer_store_dwordx4 v[48:51], v174, s[16:19], 0 offen offset:0 sc1
  buffer_store_dwordx4 v[52:55], v174, s[16:19], 0 offen offset:1024 sc1
q_epid:
  s_cmp_ge_u32 s20, 2
  s_cbranch_scc1 q_p0d
  s_cmp_lg_u32 s3, 0
  s_cbranch_scc1 q_p0b
  ds_read_b128 v[128:131], v179 offset:4096
  ds_read_b128 v[132:135], v179 offset:5120
  ds_read_b128 v[136:139], v179 offset:6144
  ds_read_b128 v[140:143], v179 offset:7168
  s_waitcnt lgkmcnt(4)
  v_mfma_f32_16x16x32_bf16 v[80:83], a[216:219], v[112:115], 0
  ds_read_b128 v[144:147], v178 offset:8192
  v_mfma_f32_16x16x32_bf16 v[84:87], a[216:219], v[116:119], 0
  ds_read_b128 v[148:151], v178 offset:9216
  v_mfma_f32_16x16x32_bf16 v[88:91], a[216:219], v[120:123], 0
  ds_read_b128 v[152:155], v178 offset:10240
  v_mfma_f32_16x16x32_bf16 v[92:95], a[216:219], v[124:127], 0
  ds_read_b128 v[156:159], v178 offset:11264
  s_waitcnt lgkmcnt(4)
  v_mfma_f32_16x16x32_bf16 v[80:83], a[220:223], v[128:131], v[80:83]
  ds_read_b128 v[112:115], v179 offset:12288
  v_mfma_f32_16x16x32_bf16 v[84:87], a[220:223], v[132:135], v[84:87]
  ds_read_b128 v[116:119], v179 offset:13312
  v_mfma_f32_16x16x32_bf16 v[88:91], a[220:223], v[136:139], v[88:91]
  ds_read_b128 v[120:123], v179 offset:14336
  v_mfma_f32_16x16x32_bf16 v[92:95], a[220:223], v[140:143], v[92:95]
  ds_read_b128 v[124:127], v179 offset:15360
  s_waitcnt lgkmcnt(4)
  v_mfma_f32_16x16x32_bf16 v[80:83], a[224:227], v[144:147], v[80:83]
  ds_read_b128 v[128:131], v178 offset:16384
  v_mfma_f32_16x16x32_bf16 v[84:87], a[224:227], v[148:151], v[84:87]
  ds_read_b128 v[132:135], v178 offset:17408
  v_mfma_f32_16x16x32_bf16 v[88:91], a[224:227], v[152:155], v[88:91]
  ds_read_b128 v[136:139], v178 offset:18432
  v_mfma_f32_16x16x32_bf16 v[92:95], a[224:227], v[156:159], v[92:95]
  ds_read_b128 v[140:143], v178 offset:19456
  s_waitcnt lgkmcnt(4)
  v_mfma_f32_16x16x32_bf16 v[80:83], a[228:231], v[112:115], v[80:83]
  ds_read_b128 v[144:147], v179 offset:20480
  v_mfma_f32_16x16x32_bf16 v[84:87], a[228:231], v[116:119], v[84:87]
  ds_read_b128 v[148:151], v179 offset:21504
  v_mfma_f32_16x16x32_bf16 v[88:91], a[228:231], v[120:123], v[88:91]
  ds_read_b128 v[152:155], v179 offset:22528
  v_mfma_f32_16x16x32_bf16 v[92:95], a[228:231], v[124:127], v[92:95]
  ds_read_b128 v[156:159], v179 offset:23552
  s_waitcnt lgkmcnt(4)
  v_mfma_f32_16x16x32_bf16 v[80:83], a[232:235], v[128:131], v[80:83]
  ds_read_b128 v[112:115], v178 offset:24576
  v_mfma_f32_16x16x32_bf16 v[84:87], a[232:235], v[132:135], v[84:87]
  ds_read_b128 v[116:119], v178 offset:25600
  v_mfma_f32_16x16x32_bf16 v[88:91], a[232:235], v[136:139], v[88:91]
  ds_read_b128 v[120:123], v178 offset:26624
  v_mfma_f32_16x16x32_bf16 v[92:95], a[232:235], v[140:143], v[92:95]
  ds_read_b128 v[124:127], v178 offset:27648
  s_waitcnt lgkmcnt(4)
  v_mfma_f32_16x16x32_bf16 v[80:83], a[236:239], v[144:147], v[80:83]
  ds_read_b128 v[128:131], v179 offset:28672
  v_mfma_f32_16x16x32_bf16 v[84:87], a[236:239], v[148:151], v[84:87]
  ds_read_b128 v[132:135], v179 offset:29696
  v_mfma_f32_16x16x32_bf16 v[88:91], a[236:239], v[152:155], v[88:91]
  ds_read_b128 v[136:139], v179 offset:30720
  v_mfma_f32_16x16x32_bf16 v[92:95], a[236:239], v[156:159], v[92:95]
  ds_read_b128 v[140:143], v179 offset:31744
  s_waitcnt lgkmcnt(4)
  v_mfma_f32_16x16x32_bf16 v[80:83], a[240:243], v[112:115], v[80:83]
  ds_read_b128 v[144:147], v178 offset:32768
  v_mfma_f32_16x16x32_bf16 v[84:87], a[240:243], v[116:119], v[84:87]
  ds_read_b128 v[148:151], v178 offset:33792
  v_mfma_f32_16x16x32_bf16 v[88:91], a[240:243], v[120:123], v[88:91]
  ds_read_b128 v[152:155], v178 offset:34816
  v_mfma_f32_16x16x32_bf16 v[92:95], a[240:243], v[124:127], v[92:95]
  ds_read_b128 v[156:159], v178 offset:35840
  s_waitcnt lgkmcnt(4)
  v_mfma_f32_16x16x32_bf16 v[80:83], a[244:247], v[128:131], v[80:83]
  ds_read_b128 v[112:115], v181 offset:0
  v_mfma_f32_16x16x32_bf16 v[84:87], a[244:247], v[132:135], v[84:87]
  ds_read_b128 v[116:119], v181 offset:1024
  v_mfma_f32_16x16x32_bf16 v[88:91], a[244:247], v[136:139], v[88:91]
  ds_read_b128 v[120:123], v181 offset:2048
  v_mfma_f32_16x16x32_bf16 v[92:95], a[244:247], v[140:143], v[92:95]
  ds_read_b128 v[124:127], v181 offset:3072
  s_waitcnt lgkmcnt(4)
  v_mfma_f32_16x16x32_bf16 v[80:83], a[248:251], v[144:147], v[80:83]
  ds_read_b128 v[128:131], v180 offset:4096
  v_mfma_f32_16x16x32_bf16 v[84:87], a[248:251], v[148:151], v[84:87]
  ds_read_b128 v[132:135], v180 offset:5120
  v_mfma_f32_16x16x32_bf16 v[88:91], a[248:251], v[152:155], v[88:91]
  ds_read_b128 v[136:139], v180 offset:6144
  v_mfma_f32_16x16x32_bf16 v[92:95], a[248:251], v[156:159], v[92:95]
  ds_read_b128 v[140:143], v180 offset:7168
  s_waitcnt lgkmcnt(4)
  v_mfma_f32_16x16x32_bf16 v[80:83], a[252:255], v[112:115], v[80:83]
  ds_read_b128 v[144:147], v181 offset:8192
  v_mfma_f32_16x16x32_bf16 v[84:87], a[252:255], v[116:119], v[84:87]
  ds_read_b128 v[148:151], v181 offset:9216
  v_mfma_f32_16x16x32_bf16 v[88:91], a[252:255], v[120:123], v[88:91]
  ds_read_b128 v[152:155], v181 offset:10240
  v_mfma_f32_16x16x32_bf16 v[92:95], a[252:255], v[124:127], v[92:95]
  ds_read_b128 v[156:159], v181 offset:11264
  s_waitcnt lgkmcnt(4)
  v_mfma_f32_16x16x32_bf16 v[80:83], v[16:19], v[128:131], v[80:83]
  ds_read_b128 v[112:115], v180 offset:12288
  v_mfma_f32_16x16x32_bf16 v[84:87], v[16:19], v[132:135], v[84:87]
  ds_read_b128 v[116:119], v180 offset:13312
  v_mfma_f32_16x16x32_bf16 v[88:91], v[16:19], v[136:139], v[88:91]
  ds_read_b128 v[120:123], v180 offset:14336
  v_mfma_f32_16x16x32_bf16 v[92:95], v[16:19], v[140:143], v[92:95]
  ds_read_b128 v[124:127], v180 offset:15360
  s_waitcnt lgkmcnt(4)
  v_mfma_f32_16x16x32_bf16 v[80:83], v[20:23], v[144:147], v[80:83]
  ds_read_b128 v[128:131], v181 offset:16384
  v_mfma_f32_16x16x32_bf16 v[84:87], v[20:23], v[148:151], v[84:87]
  ds_read_b128 v[132:135], v181 offset:17408
  v_mfma_f32_16x16x32_bf16 v[88:91], v[20:23], v[152:155], v[88:91]
  ds_read_b128 v[136:139], v181 offset:18432
  v_mfma_f32_16x16x32_bf16 v[92:95], v[20:23], v[156:159], v[92:95]
  ds_read_b128 v[140:143], v181 offset:19456
  s_waitcnt lgkmcnt(4)
  v_mfma_f32_16x16x32_bf16 v[80:83], v[24:27], v[112:115], v[80:83]
  ds_read_b128 v[144:147], v180 offset:20480
  v_mfma_f32_16x16x32_bf16 v[84:87], v[24:27], v[116:119], v[84:87]
  ds_read_b128 v[148:151], v180 offset:21504
  v_mfma_f32_16x16x32_bf16 v[88:91], v[24:27], v[120:123], v[88:91]
  ds_read_b128 v[152:155], v180 offset:22528
  v_mfma_f32_16x16x32_bf16 v[92:95], v[24:27], v[124:127], v[92:95]
  ds_read_b128 v[156:159], v180 offset:23552
  s_waitcnt lgkmcnt(4)
  v_mfma_f32_16x16x32_bf16 v[80:83], v[28:31], v[128:131], v[80:83]
  ds_read_b128 v[112:115], v181 offset:24576
  v_mfma_f32_16x16x32_bf16 v[84:87], v[28:31], v[132:135], v[84:87]
  ds_read_b128 v[116:119], v181 offset:25600
  v_mfma_f32_16x16x32_bf16 v[88:91], v[28:31], v[136:139], v[88:91]
  ds_read_b128 v[120:123], v181 offset:26624
  v_mfma_f32_16x16x32_bf16 v[92:95], v[28:31], v[140:143], v[92:95]
  ds_read_b128 v[124:127], v181 offset:27648
  s_branch q_p0d
q_p0b:
  ds_read_b128 v[128:131], v1 offset:4096
  ds_read_b128 v[132:135], v1 offset:5120
  ds_read_b128 v[136:139], v1 offset:6144
  ds_read_b128 v[140:143], v1 offset:7168
  s_waitcnt lgkmcnt(4)
  v_mfma_f32_16x16x32_bf16 v[80:83], a[216:219], v[112:115], 0
  ds_read_b128 v[144:147], v1 offset:8192
  v_mfma_f32_16x16x32_bf16 v[84:87], a[216:219], v[116:119], 0
  ds_read_b128 v[148:151], v1 offset:9216
  v_mfma_f32_16x16x32_bf16 v[88:91], a[216:219], v[120:123], 0
  ds_read_b128 v[152:155], v1 offset:10240
  v_mfma_f32_16x16x32_bf16 v[92:95], a[216:219], v[124:127], 0
  ds_read_b128 v[156:159], v1 offset:11264
  s_waitcnt lgkmcnt(4)
  v_mfma_f32_16x16x32_bf16 v[80:83], a[220:223], v[128:131], v[80:83]
  ds_read_b128 v[112:115], v1 offset:12288
  v_mfma_f32_16x16x32_bf16 v[84:87], a[220:223], v[132:135], v[84:87]
  ds_read_b128 v[116:119], v1 offset:13312
  v_mfma_f32_16x16x32_bf16 v[88:91], a[220:223], v[136:139], v[88:91]
  ds_read_b128 v[120:123], v1 offset:14336
  v_mfma_f32_16x16x32_bf16 v[92:95], a[220:223], v[140:143], v[92:95]
  ds_read_b128 v[124:127], v1 offset:15360
  s_waitcnt lgkmcnt(4)
  v_mfma_f32_16x16x32_bf16 v[80:83], a[224:227], v[144:147], v[80:83]
  ds_read_b128 v[128:131], v1 offset:16384
  v_mfma_f32_16x16x32_bf16 v[84:87], a[224:227], v[148:151], v[84:87]
  ds_read_b128 v[132:135], v1 offset:17408
  v_mfma_f32_16x16x32_bf16 v[88:91], a[224:227], v[152:155], v[88:91]
  ds_read_b128 v[136:139], v1 offset:18432
  v_mfma_f32_16x16x32_bf16 v[92:95], a[224:227], v[156:159], v[92:95]
  ds_read_b128 v[140:143], v1 offset:19456
  s_waitcnt lgkmcnt(4)
  v_mfma_f32_16x16x32_bf16 v[80:83], a[228:231], v[112:115], v[80:83]
  ds_read_b128 v[144:147], v1 offset:20480
  v_mfma_f32_16x16x32_bf16 v[84:87], a[228:231], v[116:119], v[84:87]
  ds_read_b128 v[148:151], v1 offset:21504
  v_mfma_f32_16x16x32_bf16 v[88:91], a[228:231], v[120:123], v[88:91]
  ds_read_b128 v[152:155], v1 offset:22528
  v_mfma_f32_16x16x32_bf16 v[92:95], a[228:231], v[124:127], v[92:95]
  ds_read_b128 v[156:159], v1 offset:23552
  s_waitcnt lgkmcnt(4)
  v_mfma_f32_16x16x32_bf16 v[80:83], a[232:235], v[128:131], v[80:83]
  ds_read_b128 v[112:115], v1 offset:24576
  v_mfma_f32_16x16x32_bf16 v[84:87], a[232:235], v[132:135], v[84:87]
  ds_read_b128 v[116:119], v1 offset:25600
  v_mfma_f32_16x16x32_bf16 v[88:91], a[232:235], v[136:139], v[88:91]
  ds_read_b128 v[120:123], v1 offset:26624
  v_mfma_f32_16x16x32_bf16 v[92:95], a[232:235], v[140:143], v[92:95]
  ds_read_b128 v[124:127], v1 offset:27648
  s_waitcnt lgkmcnt(4)
  v_mfma_f32_16x16x32_bf16 v[80:83], a[236:239], v[144:147], v[80:83]
  ds_read_b128 v[128:131], v1 offset:28672
  v_mfma_f32_16x16x32_bf16 v[84:87], a[236:239], v[148:151], v[84:87]
  ds_read_b128 v[132:135], v1 offset:29696
  v_mfma_f32_16x16x32_bf16 v[88:91], a[236:239], v[152:155], v[88:91]
  ds_read_b128 v[136:139], v1 offset:30720
  v_mfma_f32_16x16x32_bf16 v[92:95], a[236:239], v[156:159], v[92:95]
  ds_read_b128 v[140:143], v1 offset:31744
  s_waitcnt lgkmcnt(4)
  v_mfma_f32_16x16x32_bf16 v[80:83], a[240:243], v[112:115], v[80:83]
  ds_read_b128 v[144:147], v1 offset:32768
  v_mfma_f32_16x16x32_bf16 v[84:87], a[240:243], v[116:119], v[84:87]
  ds_read_b128 v[148:151], v1 offset:33792
  v_mfma_f32_16x16x32_bf16 v[88:91], a[240:243], v[120:123], v[88:91]
  ds_read_b128 v[152:155], v1 offset:34816
  v_mfma_f32_16x16x32_bf16 v[92:95], a[240:243], v[124:127], v[92:95]
  ds_read_b128 v[156:159], v1 offset:35840
  s_waitcnt lgkmcnt(4)
  v_mfma_f32_16x16x32_bf16 v[80:83], a[244:247], v[128:131], v[80:83]
  ds_read_b128 v[112:115], v7 offset:0
  v_mfma_f32_16x16x32_bf16 v[84:87], a[244:247], v[132:135], v[84:87]
  ds_read_b128 v[116:119], v7 offset:1024
  v_mfma_f32_16x16x32_bf16 v[88:91], a[244:247], v[136:139], v[88:91]
  ds_read_b128 v[120:123], v7 offset:2048
  v_mfma_f32_16x16x32_bf16 v[92:95], a[244:247], v[140:143], v[92:95]
  ds_read_b128 v[124:127], v7 offset:3072
  s_waitcnt lgkmcnt(4)
  v_mfma_f32_16x16x32_bf16 v[80:83], a[248:251], v[144:147], v[80:83]
  ds_read_b128 v[128:131], v7 offset:4096
  v_mfma_f32_16x16x32_bf16 v[84:87], a[248:251], v[148:151], v[84:87]
  ds_read_b128 v[132:135], v7 offset:5120
  v_mfma_f32_16x16x32_bf16 v[88:91], a[248:251], v[152:155], v[88:91]
  ds_read_b128 v[136:139], v7 offset:6144
  v_mfma_f32_16x16x32_bf16 v[92:95], a[248:251], v[156:159], v[92:95]
  ds_read_b128 v[140:143], v7 offset:7168
  s_waitcnt lgkmcnt(4)
  v_mfma_f32_16x16x32_bf16 v[80:83], a[252:255], v[112:115], v[80:83]
  ds_read_b128 v[144:147], v7 offset:8192
  v_mfma_f32_16x16x32_bf16 v[84:87], a[252:255], v[116:119], v[84:87]
  ds_read_b128 v[148:151], v7 offset:9216
  v_mfma_f32_16x16x32_bf16 v[88:91], a[252:255], v[120:123], v[88:91]
  ds_read_b128 v[152:155], v7 offset:10240
  v_mfma_f32_16x16x32_bf16 v[92:95], a[252:255], v[124:127], v[92:95]
  ds_read_b128 v[156:159], v7 offset:11264
  s_waitcnt lgkmcnt(4)
  v_mfma_f32_16x16x32_bf16 v[80:83], v[16:19], v[128:131], v[80:83]
  ds_read_b128 v[112:115], v7 offset:12288
  v_mfma_f32_16x16x32_bf16 v[84:87], v[16:19], v[132:135], v[84:87]
  ds_read_b128 v[116:119], v7 offset:13312
  v_mfma_f32_16x16x32_bf16 v[88:91], v[16:19], v[136:139], v[88:91]
  ds_read_b128 v[120:123], v7 offset:14336
  v_mfma_f32_16x16x32_bf16 v[92:95], v[16:19], v[140:143], v[92:95]
  ds_read_b128 v[124:127], v7 offset:15360
  s_waitcnt lgkmcnt(4)
  v_mfma_f32_16x16x32_bf16 v[80:83], v[20:23], v[144:147], v[80:83]
  ds_read_b128 v[128:131], v7 offset:16384
  v_mfma_f32_16x16x32_bf16 v[84:87], v[20:23], v[148:151], v[84:87]
  ds_read_b128 v[132:135], v7 offset:17408
  v_mfma_f32_16x16x32_bf16 v[88:91], v[20:23], v[152:155], v[88:91]
  ds_read_b128 v[136:139], v7 offset:18432
  v_mfma_f32_16x16x32_bf16 v[92:95], v[20:23], v[156:159], v[92:95]
  ds_read_b128 v[140:143], v7 offset:19456
  s_waitcnt lgkmcnt(4)
  v_mfma_f32_16x16x32_bf16 v[80:83], v[24:27], v[112:115], v[80:83]
  ds_read_b128 v[144:147], v7 offset:20480
  v_mfma_f32_16x16x32_bf16 v[84:87], v[24:27], v[116:119], v[84:87]
  ds_read_b128 v[148:151], v7 offset:21504
  v_mfma_f32_16x16x32_bf16 v[88:91], v[24:27], v[120:123], v[88:91]
  ds_read_b128 v[152:155], v7 offset:22528
  v_mfma_f32_16x16x32_bf16 v[92:95], v[24:27], v[124:127], v[92:95]
  ds_read_b128 v[156:159], v7 offset:23552
  s_waitcnt lgkmcnt(4)
  v_mfma_f32_16x16x32_bf16 v[80:83], v[28:31], v[128:131], v[80:83]
  ds_read_b128 v[112:115], v7 offset:24576
  v_mfma_f32_16x16x32_bf16 v[84:87], v[28:31], v[132:135], v[84:87]
  ds_read_b128 v[116:119], v7 offset:25600
  v_mfma_f32_16x16x32_bf16 v[88:91], v[28:31], v[136:139], v[88:91]
  ds_read_b128 v[120:123], v7 offset:26624
  v_mfma_f32_16x16x32_bf16 v[92:95], v[28:31], v[140:143], v[92:95]
  ds_read_b128 v[124:127], v7 offset:27648
q_p0d:
  s_waitcnt vmcnt(0)
  s_barrier
  s_cmp_lg_u32 s20, 0
  s_cbranch_scc1 pub4
  s_lshl_b32 s23, s21, 3
  s_add_u32 s23, s23, s22
  s_lshl_b32 s23, s23, 6
  s_add_u32 s23, s23, 16384
  s_add_u32 s23, s23, s14
  s_mov_b64 exec, 1
  v_mov_b32 v9, 0
  v_mov_b32 v10, s90
  v_mov_b32 v11, s91
  buffer_store_dwordx2 v[10:11], v9, s[92:95], s23 offen sc1
  s_cmp_lg_u32 s3, 0
  s_cbranch_scc1 pub4_x
  s_lshl_b32 s23, s75, 5
  s_add_u32 s23, s23, s74
  s_lshl_b32 s23, s23, 3
  s_add_u32 s23, s23, 180224
  buffer_store_dwordx2 v[10:11], v9, s[92:95], s23 offen sc1
pub4_x:
  s_mov_b64 exec, -1
pub4:
  s_cmp_ge_u32 s20, 2
  s_cbranch_scc1 q_p1d
  s_cmp_lg_u32 s3, 0
  s_cbranch_scc1 q_p1b
  s_waitcnt lgkmcnt(4)
  v_mfma_f32_16x16x32_bf16 v[80:83], v[32:35], v[144:147], v[80:83]
  ds_read_b128 v[128:131], v180 offset:28672
  v_mfma_f32_16x16x32_bf16 v[84:87], v[32:35], v[148:151], v[84:87]
  ds_read_b128 v[132:135], v180 offset:29696
  v_mfma_f32_16x16x32_bf16 v[88:91], v[32:35], v[152:155], v[88:91]
  ds_read_b128 v[136:139], v180 offset:30720
  v_mfma_f32_16x16x32_bf16 v[92:95], v[32:35], v[156:159], v[92:95]
  ds_read_b128 v[140:143], v180 offset:31744
  s_waitcnt lgkmcnt(4)
  v_mfma_f32_16x16x32_bf16 v[80:83], v[36:39], v[112:115], v[80:83]
  ds_read_b128 v[144:147], v181 offset:32768
  v_mfma_f32_16x16x32_bf16 v[84:87], v[36:39], v[116:119], v[84:87]
  ds_read_b128 v[148:151], v181 offset:33792
  v_mfma_f32_16x16x32_bf16 v[88:91], v[36:39], v[120:123], v[88:91]
  ds_read_b128 v[152:155], v181 offset:34816
  v_mfma_f32_16x16x32_bf16 v[92:95], v[36:39], v[124:127], v[92:95]
  ds_read_b128 v[156:159], v181 offset:35840
  s_waitcnt lgkmcnt(4)
  v_mfma_f32_16x16x32_bf16 v[80:83], v[40:43], v[128:131], v[80:83]
  v_mfma_f32_16x16x32_bf16 v[84:87], v[40:43], v[132:135], v[84:87]
  v_mfma_f32_16x16x32_bf16 v[88:91], v[40:43], v[136:139], v[88:91]
  v_mfma_f32_16x16x32_bf16 v[92:95], v[40:43], v[140:143], v[92:95]
  s_waitcnt lgkmcnt(0)
  v_mfma_f32_16x16x32_bf16 v[80:83], v[44:47], v[144:147], v[80:83]
  v_mfma_f32_16x16x32_bf16 v[84:87], v[44:47], v[148:151], v[84:87]
  v_mfma_f32_16x16x32_bf16 v[88:91], v[44:47], v[152:155], v[88:91]
  v_mfma_f32_16x16x32_bf16 v[92:95], v[44:47], v[156:159], v[92:95]
  s_branch q_p1d
q_p1b:
  s_waitcnt lgkmcnt(4)
  v_mfma_f32_16x16x32_bf16 v[80:83], v[32:35], v[144:147], v[80:83]
  ds_read_b128 v[128:131], v7 offset:28672
  v_mfma_f32_16x16x32_bf16 v[84:87], v[32:35], v[148:151], v[84:87]
  ds_read_b128 v[132:135], v7 offset:29696
  v_mfma_f32_16x16x32_bf16 v[88:91], v[32:35], v[152:155], v[88:91]
  ds_read_b128 v[136:139], v7 offset:30720
  v_mfma_f32_16x16x32_bf16 v[92:95], v[32:35], v[156:159], v[92:95]
  ds_read_b128 v[140:143], v7 offset:31744
  s_waitcnt lgkmcnt(4)
  v_mfma_f32_16x16x32_bf16 v[80:83], v[36:39], v[112:115], v[80:83]
  ds_read_b128 v[144:147], v7 offset:32768
  v_mfma_f32_16x16x32_bf16 v[84:87], v[36:39], v[116:119], v[84:87]
  ds_read_b128 v[148:151], v7 offset:33792
  v_mfma_f32_16x16x32_bf16 v[88:91], v[36:39], v[120:123], v[88:91]
  ds_read_b128 v[152:155], v7 offset:34816
  v_mfma_f32_16x16x32_bf16 v[92:95], v[36:39], v[124:127], v[92:95]
  ds_read_b128 v[156:159], v7 offset:35840
  s_waitcnt lgkmcnt(4)
  v_mfma_f32_16x16x32_bf16 v[80:83], v[40:43], v[128:131], v[80:83]
  v_mfma_f32_16x16x32_bf16 v[84:87], v[40:43], v[132:135], v[84:87]
  v_mfma_f32_16x16x32_bf16 v[88:91], v[40:43], v[136:139], v[88:91]
  v_mfma_f32_16x16x32_bf16 v[92:95], v[40:43], v[140:143], v[92:95]
  s_waitcnt lgkmcnt(0)
  v_mfma_f32_16x16x32_bf16 v[80:83], v[44:47], v[144:147], v[80:83]
  v_mfma_f32_16x16x32_bf16 v[84:87], v[44:47], v[148:151], v[84:87]
  v_mfma_f32_16x16x32_bf16 v[88:91], v[44:47], v[152:155], v[88:91]
  v_mfma_f32_16x16x32_bf16 v[92:95], v[44:47], v[156:159], v[92:95]
q_p1d:
  s_nop 7
  v_mul_f32 v80, s28, v80
  v_mul_f32 v81, s28, v81
  v_mul_f32 v82, s28, v82
  v_mul_f32 v83, s28, v83
  v_mul_f32 v84, s28, v84
  v_mul_f32 v85, s28, v85
  v_mul_f32 v86, s28, v86
  v_mul_f32 v87, s28, v87
  v_mul_f32 v88, s28, v88
  v_mul_f32 v89, s28, v89
  v_mul_f32 v90, s28, v90
  v_mul_f32 v91, s28, v91
  v_mul_f32 v92, s28, v92
  v_mul_f32 v93, s28, v93
  v_mul_f32 v94, s28, v94
  v_mul_f32 v95, s28, v95
  v_cvt_pk_bf16_f32 v24, v80, v81
  v_cvt_pk_bf16_f32 v25, v82, v83
  v_cvt_pk_bf16_f32 v26, v84, v85
  v_cvt_pk_bf16_f32 v27, v86, v87
  v_cvt_pk_bf16_f32 v28, v88, v89
  v_cvt_pk_bf16_f32 v29, v90, v91
  v_cvt_pk_bf16_f32 v30, v92, v93
  v_cvt_pk_bf16_f32 v31, v94, v95
  v_and_b32 v9, 31, v0
  v_mul_u32_u24 v9, 72, v9
  s_lshl_b32 s23, s20, 2
  s_add_u32 s23, s23, 87584
  v_add_u32 v9, s23, v9
  ds_read_b32 v240, v9
  ds_read_b32 v241, v9 offset:2304
  v_permlane16_swap_b32 v24, v26
  v_permlane16_swap_b32 v25, v27
  v_permlane16_swap_b32 v28, v30
  v_permlane16_swap_b32 v29, v31
  v_and_b32 v200, 31, v0
  v_lshrrev_b32 v201, 5, v0
  s_add_i32 s23, s21, -4
  s_cmp_lt_i32 s23, 0
  s_cselect_b32 s8, 61770, 0
  s_max_i32 s23, s23, 0
  s_lshl_b32 s23, s23, 3
  s_add_u32 s23, s23, s22
  s_mul_i32 s82, s23, 28672
  s_add_i32 s23, s21, -3
  s_cmp_lt_i32 s23, 0
  s_cselect_b32 s9, 61770, 0
  s_max_i32 s23, s23, 0
  s_lshl_b32 s23, s23, 3
  s_add_u32 s23, s23, s22
  s_mul_i32 s83, s23, 28672
  s_add_i32 s23, s21, -2
  s_cmp_lt_i32 s23, 0
  s_cselect_b32 s10, 61770, 0
  s_max_i32 s23, s23, 0
  s_lshl_b32 s23, s23, 3
  s_add_u32 s23, s23, s22
  s_mul_i32 s84, s23, 28672
  s_add_i32 s23, s21, -1
  s_cmp_lt_i32 s23, 0
  s_cselect_b32 s11, 61770, 0
  s_max_i32 s23, s23, 0
  s_lshl_b32 s23, s23, 3
  s_add_u32 s23, s23, s22
  s_mul_i32 s85, s23, 28672
  s_add_i32 s23, s21, 0
  s_cmp_lt_i32 s23, 0
  s_cselect_b32 s87, 61770, 0
  s_max_i32 s23, s23, 0
  s_lshl_b32 s23, s23, 3
  s_add_u32 s23, s23, s22
  s_mul_i32 s86, s23, 28672
  s_lshl_b32 s15, s20, 11
  v_add_u32 v2, s15, v1
  v_add_u32 v2, 8192, v2
  s_lshl_b32 s25, s20, 8
  v_lshlrev_b32 v3, 3, v200
  v_add_u32 v3, s25, v3
  v_mov_b32 v203, 0x80000000
  v_cmp_gt_u32 vcc, 32, v0
  v_add_u32 v3, 27648, v3
  s_waitcnt lgkmcnt(0)
  v_cndmask_b32 v224, 0, v240, vcc
  v_cndmask_b32 v229, 0, v240, vcc
  v_cndmask_b32 v232, 0, v241, vcc
  v_cndmask_b32 v237, 0, v241, vcc
  v_lshlrev_b32 v204, 2, v0
  v_cndmask_b32 v7, v203, v204, vcc
  s_add_u32 s4, s96, s3
  s_addc_u32 s5, s97, 0
  s_mov_b32 s6, 0x00700000
  s_mov_b32 s7, 0x00020000
  v_mov_b32 v209, 0x3f80
  v_mov_b32 v208, 0
  v_mov_b32 v225, 0
  v_cndmask_b32 v226, 0, v209, vcc
  v_mov_b32 v227, 0
  v_mov_b32 v228, 0
  v_cndmask_b32 v230, 0, v209, vcc
  v_mov_b32 v231, 0
  v_mov_b32 v233, 0
  v_cndmask_b32 v234, 0, v209, vcc
  v_mov_b32 v235, 0
  v_mov_b32 v236, 0
  v_cndmask_b32 v238, 0, v209, vcc
  v_mov_b32 v239, 0
  v_mov_b32 v209, s8
  v_accvgpr_write_b32 a3, v208
  v_accvgpr_write_b32 a2, v209
  v_mov_b32 v209, s9
  v_accvgpr_write_b32 a15, v208
  v_accvgpr_write_b32 a14, v209
  v_mov_b32 v209, s10
  v_accvgpr_write_b32 a27, v208
  v_accvgpr_write_b32 a26, v209
  v_mov_b32 v209, s11
  v_accvgpr_write_b32 a39, v208
  v_accvgpr_write_b32 a38, v209
  v_mov_b32 v209, s87
  v_accvgpr_write_b32 a51, v208
  v_accvgpr_write_b32 a50, v209
  s_mul_i32 s25, s20, 18
  v_add_u32 v204, s25, v200
  v_cmp_eq_u32 vcc, 18, v200
  v_mov_b32 v205, 72
  s_nop 0
  v_cndmask_b32 v204, v204, v205, vcc
  v_lshrrev_b32 v205, 4, v204
  v_and_b32 v204, 15, v204
  v_lshlrev_b32 v204, 4, v204
  v_lshl_add_u32 v204, v205, 11, v204
  v_lshl_add_u32 v204, v201, 8, v204
  v_add_u32 v204, 16384, v204
  v_cmp_gt_u32 vcc, 19, v200
  v_lshlrev_b32 v8, 2, v201
  v_sub_u32 v8, v200, v8
  v_cndmask_b32 v5, v203, v204, vcc
  v_cmp_le_i32 s[28:29], 0, v8
  v_cmp_le_i32 s[30:31], 1, v8
  v_cmp_le_i32 s[32:33], 2, v8
  v_cmp_le_i32 s[34:35], 3, v8
  v_cmp_le_i32 s[36:37], 8, v8
  v_cmp_le_i32 s[38:39], 9, v8
  v_cmp_le_i32 s[40:41], 10, v8
  v_cmp_le_i32 s[42:43], 11, v8
  v_cmp_le_i32 s[44:45], 16, v8
  v_cmp_le_i32 s[46:47], 17, v8
  v_cmp_le_i32 s[48:49], 18, v8
  v_cmp_le_i32 s[50:51], 19, v8
  v_cmp_le_i32 s[52:53], 24, v8
  v_cmp_le_i32 s[54:55], 25, v8
  v_cmp_le_i32 s[56:57], 26, v8
  v_cmp_le_i32 s[58:59], 27, v8
  v_mov_b32 v209, 0xffff
  v_cndmask_b32 v216, 0, v209, s[28:29]
  v_cndmask_b32 v217, 0, v209, s[32:33]
  v_cndmask_b32 v218, 0, v209, s[36:37]
  v_cndmask_b32 v219, 0, v209, s[40:41]
  v_cndmask_b32 v220, 0, v209, s[44:45]
  v_cndmask_b32 v221, 0, v209, s[48:49]
  v_cndmask_b32 v222, 0, v209, s[52:53]
  v_cndmask_b32 v223, 0, v209, s[56:57]
  v_cndmask_b32 v216, v216, -1, s[30:31]
  v_cndmask_b32 v217, v217, -1, s[34:35]
  v_cndmask_b32 v218, v218, -1, s[38:39]
  v_cndmask_b32 v219, v219, -1, s[42:43]
  v_cndmask_b32 v220, v220, -1, s[46:47]
  v_cndmask_b32 v221, v221, -1, s[50:51]
  v_cndmask_b32 v222, v222, -1, s[54:55]
  v_cndmask_b32 v223, v223, -1, s[58:59]
  s_mul_i32 s23, s21, 73728
  s_add_u32 s23, s23, s3
  s_add_u32 s23, s23, 0x00800000
  s_add_u32 s16, s96, s23
  s_addc_u32 s17, s97, 0
  s_mov_b32 s18, 0x00012000
  s_mov_b32 s19, 0x00020000
  s_lshl_b32 s88, s22, 13
  s_add_u32 s88, s88, s15
  v_lshlrev_b32 v6, 4, v200
  v_lshl_add_u32 v6, v201, 10, v6
  s_add_u32 s89, s22, 64
  s_lshl_b32 s89, s89, 10
  s_lshl_b32 s23, s20, 8
  s_add_u32 s89, s89, s23
  v_mov_b32 v16, 0xff7fffff
  v_mov_b32 v17, 0xff7fffff
  v_mov_b32 v18, 0xff7fffff
  v_mov_b32 v19, 0xff7fffff
  s_bfe_u32 s23, s2, 0x30003
  s_mul_i32 s23, s23, 92160
  s_add_u32 s23, s23, 0x06300000
  s_add_u32 s8, s96, s23
  s_addc_u32 s9, s97, 0
  s_mov_b32 s10, 0x00016800
  s_mov_b32 s11, 0x00020000
  s_cmp_lg_u32 s20, 3
  s_cbranch_scc1 wt5_d
  v_min_u32 v9, 4, v0
  s_sub_u32 s23, s21, 4
  v_add_u32 v9, s23, v9
  v_max_i32 v9, 0, v9
  v_lshlrev_b32 v9, 3, v9
  v_add_u32 v9, s22, v9
  v_lshlrev_b32 v9, 6, v9
  s_add_u32 s23, s14, 16384
  v_add_u32 v9, s23, v9
  s_mov_b32 s23, 0x10000
wt5_l:
  buffer_load_dwordx2 v[10:11], v9, s[92:95], 0 offen sc1
  s_waitcnt vmcnt(0)
  v_cmp_ne_u64 vcc, s[90:91], v[10:11]
  s_sub_u32 s23, s23, 1
  s_cselect_b64 s[24:25], 0, -1
  s_nop 1
  s_and_b64 vcc, vcc, s[24:25]
  s_cbranch_vccnz wt5_l
wt5_d:
  s_barrier
  s_mov_b32 s15, 0
  buffer_load_dwordx4 a[4:7], v2, s[4:7], s82 offen offset:0 sc1
  buffer_load_dwordx2 a[0:1], v3, s[4:7], s82 offen sc1
  buffer_load_dwordx4 a[52:55], v2, s[4:7], s86 offen offset:0 sc1
  buffer_load_dwordx2 a[48:49], v3, s[4:7], s86 offen sc1
  buffer_load_dwordx4 a[8:11], v2, s[4:7], s82 offen offset:1024 sc1
  buffer_load_dwordx4 a[56:59], v2, s[4:7], s86 offen offset:1024 sc1
  buffer_load_dwordx4 a[60:63], v5, s[4:7], s82 offen offset:0 sc1
  buffer_load_dwordx4 a[64:67], v5, s[4:7], s82 offen offset:512 sc1
att_again:
  s_waitcnt vmcnt(4)
  v_mfma_f32_32x32x16_bf16 v[104:119], a[4:7], v[24:27], 0
  v_mfma_f32_32x32x16_bf16 v[104:119], a[0:3], v[224:227], v[104:119]
  v_mfma_f32_32x32x16_bf16 v[120:135], a[52:55], v[24:27], 0
  v_mfma_f32_32x32x16_bf16 v[120:135], a[48:51], v[224:227], v[120:135]
  buffer_load_dwordx4 a[124:127], v5, s[4:7], s86 offen offset:0 sc1
  buffer_load_dwordx4 a[128:131], v5, s[4:7], s86 offen offset:512 sc1
  s_waitcnt vmcnt(4)
  v_mfma_f32_32x32x16_bf16 v[136:151], a[8:11], v[28:31], 0
  v_mfma_f32_32x32x16_bf16 v[136:151], a[0:3], v[236:239], v[136:151]
  v_mfma_f32_32x32x16_bf16 v[152:167], a[56:59], v[28:31], 0
  v_mfma_f32_32x32x16_bf16 v[152:167], a[48:51], v[236:239], v[152:167]
  buffer_load_dwordx4 a[16:19], v2, s[4:7], s83 offen offset:0 sc1
  buffer_load_dwordx2 a[12:13], v3, s[4:7], s83 offen sc1
  s_nop 3
  v_cndmask_b32 v104, v104, v120, s[28:29]
  v_cndmask_b32 v105, v105, v121, s[30:31]
  v_cndmask_b32 v106, v106, v122, s[32:33]
  v_cndmask_b32 v107, v107, v123, s[34:35]
  buffer_load_dwordx4 a[68:71], v5, s[4:7], s82 offen offset:1024 sc1
  v_cndmask_b32 v108, v108, v124, s[36:37]
  v_cndmask_b32 v109, v109, v125, s[38:39]
  v_cndmask_b32 v110, v110, v126, s[40:41]
  v_cndmask_b32 v111, v111, v127, s[42:43]
  v_cndmask_b32 v112, v112, v128, s[44:45]
  v_cndmask_b32 v113, v113, v129, s[46:47]
  v_cndmask_b32 v114, v114, v130, s[48:49]
  v_cndmask_b32 v115, v115, v131, s[50:51]
  buffer_load_dwordx4 a[72:75], v5, s[4:7], s82 offen offset:1536 sc1
  v_cndmask_b32 v116, v116, v132, s[52:53]
  v_cndmask_b32 v117, v117, v133, s[54:55]
  v_cndmask_b32 v118, v118, v134, s[56:57]
  v_cndmask_b32 v119, v119, v135, s[58:59]
  v_max3_f32 v16, v104, v105, v16
  v_max3_f32 v17, v106, v107, v17
  v_max3_f32 v16, v108, v109, v16
  v_max3_f32 v17, v110, v111, v17
  v_max3_f32 v16, v112, v113, v16
  v_max3_f32 v17, v114, v115, v17
  v_max3_f32 v16, v116, v117, v16
  v_max3_f32 v17, v118, v119, v17
  v_cndmask_b32 v136, v136, v152, s[28:29]
  v_cndmask_b32 v137, v137, v153, s[30:31]
  v_cndmask_b32 v138, v138, v154, s[32:33]
  v_cndmask_b32 v139, v139, v155, s[34:35]
  buffer_load_dwordx4 a[132:135], v5, s[4:7], s86 offen offset:1024 sc1
  v_cndmask_b32 v140, v140, v156, s[36:37]
  v_cndmask_b32 v141, v141, v157, s[38:39]
  v_cndmask_b32 v142, v142, v158, s[40:41]
  v_cndmask_b32 v143, v143, v159, s[42:43]
  v_cndmask_b32 v144, v144, v160, s[44:45]
  v_cndmask_b32 v145, v145, v161, s[46:47]
  v_cndmask_b32 v146, v146, v162, s[48:49]
  v_cndmask_b32 v147, v147, v163, s[50:51]
  buffer_load_dwordx4 a[136:139], v5, s[4:7], s86 offen offset:1536 sc1
  v_cndmask_b32 v148, v148, v164, s[52:53]
  v_cndmask_b32 v149, v149, v165, s[54:55]
  v_cndmask_b32 v150, v150, v166, s[56:57]
  v_cndmask_b32 v151, v151, v167, s[58:59]
  v_max3_f32 v18, v136, v137, v18
  v_max3_f32 v19, v138, v139, v19
  v_max3_f32 v18, v140, v141, v18
  v_max3_f32 v19, v142, v143, v19
  v_max3_f32 v18, v144, v145, v18
  v_max3_f32 v19, v146, v147, v19
  v_max3_f32 v18, v148, v149, v18
  v_max3_f32 v19, v150, v151, v19
  v_max_f32 v16, v16, v17
  v_max_f32 v18, v18, v19
  v_mov_b32 v17, v16
  v_mov_b32 v19, v18
  buffer_load_dwordx4 a[20:23], v2, s[4:7], s83 offen offset:1024 sc1
  s_nop 0
  v_permlane32_swap_b32 v16, v17
  v_permlane32_swap_b32 v18, v19
  buffer_load_dwordx4 a[76:79], v5, s[4:7], s83 offen offset:0 sc1
  s_nop 0
  v_max_f32 v16, v16, v17
  v_max_f32 v18, v18, v19
  v_sub_f32 v56, 0, v18
  v_sub_f32 v57, 0, v18
  v_sub_f32 v58, 0, v18
  v_sub_f32 v59, 0, v18
  v_sub_f32 v60, 0, v18
  v_sub_f32 v61, 0, v18
  v_sub_f32 v62, 0, v18
  v_sub_f32 v63, 0, v18
  v_sub_f32 v64, 0, v18
  v_sub_f32 v65, 0, v18
  v_sub_f32 v66, 0, v18
  v_sub_f32 v67, 0, v18
  v_sub_f32 v68, 0, v18
  v_sub_f32 v69, 0, v18
  v_sub_f32 v70, 0, v18
  v_sub_f32 v71, 0, v18
  s_nop 0
  v_sub_f32 v104, v104, v16
  v_mfma_f32_32x32x16_bf16 v[120:135], a[52:55], v[28:31], v[56:71]
  v_sub_f32 v105, v105, v16
  v_sub_f32 v106, v106, v16
  v_sub_f32 v107, v107, v16
  v_sub_f32 v108, v108, v16
  v_sub_f32 v109, v109, v16
  v_sub_f32 v110, v110, v16
  v_sub_f32 v111, v111, v16
  v_sub_f32 v112, v112, v16
  v_sub_f32 v113, v113, v16
  v_sub_f32 v114, v114, v16
  v_sub_f32 v115, v115, v16
  v_sub_f32 v116, v116, v16
  v_sub_f32 v117, v117, v16
  v_sub_f32 v118, v118, v16
  v_mfma_f32_32x32x16_bf16 v[120:135], a[48:51], v[232:235], v[120:135]
  v_sub_f32 v119, v119, v16
  v_exp_f32 v104, v104
  v_exp_f32 v105, v105
  v_exp_f32 v106, v106
  v_exp_f32 v107, v107
  v_cvt_pk_bf16_f32 v168, v104, v105
  v_exp_f32 v108, v108
  v_exp_f32 v109, v109
  buffer_load_dwordx4 a[80:83], v5, s[4:7], s83 offen offset:512 sc1
  v_cvt_pk_bf16_f32 v169, v106, v107
  v_exp_f32 v110, v110
  v_exp_f32 v111, v111
  v_cvt_pk_bf16_f32 v170, v108, v109
  v_exp_f32 v112, v112
  v_exp_f32 v113, v113
  v_cvt_pk_bf16_f32 v171, v110, v111
  v_exp_f32 v114, v114
  buffer_load_dwordx4 a[28:31], v2, s[4:7], s84 offen offset:0 sc1
  v_exp_f32 v115, v115
  v_cvt_pk_bf16_f32 v172, v112, v113
  v_exp_f32 v116, v116
  v_exp_f32 v117, v117
  v_cvt_pk_bf16_f32 v173, v114, v115
  v_exp_f32 v118, v118
  v_exp_f32 v119, v119
  v_cvt_pk_bf16_f32 v174, v116, v117
  v_and_b32 v176, v168, v216
  buffer_load_dwordx2 a[24:25], v3, s[4:7], s84 offen sc1
  v_cvt_pk_bf16_f32 v175, v118, v119
  v_and_b32 v177, v169, v217
  v_and_b32 v178, v170, v218
  v_and_b32 v179, v171, v219
  v_and_b32 v180, v172, v220
  v_and_b32 v181, v173, v221
  v_and_b32 v182, v174, v222
  v_and_b32 v183, v175, v223
  v_xor_b32 v168, v168, v176
  v_xor_b32 v169, v169, v177
  v_xor_b32 v170, v170, v178
  v_xor_b32 v171, v171, v179
  v_xor_b32 v172, v172, v180
  v_xor_b32 v173, v173, v181
  v_xor_b32 v174, v174, v182
  v_xor_b32 v175, v175, v183
  v_sub_f32 v40, 0, v16
  buffer_load_dwordx4 a[84:87], v5, s[4:7], s83 offen offset:1024 sc1
  v_sub_f32 v41, 0, v16
  v_sub_f32 v42, 0, v16
  v_sub_f32 v43, 0, v16
  v_sub_f32 v44, 0, v16
  v_sub_f32 v45, 0, v16
  v_sub_f32 v46, 0, v16
  v_sub_f32 v47, 0, v16
  v_sub_f32 v48, 0, v16
  buffer_load_dwordx4 a[88:91], v5, s[4:7], s83 offen offset:1536 sc1
  v_sub_f32 v49, 0, v16
  v_sub_f32 v50, 0, v16
  v_sub_f32 v51, 0, v16
  v_sub_f32 v52, 0, v16
  v_sub_f32 v53, 0, v16
  v_sub_f32 v54, 0, v16
  v_sub_f32 v55, 0, v16
  buffer_load_dwordx4 a[32:35], v2, s[4:7], s84 offen offset:1024 sc1
  v_exp_f32 v120, v120
  v_exp_f32 v121, v121
  v_exp_f32 v122, v122
  v_exp_f32 v123, v123
  s_waitcnt vmcnt(16)
  v_mfma_f32_32x32x16_bf16 v[72:87], a[60:63], v[168:171], 0
  v_cvt_pk_bf16_f32 v184, v120, v121
  v_exp_f32 v124, v124
  v_exp_f32 v125, v125
  v_cvt_pk_bf16_f32 v185, v122, v123
  v_exp_f32 v126, v126
  v_mfma_f32_32x32x16_bf16 v[72:87], a[64:67], v[172:175], v[72:87]
  v_exp_f32 v127, v127
  v_cvt_pk_bf16_f32 v186, v124, v125
  v_exp_f32 v128, v128
  v_exp_f32 v129, v129
  s_waitcnt vmcnt(14)
  v_mfma_f32_32x32x16_bf16 v[72:87], a[124:127], v[176:179], v[72:87]
  v_cvt_pk_bf16_f32 v187, v126, v127
  v_exp_f32 v130, v130
  v_exp_f32 v131, v131
  v_cvt_pk_bf16_f32 v188, v128, v129
  v_exp_f32 v132, v132
  v_mfma_f32_32x32x16_bf16 v[72:87], a[128:131], v[180:183], v[72:87]
  v_exp_f32 v133, v133
  v_cvt_pk_bf16_f32 v189, v130, v131
  v_exp_f32 v134, v134
  v_exp_f32 v135, v135
  v_cvt_pk_bf16_f32 v190, v132, v133
  v_cvt_pk_bf16_f32 v191, v134, v135
  v_sub_f32 v136, v136, v18
  v_mfma_f32_32x32x16_bf16 v[152:167], a[8:11], v[24:27], v[40:55]
  v_sub_f32 v137, v137, v18
  v_sub_f32 v138, v138, v18
  v_sub_f32 v139, v139, v18
  v_sub_f32 v140, v140, v18
  v_sub_f32 v141, v141, v18
  v_sub_f32 v142, v142, v18
  v_sub_f32 v143, v143, v18
  v_sub_f32 v144, v144, v18
  v_sub_f32 v145, v145, v18
  v_sub_f32 v146, v146, v18
  v_mfma_f32_32x32x16_bf16 v[152:167], a[0:3], v[228:231], v[152:167]
  v_sub_f32 v147, v147, v18
  v_sub_f32 v148, v148, v18
  v_sub_f32 v149, v149, v18
  v_sub_f32 v150, v150, v18
  v_sub_f32 v151, v151, v18
  v_exp_f32 v136, v136
  v_exp_f32 v137, v137
  v_exp_f32 v138, v138
  buffer_load_dwordx4 a[92:95], v5, s[4:7], s84 offen offset:0 sc1
  v_exp_f32 v139, v139
  v_cvt_pk_bf16_f32 v192, v136, v137
  v_exp_f32 v140, v140
  v_exp_f32 v141, v141
  v_cvt_pk_bf16_f32 v193, v138, v139
  v_exp_f32 v142, v142
  buffer_load_dwordx4 a[96:99], v5, s[4:7], s84 offen offset:512 sc1
  v_exp_f32 v143, v143
  v_cvt_pk_bf16_f32 v194, v140, v141
  v_exp_f32 v144, v144
  v_exp_f32 v145, v145
  v_cvt_pk_bf16_f32 v195, v142, v143
  buffer_load_dwordx4 a[40:43], v2, s[4:7], s85 offen offset:0 sc1
  v_exp_f32 v146, v146
  v_exp_f32 v147, v147
  v_cvt_pk_bf16_f32 v196, v144, v145
  v_exp_f32 v148, v148
  v_exp_f32 v149, v149
  v_cvt_pk_bf16_f32 v197, v146, v147
  v_mfma_f32_32x32x16_bf16 v[88:103], a[124:127], v[184:187], 0
  v_exp_f32 v150, v150
  v_exp_f32 v151, v151
  v_cvt_pk_bf16_f32 v198, v148, v149
  v_and_b32 v168, v192, v216
  v_cvt_pk_bf16_f32 v199, v150, v151
  v_and_b32 v169, v193, v217
  v_and_b32 v170, v194, v218
  v_and_b32 v171, v195, v219
  v_mfma_f32_32x32x16_bf16 v[88:103], a[128:131], v[188:191], v[88:103]
  v_and_b32 v172, v196, v220
  v_and_b32 v173, v197, v221
  v_and_b32 v174, v198, v222
  v_and_b32 v175, v199, v223
  v_xor_b32 v192, v192, v168
  v_xor_b32 v193, v193, v169
  v_xor_b32 v194, v194, v170
  v_xor_b32 v195, v195, v171
  v_xor_b32 v196, v196, v172
  v_xor_b32 v197, v197, v173
  v_xor_b32 v198, v198, v174
  v_xor_b32 v199, v199, v175
  v_exp_f32 v152, v152
  s_waitcnt vmcnt(15)
  v_mfma_f32_32x32x16_bf16 v[104:119], a[16:19], v[24:27], v[40:55]
  v_exp_f32 v153, v153
  v_exp_f32 v154, v154
  v_mfma_f32_32x32x16_bf16 v[104:119], a[12:15], v[224:227], v[104:119]
  v_exp_f32 v155, v155
  v_cvt_pk_bf16_f32 v176, v152, v153
  buffer_load_dwordx2 a[36:37], v3, s[4:7], s85 offen sc1
  v_exp_f32 v156, v156
  v_exp_f32 v157, v157
  buffer_load_dwordx4 a[100:103], v5, s[4:7], s84 offen offset:1024 sc1
  v_cvt_pk_bf16_f32 v177, v154, v155
  v_exp_f32 v158, v158
  v_exp_f32 v159, v159
  buffer_load_dwordx4 a[104:107], v5, s[4:7], s84 offen offset:1536 sc1
  v_cvt_pk_bf16_f32 v178, v156, v157
  v_exp_f32 v160, v160
  s_waitcnt vmcnt(16)
  v_mfma_f32_32x32x16_bf16 v[88:103], a[68:71], v[192:195], v[88:103]
  v_exp_f32 v161, v161
  v_cvt_pk_bf16_f32 v179, v158, v159
  v_exp_f32 v162, v162
  v_mfma_f32_32x32x16_bf16 v[88:103], a[72:75], v[196:199], v[88:103]
  v_exp_f32 v163, v163
  v_cvt_pk_bf16_f32 v180, v160, v161
  s_waitcnt vmcnt(14)
  v_mfma_f32_32x32x16_bf16 v[88:103], a[132:135], v[168:171], v[88:103]
  v_exp_f32 v164, v164
  v_exp_f32 v165, v165
  v_mfma_f32_32x32x16_bf16 v[88:103], a[136:139], v[172:175], v[88:103]
  v_cvt_pk_bf16_f32 v181, v162, v163
  v_exp_f32 v166, v166
  v_exp_f32 v167, v167
  v_cvt_pk_bf16_f32 v182, v164, v165
  v_cvt_pk_bf16_f32 v183, v166, v167
  v_exp_f32 v104, v104
  v_mfma_f32_32x32x16_bf16 v[120:135], a[16:19], v[28:31], v[56:71]
  v_exp_f32 v105, v105
  v_exp_f32 v106, v106
  v_exp_f32 v107, v107
  v_mfma_f32_32x32x16_bf16 v[120:135], a[12:15], v[232:235], v[120:135]
  v_cvt_pk_bf16_f32 v184, v104, v105
  v_exp_f32 v108, v108
  v_exp_f32 v109, v109
  buffer_load_dwordx4 a[44:47], v2, s[4:7], s85 offen offset:1024 sc1
  v_cvt_pk_bf16_f32 v185, v106, v107
  v_exp_f32 v110, v110
  v_exp_f32 v111, v111
  buffer_load_dwordx4 a[108:111], v5, s[4:7], s85 offen offset:0 sc1
  v_cvt_pk_bf16_f32 v186, v108, v109
  v_exp_f32 v112, v112
  v_exp_f32 v113, v113
  buffer_load_dwordx4 a[112:115], v5, s[4:7], s85 offen offset:512 sc1
  v_cvt_pk_bf16_f32 v187, v110, v111
  v_exp_f32 v114, v114
  v_exp_f32 v115, v115
  v_mfma_f32_32x32x16_bf16 v[72:87], a[68:71], v[176:179], v[72:87]
  v_cvt_pk_bf16_f32 v188, v112, v113
  v_exp_f32 v116, v116
  v_exp_f32 v117, v117
  v_mfma_f32_32x32x16_bf16 v[72:87], a[72:75], v[180:183], v[72:87]
  v_cvt_pk_bf16_f32 v189, v114, v115
  v_exp_f32 v118, v118
  v_exp_f32 v119, v119
  v_cvt_pk_bf16_f32 v190, v116, v117
  v_cvt_pk_bf16_f32 v191, v118, v119
  v_exp_f32 v120, v120
  s_waitcnt vmcnt(16)
  v_mfma_f32_32x32x16_bf16 v[136:151], a[20:23], v[24:27], v[40:55]
  v_exp_f32 v121, v121
  v_exp_f32 v122, v122
  v_exp_f32 v123, v123
  v_mfma_f32_32x32x16_bf16 v[136:151], a[12:15], v[228:231], v[136:151]
  v_cvt_pk_bf16_f32 v192, v120, v121
  v_exp_f32 v124, v124
  v_exp_f32 v125, v125
  buffer_load_dwordx4 a[116:119], v5, s[4:7], s85 offen offset:1024 sc1
  v_cvt_pk_bf16_f32 v193, v122, v123
  v_exp_f32 v126, v126
  v_exp_f32 v127, v127
  buffer_load_dwordx4 a[120:123], v5, s[4:7], s85 offen offset:1536 sc1
  v_cvt_pk_bf16_f32 v194, v124, v125
  v_exp_f32 v128, v128
  v_exp_f32 v129, v129
  v_cvt_pk_bf16_f32 v195, v126, v127
  v_exp_f32 v130, v130
  v_exp_f32 v131, v131
  s_waitcnt vmcnt(16)
  v_mfma_f32_32x32x16_bf16 v[72:87], a[76:79], v[184:187], v[72:87]
  v_cvt_pk_bf16_f32 v196, v128, v129
  v_exp_f32 v132, v132
  v_exp_f32 v133, v133
  v_mfma_f32_32x32x16_bf16 v[72:87], a[80:83], v[188:191], v[72:87]
  v_cvt_pk_bf16_f32 v197, v130, v131
  v_exp_f32 v134, v134
  v_exp_f32 v135, v135
  v_cvt_pk_bf16_f32 v198, v132, v133
  v_cvt_pk_bf16_f32 v199, v134, v135
  v_exp_f32 v136, v136
  v_mfma_f32_32x32x16_bf16 v[152:167], a[20:23], v[28:31], v[56:71]
  v_exp_f32 v137, v137
  v_exp_f32 v138, v138
  v_exp_f32 v139, v139
  v_cvt_pk_bf16_f32 v168, v136, v137
  v_mfma_f32_32x32x16_bf16 v[152:167], a[12:15], v[236:239], v[152:167]
  v_exp_f32 v140, v140
  v_exp_f32 v141, v141
  v_cvt_pk_bf16_f32 v169, v138, v139
  v_exp_f32 v142, v142
  s_mov_b32 s26, 0
  s_mov_b32 s27, 0x00020000
  s_mov_b64 s[24:25], s[60:61]
  s_mov_b64 s[12:13], s[60:61]
  s_cmp_lg_u32 s3, 0
  s_cbranch_scc1 att_notouch
  s_lshl_b32 s76, s20, 5
  s_add_u32 s76, s76, s74
  s_add_u32 s76, s76, 128
  s_sub_u32 s77, s76, 162
  s_lshl_b32 s77, s77, 1
  s_cmp_lt_u32 s76, 162
  s_cselect_b32 s76, s76, s77
  s_mov_b32 s77, 1152
  s_cselect_b32 s77, 9216, s77
  s_mov_b32 s80, 663552
  s_cselect_b32 s80, 1152, s80
  s_cselect_b32 s81, 0, 36864
  s_cselect_b64 s[24:25], s[60:61], s[72:73]
  s_cselect_b64 s[12:13], s[64:65], s[72:73]
  s_mul_i32 s78, s76, 3641
  s_lshr_b32 s78, s78, 16
  s_mul_i32 s79, s78, 18
  s_sub_u32 s79, s76, s79
  s_lshl_b32 s79, s79, 5
  s_mul_i32 s79, s79, s77
  s_lshl_b32 s78, s78, 7
  s_add_u32 s78, s78, s79
  s_mul_i32 s79, s75, s80
  s_add_u32 s78, s78, s79
  s_add_u32 s81, s81, s78
  s_mov_b32 s26, 0x00510000
att_notouch:
  v_and_b32 v9, 31, v0
  v_mul_u32_u24 v9, s77, v9
  buffer_load_dword v10, v9, s[24:27], s78 offen
  s_mov_b64 s[24:25], s[12:13]
  buffer_load_dword v11, v9, s[24:27], s81 offen
  v_exp_f32 v143, v143
  v_cvt_pk_bf16_f32 v170, v140, v141
  v_exp_f32 v144, v144
  v_exp_f32 v145, v145
  v_mfma_f32_32x32x16_bf16 v[88:103], a[76:79], v[192:195], v[88:103]
  v_cvt_pk_bf16_f32 v171, v142, v143
  v_exp_f32 v146, v146
  v_exp_f32 v147, v147
  v_cvt_pk_bf16_f32 v172, v144, v145
  v_exp_f32 v148, v148
  v_mfma_f32_32x32x16_bf16 v[88:103], a[80:83], v[196:199], v[88:103]
  v_exp_f32 v149, v149
  v_cvt_pk_bf16_f32 v173, v146, v147
  v_exp_f32 v150, v150
  v_exp_f32 v151, v151
  v_cvt_pk_bf16_f32 v174, v148, v149
  v_cvt_pk_bf16_f32 v175, v150, v151
  v_exp_f32 v152, v152
  s_waitcnt vmcnt(16)
  v_mfma_f32_32x32x16_bf16 v[104:119], a[28:31], v[24:27], v[40:55]
  v_exp_f32 v153, v153
  v_exp_f32 v154, v154
  v_exp_f32 v155, v155
  v_mfma_f32_32x32x16_bf16 v[104:119], a[24:27], v[224:227], v[104:119]
  v_cvt_pk_bf16_f32 v176, v152, v153
  v_exp_f32 v156, v156
  v_exp_f32 v157, v157
  v_cvt_pk_bf16_f32 v177, v154, v155
  v_exp_f32 v158, v158
  v_exp_f32 v159, v159
  v_cvt_pk_bf16_f32 v178, v156, v157
  v_exp_f32 v160, v160
  v_exp_f32 v161, v161
  v_cvt_pk_bf16_f32 v179, v158, v159
  v_exp_f32 v162, v162
  v_exp_f32 v163, v163
  s_waitcnt vmcnt(14)
  v_mfma_f32_32x32x16_bf16 v[72:87], a[84:87], v[168:171], v[72:87]
  v_cvt_pk_bf16_f32 v180, v160, v161
  v_exp_f32 v164, v164
  v_exp_f32 v165, v165
  v_mfma_f32_32x32x16_bf16 v[72:87], a[88:91], v[172:175], v[72:87]
  v_cvt_pk_bf16_f32 v181, v162, v163
  v_exp_f32 v166, v166
  v_exp_f32 v167, v167
  v_cvt_pk_bf16_f32 v182, v164, v165
  v_cvt_pk_bf16_f32 v183, v166, v167
  v_exp_f32 v104, v104
  v_mfma_f32_32x32x16_bf16 v[120:135], a[28:31], v[28:31], v[56:71]
  v_exp_f32 v105, v105
  v_exp_f32 v106, v106
  v_exp_f32 v107, v107
  v_mfma_f32_32x32x16_bf16 v[120:135], a[24:27], v[232:235], v[120:135]
  v_cvt_pk_bf16_f32 v184, v104, v105
  v_exp_f32 v108, v108
  v_exp_f32 v109, v109
  v_cvt_pk_bf16_f32 v185, v106, v107
  v_exp_f32 v110, v110
  v_exp_f32 v111, v111
  v_cvt_pk_bf16_f32 v186, v108, v109
  v_exp_f32 v112, v112
  v_exp_f32 v113, v113
  v_cvt_pk_bf16_f32 v187, v110, v111
  v_exp_f32 v114, v114
  v_exp_f32 v115, v115
  v_mfma_f32_32x32x16_bf16 v[88:103], a[84:87], v[176:179], v[88:103]
  v_cvt_pk_bf16_f32 v188, v112, v113
  v_exp_f32 v116, v116
  v_exp_f32 v117, v117
  v_mfma_f32_32x32x16_bf16 v[88:103], a[88:91], v[180:183], v[88:103]
  v_cvt_pk_bf16_f32 v189, v114, v115
  v_exp_f32 v118, v118
  v_exp_f32 v119, v119
  v_cvt_pk_bf16_f32 v190, v116, v117
  v_cvt_pk_bf16_f32 v191, v118, v119
  v_exp_f32 v120, v120
  s_waitcnt vmcnt(13)
  v_mfma_f32_32x32x16_bf16 v[136:151], a[32:35], v[24:27], v[40:55]
  v_exp_f32 v121, v121
  v_exp_f32 v122, v122
  v_exp_f32 v123, v123
  v_mfma_f32_32x32x16_bf16 v[136:151], a[24:27], v[228:231], v[136:151]
  v_cvt_pk_bf16_f32 v192, v120, v121
  v_exp_f32 v124, v124
  v_exp_f32 v125, v125
  v_cvt_pk_bf16_f32 v193, v122, v123
  v_exp_f32 v126, v126
  v_exp_f32 v127, v127
  v_cvt_pk_bf16_f32 v194, v124, v125
  v_exp_f32 v128, v128
  v_exp_f32 v129, v129
  v_cvt_pk_bf16_f32 v195, v126, v127
  v_exp_f32 v130, v130
  v_exp_f32 v131, v131
  s_waitcnt vmcnt(11)
  v_mfma_f32_32x32x16_bf16 v[72:87], a[92:95], v[184:187], v[72:87]
  v_cvt_pk_bf16_f32 v196, v128, v129
  v_exp_f32 v132, v132
  v_exp_f32 v133, v133
  v_mfma_f32_32x32x16_bf16 v[72:87], a[96:99], v[188:191], v[72:87]
  v_cvt_pk_bf16_f32 v197, v130, v131
  v_exp_f32 v134, v134
  v_exp_f32 v135, v135
  v_cvt_pk_bf16_f32 v198, v132, v133
  v_cvt_pk_bf16_f32 v199, v134, v135
  v_exp_f32 v136, v136
  v_mfma_f32_32x32x16_bf16 v[152:167], a[32:35], v[28:31], v[56:71]
  v_exp_f32 v137, v137
  v_exp_f32 v138, v138
  v_exp_f32 v139, v139
  v_mfma_f32_32x32x16_bf16 v[152:167], a[24:27], v[236:239], v[152:167]
  v_cvt_pk_bf16_f32 v168, v136, v137
  v_exp_f32 v140, v140
  v_exp_f32 v141, v141
  v_cvt_pk_bf16_f32 v169, v138, v139
  v_exp_f32 v142, v142
  v_exp_f32 v143, v143
  v_cvt_pk_bf16_f32 v170, v140, v141
  v_exp_f32 v144, v144
  v_exp_f32 v145, v145
  v_cvt_pk_bf16_f32 v171, v142, v143
  v_exp_f32 v146, v146
  v_exp_f32 v147, v147
  v_mfma_f32_32x32x16_bf16 v[88:103], a[92:95], v[192:195], v[88:103]
  v_cvt_pk_bf16_f32 v172, v144, v145
  v_exp_f32 v148, v148
  v_exp_f32 v149, v149
  v_mfma_f32_32x32x16_bf16 v[88:103], a[96:99], v[196:199], v[88:103]
  v_cvt_pk_bf16_f32 v173, v146, v147
  v_exp_f32 v150, v150
  v_exp_f32 v151, v151
  v_cvt_pk_bf16_f32 v174, v148, v149
  v_cvt_pk_bf16_f32 v175, v150, v151
  v_exp_f32 v152, v152
  s_waitcnt vmcnt(9)
  v_mfma_f32_32x32x16_bf16 v[104:119], a[40:43], v[24:27], v[40:55]
  v_exp_f32 v153, v153
  v_exp_f32 v154, v154
  v_exp_f32 v155, v155
  v_mfma_f32_32x32x16_bf16 v[104:119], a[36:39], v[224:227], v[104:119]
  v_cvt_pk_bf16_f32 v176, v152, v153
  v_exp_f32 v156, v156
  v_exp_f32 v157, v157
  v_cvt_pk_bf16_f32 v177, v154, v155
  v_exp_f32 v158, v158
  v_exp_f32 v159, v159
  v_cvt_pk_bf16_f32 v178, v156, v157
  v_exp_f32 v160, v160
  v_exp_f32 v161, v161
  v_cvt_pk_bf16_f32 v179, v158, v159
  v_exp_f32 v162, v162
  v_exp_f32 v163, v163
  s_waitcnt vmcnt(7)
  v_mfma_f32_32x32x16_bf16 v[72:87], a[100:103], v[168:171], v[72:87]
  v_cvt_pk_bf16_f32 v180, v160, v161
  v_exp_f32 v164, v164
  v_exp_f32 v165, v165
  v_mfma_f32_32x32x16_bf16 v[72:87], a[104:107], v[172:175], v[72:87]
  v_cvt_pk_bf16_f32 v181, v162, v163
  v_exp_f32 v166, v166
  v_exp_f32 v167, v167
  v_cvt_pk_bf16_f32 v182, v164, v165
  v_cvt_pk_bf16_f32 v183, v166, v167
  v_exp_f32 v104, v104
  v_mfma_f32_32x32x16_bf16 v[120:135], a[40:43], v[28:31], v[56:71]
  v_exp_f32 v105, v105
  v_exp_f32 v106, v106
  v_exp_f32 v107, v107
  v_mfma_f32_32x32x16_bf16 v[120:135], a[36:39], v[232:235], v[120:135]
  v_cvt_pk_bf16_f32 v184, v104, v105
  v_exp_f32 v108, v108
  v_exp_f32 v109, v109
  v_cvt_pk_bf16_f32 v185, v106, v107
  v_exp_f32 v110, v110
  v_exp_f32 v111, v111
  v_cvt_pk_bf16_f32 v186, v108, v109
  v_exp_f32 v112, v112
  v_exp_f32 v113, v113
  v_cvt_pk_bf16_f32 v187, v110, v111
  v_exp_f32 v114, v114
  v_exp_f32 v115, v115
  v_mfma_f32_32x32x16_bf16 v[88:103], a[100:103], v[176:179], v[88:103]
  v_cvt_pk_bf16_f32 v188, v112, v113
  v_exp_f32 v116, v116
  v_exp_f32 v117, v117
  v_mfma_f32_32x32x16_bf16 v[88:103], a[104:107], v[180:183], v[88:103]
  v_cvt_pk_bf16_f32 v189, v114, v115
  v_exp_f32 v118, v118
  v_exp_f32 v119, v119
  v_cvt_pk_bf16_f32 v190, v116, v117
  v_cvt_pk_bf16_f32 v191, v118, v119
  v_exp_f32 v120, v120
  s_waitcnt vmcnt(6)
  v_mfma_f32_32x32x16_bf16 v[136:151], a[44:47], v[24:27], v[40:55]
  v_exp_f32 v121, v121
  v_exp_f32 v122, v122
  v_exp_f32 v123, v123
  v_mfma_f32_32x32x16_bf16 v[136:151], a[36:39], v[228:231], v[136:151]
  v_cvt_pk_bf16_f32 v192, v120, v121
  v_exp_f32 v124, v124
  v_exp_f32 v125, v125
  v_cvt_pk_bf16_f32 v193, v122, v123
  v_exp_f32 v126, v126
  v_exp_f32 v127, v127
  v_cvt_pk_bf16_f32 v194, v124, v125
  v_exp_f32 v128, v128
  v_exp_f32 v129, v129
  v_cvt_pk_bf16_f32 v195, v126, v127
  v_exp_f32 v130, v130
  v_exp_f32 v131, v131
  s_waitcnt vmcnt(4)
  v_mfma_f32_32x32x16_bf16 v[72:87], a[108:111], v[184:187], v[72:87]
  v_cvt_pk_bf16_f32 v196, v128, v129
  v_exp_f32 v132, v132
  v_exp_f32 v133, v133
  v_mfma_f32_32x32x16_bf16 v[72:87], a[112:115], v[188:191], v[72:87]
  v_cvt_pk_bf16_f32 v197, v130, v131
  v_exp_f32 v134, v134
  v_exp_f32 v135, v135
  v_cvt_pk_bf16_f32 v198, v132, v133
  v_cvt_pk_bf16_f32 v199, v134, v135
  v_exp_f32 v136, v136
  v_mfma_f32_32x32x16_bf16 v[152:167], a[44:47], v[28:31], v[56:71]
  v_exp_f32 v137, v137
  v_exp_f32 v138, v138
  v_exp_f32 v139, v139
  v_mfma_f32_32x32x16_bf16 v[152:167], a[36:39], v[236:239], v[152:167]
  v_cvt_pk_bf16_f32 v168, v136, v137
  v_exp_f32 v140, v140
  v_exp_f32 v141, v141
  v_cvt_pk_bf16_f32 v169, v138, v139
  v_exp_f32 v142, v142
  v_exp_f32 v143, v143
  v_cvt_pk_bf16_f32 v170, v140, v141
  v_exp_f32 v144, v144
  v_exp_f32 v145, v145
  v_cvt_pk_bf16_f32 v171, v142, v143
  v_exp_f32 v146, v146
  v_exp_f32 v147, v147
  v_mfma_f32_32x32x16_bf16 v[88:103], a[108:111], v[192:195], v[88:103]
  v_cvt_pk_bf16_f32 v172, v144, v145
  v_exp_f32 v148, v148
  v_exp_f32 v149, v149
  v_mfma_f32_32x32x16_bf16 v[88:103], a[112:115], v[196:199], v[88:103]
  v_cvt_pk_bf16_f32 v173, v146, v147
  v_exp_f32 v150, v150
  v_exp_f32 v151, v151
  v_cvt_pk_bf16_f32 v174, v148, v149
  v_cvt_pk_bf16_f32 v175, v150, v151
  v_exp_f32 v152, v152
  v_exp_f32 v153, v153
  v_exp_f32 v154, v154
  v_exp_f32 v155, v155
  v_cvt_pk_bf16_f32 v176, v152, v153
  v_exp_f32 v156, v156
  v_exp_f32 v157, v157
  v_cvt_pk_bf16_f32 v177, v154, v155
  v_exp_f32 v158, v158
  v_exp_f32 v159, v159
  v_cvt_pk_bf16_f32 v178, v156, v157
  v_exp_f32 v160, v160
  v_exp_f32 v161, v161
  s_waitcnt vmcnt(2)
  v_mfma_f32_32x32x16_bf16 v[72:87], a[116:119], v[168:171], v[72:87]
  v_cvt_pk_bf16_f32 v179, v158, v159
  v_exp_f32 v162, v162
  v_exp_f32 v163, v163
  v_cvt_pk_bf16_f32 v180, v160, v161
  v_exp_f32 v164, v164
  v_mfma_f32_32x32x16_bf16 v[72:87], a[120:123], v[172:175], v[72:87]
  v_exp_f32 v165, v165
  v_cvt_pk_bf16_f32 v181, v162, v163
  v_exp_f32 v166, v166
  v_exp_f32 v167, v167
  v_cvt_pk_bf16_f32 v182, v164, v165
  v_cvt_pk_bf16_f32 v183, v166, v167
  s_nop 1
  v_mfma_f32_32x32x16_bf16 v[88:103], a[116:119], v[176:179], v[88:103]
  v_mfma_f32_32x32x16_bf16 v[88:103], a[120:123], v[180:183], v[88:103]
  s_nop 5
  v_mov_b32 v208, 0x4e800000
  v_mov_b32 v209, 0x7b800000
  v_mov_b32 v201, v82
  v_max3_f32 v202, |v72|, |v73|, |v74|
  v_max3_f32 v203, |v75|, |v76|, |v77|
  v_permlane32_swap_b32 v82, v201
  v_max3_f32 v202, |v78|, |v79|, v202
  v_max3_f32 v203, |v80|, |v81|, v203
  v_max_f32 v202, v202, v203
  v_cmp_nlt_f32 s[24:25], v82, v208
  v_cmp_nlt_f32 vcc, v202, v209
  v_rcp_f32 v200, v82
  s_nop 1
  s_or_b64 s[24:25], s[24:25], vcc
  v_mov_b32 v205, v98
  v_max3_f32 v206, |v88|, |v89|, |v90|
  v_max3_f32 v207, |v91|, |v92|, |v93|
  v_permlane32_swap_b32 v98, v205
  v_max3_f32 v206, |v94|, |v95|, v206
  v_max3_f32 v207, |v96|, |v97|, v207
  v_max_f32 v206, v206, v207
  v_cmp_nlt_f32 s[26:27], v98, v208
  v_cmp_nlt_f32 vcc, v206, v209
  v_rcp_f32 v204, v98
  s_nop 1
  s_or_b64 s[26:27], s[26:27], vcc
  s_or_b64 s[24:25], s[24:25], s[26:27]
  s_cselect_b32 s24, 1, 0
  s_cmp_gt_u32 s24, s15
  s_cbranch_scc1 att_full
  v_mul_f32 v72, v72, v200
  v_mul_f32 v73, v73, v200
  v_mul_f32 v74, v74, v200
  v_mul_f32 v75, v75, v200
  v_mul_f32 v76, v76, v200
  v_mul_f32 v77, v77, v200
  v_mul_f32 v78, v78, v200
  v_mul_f32 v79, v79, v200
  v_mul_f32 v80, v80, v200
  v_mul_f32 v81, v81, v200
  v_cvt_pk_bf16_f32 v40, v72, v73
  v_cvt_pk_bf16_f32 v41, v74, v75
  v_cvt_pk_bf16_f32 v42, v76, v77
  v_cvt_pk_bf16_f32 v43, v78, v79
  v_cvt_pk_bf16_f32 v44, v80, v81
  buffer_store_dwordx4 v[40:43], v6, s[16:19], s88 offen offset:0 sc1
  buffer_store_dword v44, v7, s[16:19], s89 offen offset:0 sc1
  v_mul_f32 v88, v88, v204
  v_mul_f32 v89, v89, v204
  v_mul_f32 v90, v90, v204
  v_mul_f32 v91, v91, v204
  v_mul_f32 v92, v92, v204
  v_mul_f32 v93, v93, v204
  v_mul_f32 v94, v94, v204
  v_mul_f32 v95, v95, v204
  v_mul_f32 v96, v96, v204
  v_mul_f32 v97, v97, v204
  v_cvt_pk_bf16_f32 v48, v88, v89
  v_cvt_pk_bf16_f32 v49, v90, v91
  v_cvt_pk_bf16_f32 v50, v92, v93
  v_cvt_pk_bf16_f32 v51, v94, v95
  v_cvt_pk_bf16_f32 v52, v96, v97
  buffer_store_dwordx4 v[48:51], v6, s[16:19], s88 offen offset:512 sc1
  buffer_store_dword v52, v7, s[16:19], s89 offen offset:128 sc1
  s_mul_i32 s26, s20, 23552
  s_add_u32 s27, s26, 0
  s_mov_b32 m0, s27
  s_add_u32 s27, s27, 0x1000
  buffer_load_dwordx4 v1, s[8:11], s26 offen sc1 lds
  buffer_load_dwordx4 v1, s[8:11], s26 offen offset:1024 sc1 lds
  buffer_load_dwordx4 v1, s[8:11], s26 offen offset:2048 sc1 lds
  buffer_load_dwordx4 v1, s[8:11], s26 offen offset:3072 sc1 lds
  s_add_u32 s26, s26, 0x1000
  s_mov_b32 m0, s27
  s_add_u32 s27, s27, 0x1000
  buffer_load_dwordx4 v1, s[8:11], s26 offen sc1 lds
  buffer_load_dwordx4 v1, s[8:11], s26 offen offset:1024 sc1 lds
  buffer_load_dwordx4 v1, s[8:11], s26 offen offset:2048 sc1 lds
  buffer_load_dwordx4 v1, s[8:11], s26 offen offset:3072 sc1 lds
  s_add_u32 s26, s26, 0x1000
  s_waitcnt vmcnt(8)
  s_barrier
  s_cmp_lg_u32 s20, 0
  s_cbranch_scc1 pub6
  s_lshl_b32 s23, s21, 3
  s_add_u32 s23, s23, s22
  s_lshl_b32 s23, s23, 6
  s_add_u32 s23, s23, 32768
  s_add_u32 s23, s23, s14
  s_mov_b64 exec, 1
  v_mov_b32 v9, 0
  v_mov_b32 v10, s90
  v_mov_b32 v11, s91
  buffer_store_dwordx2 v[10:11], v9, s[92:95], s23 offen sc1
  s_mov_b64 exec, -1
pub6:
  s_mov_b32 m0, s27
  s_add_u32 s27, s27, 0x1000
  buffer_load_dwordx4 v1, s[8:11], s26 offen sc1 lds
  buffer_load_dwordx4 v1, s[8:11], s26 offen offset:1024 sc1 lds
  buffer_load_dwordx4 v1, s[8:11], s26 offen offset:2048 sc1 lds
  buffer_load_dwordx4 v1, s[8:11], s26 offen offset:3072 sc1 lds
  s_add_u32 s26, s26, 0x1000
  s_mov_b32 m0, s27
  s_add_u32 s27, s27, 0x1000
  buffer_load_dwordx4 v1, s[8:11], s26 offen sc1 lds
  buffer_load_dwordx4 v1, s[8:11], s26 offen offset:1024 sc1 lds
  buffer_load_dwordx4 v1, s[8:11], s26 offen offset:2048 sc1 lds
  buffer_load_dwordx4 v1, s[8:11], s26 offen offset:3072 sc1 lds
  s_add_u32 s26, s26, 0x1000
  s_mov_b32 m0, s27
  s_add_u32 s27, s27, 0x1000
  buffer_load_dwordx4 v1, s[8:11], s26 offen sc1 lds
  buffer_load_dwordx4 v1, s[8:11], s26 offen offset:1024 sc1 lds
  buffer_load_dwordx4 v1, s[8:11], s26 offen offset:2048 sc1 lds
  buffer_load_dwordx4 v1, s[8:11], s26 offen offset:3072 sc1 lds
  s_add_u32 s26, s26, 0x1000
  s_mov_b32 m0, s27
  s_add_u32 s27, s27, 0x1000
  buffer_load_dwordx4 v1, s[8:11], s26 offen sc1 lds
  s_cmp_eq_u32 s20, 3
  s_cbranch_scc1 wo_dsk
  buffer_load_dwordx4 v1, s[8:11], s26 offen offset:1024 sc1 lds
  buffer_load_dwordx4 v1, s[8:11], s26 offen offset:2048 sc1 lds
wo_dsk:
  s_bfe_u32 s22, s2, 0x30003
  s_and_b32 s45, s2, 7
  s_lshr_b32 s44, s2, 6
  s_lshl_b32 s21, s45, 2
  s_add_u32 s21, s21, s44
  v_lshrrev_b32 v16, 4, v0
  v_and_b32 v17, 15, v0
  s_lshl_b32 s38, s20, 4
  v_add_u32 v18, s38, v17
  v_lshlrev_b32 v2, 10, v16
  v_lshl_add_u32 v8, v18, 2, v2
  v_lshl_add_u32 v2, v18, 4, v2
  s_mul_i32 s39, s21, 73728
  s_add_u32 s41, s39, s3
  s_add_u32 s42, s41, 0x00800000
  s_add_u32 s4, s96, s42
  s_addc_u32 s5, s97, 0
  s_mov_b32 s6, 0x00012000
  s_mov_b32 s7, 0x00020000
  s_add_u32 s42, s96, 0x00e00000
  s_addc_u32 s43, s97, 0
  s_cmp_eq_u32 s3, 0
  s_cselect_b32 s8, s98, s42
  s_cselect_b32 s9, s99, s43
  s_cselect_b64 vcc, -1, 0
  s_cselect_b32 s36, 32, 2048
  s_mul_i32 s46, s22, 9216
  s_mul_i32 s37, s22, 144
  s_cselect_b32 s45, s37, s46
  s_add_u32 s8, s8, s39
  s_addc_u32 s9, s9, 0
  s_mov_b32 s10, 0x00012000
  s_mov_b32 s11, 0x00020000
  v_mul_u32_u24 v22, 1152, v18
  v_lshl_add_u32 v22, v16, 3, v22
  v_lshrrev_b32 v19, 1, v16
  v_and_b32 v20, 1, v16
  v_lshlrev_b32 v23, 4, v18
  v_lshl_add_u32 v21, v20, 3, v23
  v_lshl_add_u32 v21, v19, 10, v21
  v_cndmask_b32 v5, v21, v22, vcc
  s_mov_b64 s[48:49], s[8:9]
  s_mov_b64 s[50:51], s[10:11]
  v_add_u32 v3, 0, v1
  v_add_u32 v4, 61440, v1
  v_lshl_add_u32 v22, v20, 1, v19
  v_lshl_add_u32 v6, v22, 10, v23
  v_lshl_add_u32 v22, v16, 3, v23
  v_add_u32 v22, 8192, v22
  v_mov_b32 v21, 0x80000000
  v_cmp_gt_u32 vcc, 2, v16
  s_nop 1
  v_cndmask_b32 v7, v21, v22, vcc
  s_add_u32 s42, s41, 0x00b00000
  s_add_u32 s16, s96, s42
  s_addc_u32 s17, s97, 0
  s_mov_b32 s18, 0x00012000
  s_mov_b32 s19, 0x00020000
  s_add_u32 s47, s46, 4096
  s_mov_b32 s40, 0
  s_mov_b32 s29, 0x3f803f80
  v_cndmask_b32 v28, 0, -1, vcc
  v_lshlrev_b32 v22, 3, v18
  v_cmp_gt_u32 vcc, 16, v0
  s_lshl_b32 s42, s21, 3
  s_add_u32 s42, s42, s22
  s_lshl_b32 s42, s42, 9
  s_add_u32 s42, s42, s3
  s_add_u32 s42, s42, 0x02700000
  v_cndmask_b32 v29, v21, v22, vcc
  s_add_u32 s8, s96, s42
  s_addc_u32 s9, s97, 0
  s_mov_b32 s10, 0x00000200
  s_mov_b32 s11, 0x00020000
  s_waitcnt vmcnt(0)
  s_cmp_lg_u32 s20, 0
  s_cbranch_scc1 wt7_d
  v_and_b32 v9, 7, v0
  s_lshl_b32 s23, s21, 3
  v_add_u32 v9, s23, v9
  v_lshlrev_b32 v9, 6, v9
  s_add_u32 s23, s14, 0x00008000
  v_add_u32 v9, s23, v9
  s_and_b32 s31, s2, 7
  s_lshr_b32 s32, s2, 3
  s_lshr_b32 s35, s31, 1
  s_lshl_b32 s35, s35, 1
  s_and_b32 s33, s32, 1
  s_add_u32 s35, s35, s33
  s_lshr_b32 s30, s32, 1
  s_lshl_b32 s34, s30, 1
  s_and_b32 s33, s31, 1
  s_add_u32 s34, s34, s33
  v_and_b32 v10, 31, v0
  s_lshl_b32 s35, s35, 5
  v_add_u32 v10, s35, v10
  v_lshlrev_b32 v10, 3, v10
  v_add_u32 v10, 180224, v10
  v_cmp_gt_u32 vcc, 32, v0
  s_nop 1
  v_cndmask_b32 v9, v10, v9, vcc
  s_mov_b32 s23, 0x10000
wt7_l:
  buffer_load_dwordx2 v[10:11], v9, s[92:95], 0 offen sc1
  s_waitcnt vmcnt(0)
  v_cmp_ne_u64 vcc, s[90:91], v[10:11]
  s_sub_u32 s23, s23, 1
  s_cselect_b64 s[24:25], 0, -1
  s_nop 1
  s_and_b64 vcc, vcc, s[24:25]
  s_cbranch_vccnz wt7_l
wt7_d:
  s_barrier
  buffer_load_dwordx4 v[108:111], v2, s[4:7], s40 offen sc1
  s_add_u32 s40, s40, 0x1000
  buffer_load_dwordx4 v[112:115], v2, s[4:7], s40 offen sc1
  s_add_u32 s40, s40, 0x1000
  buffer_load_dwordx4 v[116:119], v2, s[4:7], s40 offen sc1
  s_add_u32 s40, s40, 0x1000
  buffer_load_dwordx4 v[120:123], v2, s[4:7], s40 offen sc1
  s_add_u32 s40, s40, 0x1000
  buffer_load_dwordx4 v[124:127], v2, s[4:7], s40 offen sc1
  s_add_u32 s40, s40, 0x1000
  buffer_load_dwordx4 v[128:131], v2, s[4:7], s40 offen sc1
  s_add_u32 s40, s40, 0x1000
  buffer_load_dwordx4 v[132:135], v2, s[4:7], s40 offen sc1
  s_add_u32 s40, s40, 0x1000
  buffer_load_dwordx4 v[136:139], v2, s[4:7], s40 offen sc1
  s_add_u32 s40, s40, 0x1000
  buffer_load_dwordx4 v[140:143], v2, s[4:7], s40 offen sc1
  s_add_u32 s40, s40, 0x1000
  buffer_load_dwordx4 v[144:147], v2, s[4:7], s40 offen sc1
  s_add_u32 s40, s40, 0x1000
  buffer_load_dwordx4 v[148:151], v2, s[4:7], s40 offen sc1
  s_add_u32 s40, s40, 0x1000
  buffer_load_dwordx4 v[152:155], v2, s[4:7], s40 offen sc1
  s_add_u32 s40, s40, 0x1000
  buffer_load_dwordx4 v[156:159], v2, s[4:7], s40 offen sc1
  s_add_u32 s40, s40, 0x1000
  buffer_load_dwordx4 v[160:163], v2, s[4:7], s40 offen sc1
  s_add_u32 s40, s40, 0x1000
  buffer_load_dwordx4 v[164:167], v2, s[4:7], s40 offen sc1
  s_add_u32 s40, s40, 0x1000
  buffer_load_dwordx4 v[168:171], v2, s[4:7], s40 offen sc1
  s_add_u32 s40, s40, 0x1000
  buffer_load_dword v172, v8, s[4:7], s40 offen offset:0 sc1
  buffer_load_dword v173, v8, s[4:7], s40 offen offset:256 sc1
  buffer_load_dword v174, v8, s[4:7], s40 offen offset:512 sc1
  buffer_load_dword v175, v8, s[4:7], s40 offen offset:768 sc1
  s_add_u32 s40, s40, 0x1000
  buffer_load_dword v176, v8, s[4:7], s40 offen offset:0 sc1
  buffer_load_dword v177, v8, s[4:7], s40 offen offset:256 sc1
  buffer_load_dword v178, v8, s[4:7], s40 offen offset:512 sc1
  buffer_load_dword v179, v8, s[4:7], s40 offen offset:768 sc1
  ds_read_b128 v[184:187], v3 offset:0
  ds_read_b128 v[188:191], v3 offset:1024
  ds_read_b128 v[192:195], v3 offset:2048
  ds_read_b128 v[196:199], v3 offset:3072
  ds_read_b128 v[200:203], v3 offset:4096
  ds_read_b128 v[204:207], v3 offset:5120
  ds_read_b128 v[208:211], v3 offset:6144
  ds_read_b128 v[212:215], v3 offset:7168
  ds_read_b128 v[216:219], v3 offset:8192
  ds_read_b128 v[220:223], v3 offset:9216
  s_waitcnt vmcnt(23) lgkmcnt(5)
  v_mfma_f32_16x16x32_bf16 v[36:39], v[184:187], v[108:111], 0
  ds_read_b128 v[224:227], v3 offset:10240
  v_mfma_f32_16x16x32_bf16 v[40:43], v[188:191], v[108:111], 0
  ds_read_b128 v[228:231], v3 offset:11264
  v_mfma_f32_16x16x32_bf16 v[44:47], v[192:195], v[108:111], 0
  ds_read_b128 v[232:235], v3 offset:12288
  v_mfma_f32_16x16x32_bf16 v[48:51], v[196:199], v[108:111], 0
  ds_read_b128 v[236:239], v3 offset:13312
  v_mfma_f32_16x16x32_bf16 v[52:55], v[200:203], v[108:111], 0
  ds_read_b128 v[240:243], v3 offset:14336
  buffer_load_dwordx2 v[56:57], v5, s[48:51], s45 offen sc1
  s_add_u32 s45, s45, s36
  s_waitcnt vmcnt(23) lgkmcnt(5)
  v_mfma_f32_16x16x32_bf16 v[36:39], v[204:207], v[112:115], v[36:39]
  ds_read_b128 v[184:187], v3 offset:15360
  v_mfma_f32_16x16x32_bf16 v[40:43], v[208:211], v[112:115], v[40:43]
  ds_read_b128 v[188:191], v3 offset:16384
  v_mfma_f32_16x16x32_bf16 v[44:47], v[212:215], v[112:115], v[44:47]
  ds_read_b128 v[192:195], v3 offset:17408
  v_mfma_f32_16x16x32_bf16 v[48:51], v[216:219], v[112:115], v[48:51]
  ds_read_b128 v[196:199], v3 offset:18432
  v_mfma_f32_16x16x32_bf16 v[52:55], v[220:223], v[112:115], v[52:55]
  ds_read_b128 v[200:203], v3 offset:19456
  buffer_load_dwordx2 v[58:59], v5, s[48:51], s45 offen sc1
  s_add_u32 s45, s45, s36
  s_waitcnt vmcnt(23) lgkmcnt(5)
  v_mfma_f32_16x16x32_bf16 v[36:39], v[224:227], v[116:119], v[36:39]
  ds_read_b128 v[204:207], v3 offset:20480
  v_mfma_f32_16x16x32_bf16 v[40:43], v[228:231], v[116:119], v[40:43]
  ds_read_b128 v[208:211], v3 offset:21504
  v_mfma_f32_16x16x32_bf16 v[44:47], v[232:235], v[116:119], v[44:47]
  ds_read_b128 v[212:215], v3 offset:22528
  v_mfma_f32_16x16x32_bf16 v[48:51], v[236:239], v[116:119], v[48:51]
  ds_read_b128 v[216:219], v3 offset:23552
  v_mfma_f32_16x16x32_bf16 v[52:55], v[240:243], v[116:119], v[52:55]
  ds_read_b128 v[220:223], v3 offset:24576
  buffer_load_dwordx2 v[60:61], v5, s[48:51], s45 offen sc1
  s_add_u32 s45, s45, s36
  s_waitcnt vmcnt(23) lgkmcnt(5)
  v_mfma_f32_16x16x32_bf16 v[36:39], v[184:187], v[120:123], v[36:39]
  ds_read_b128 v[224:227], v3 offset:25600
  v_mfma_f32_16x16x32_bf16 v[40:43], v[188:191], v[120:123], v[40:43]
  ds_read_b128 v[228:231], v3 offset:26624
  v_mfma_f32_16x16x32_bf16 v[44:47], v[192:195], v[120:123], v[44:47]
  ds_read_b128 v[232:235], v3 offset:27648
  v_mfma_f32_16x16x32_bf16 v[48:51], v[196:199], v[120:123], v[48:51]
  ds_read_b128 v[236:239], v3 offset:28672
  v_mfma_f32_16x16x32_bf16 v[52:55], v[200:203], v[120:123], v[52:55]
  ds_read_b128 v[240:243], v3 offset:29696
  buffer_load_dwordx2 v[62:63], v5, s[48:51], s45 offen sc1
  s_add_u32 s45, s45, s36
  s_waitcnt vmcnt(23) lgkmcnt(5)
  v_mfma_f32_16x16x32_bf16 v[36:39], v[204:207], v[124:127], v[36:39]
  ds_read_b128 v[184:187], v3 offset:30720
  v_mfma_f32_16x16x32_bf16 v[40:43], v[208:211], v[124:127], v[40:43]
  ds_read_b128 v[188:191], v3 offset:31744
  v_mfma_f32_16x16x32_bf16 v[44:47], v[212:215], v[124:127], v[44:47]
  ds_read_b128 v[192:195], v3 offset:32768
  v_mfma_f32_16x16x32_bf16 v[48:51], v[216:219], v[124:127], v[48:51]
  ds_read_b128 v[196:199], v3 offset:33792
  v_mfma_f32_16x16x32_bf16 v[52:55], v[220:223], v[124:127], v[52:55]
  ds_read_b128 v[200:203], v3 offset:34816
  buffer_load_dwordx2 v[64:65], v5, s[48:51], s45 offen sc1
  s_add_u32 s45, s45, s36
  s_waitcnt vmcnt(23) lgkmcnt(5)
  v_mfma_f32_16x16x32_bf16 v[36:39], v[224:227], v[128:131], v[36:39]
  ds_read_b128 v[204:207], v3 offset:35840
  v_mfma_f32_16x16x32_bf16 v[40:43], v[228:231], v[128:131], v[40:43]
  ds_read_b128 v[208:211], v3 offset:36864
  v_mfma_f32_16x16x32_bf16 v[44:47], v[232:235], v[128:131], v[44:47]
  ds_read_b128 v[212:215], v3 offset:37888
  v_mfma_f32_16x16x32_bf16 v[48:51], v[236:239], v[128:131], v[48:51]
  ds_read_b128 v[216:219], v3 offset:38912
  v_mfma_f32_16x16x32_bf16 v[52:55], v[240:243], v[128:131], v[52:55]
  ds_read_b128 v[220:223], v3 offset:39936
  s_waitcnt vmcnt(22) lgkmcnt(5)
  v_mfma_f32_16x16x32_bf16 v[36:39], v[184:187], v[132:135], v[36:39]
  ds_read_b128 v[224:227], v3 offset:40960
  v_mfma_f32_16x16x32_bf16 v[40:43], v[188:191], v[132:135], v[40:43]
  ds_read_b128 v[228:231], v3 offset:41984
  v_mfma_f32_16x16x32_bf16 v[44:47], v[192:195], v[132:135], v[44:47]
  ds_read_b128 v[232:235], v3 offset:43008
  v_mfma_f32_16x16x32_bf16 v[48:51], v[196:199], v[132:135], v[48:51]
  ds_read_b128 v[236:239], v3 offset:44032
  v_mfma_f32_16x16x32_bf16 v[52:55], v[200:203], v[132:135], v[52:55]
  ds_read_b128 v[240:243], v3 offset:45056
  s_waitcnt vmcnt(21) lgkmcnt(5)
  v_mfma_f32_16x16x32_bf16 v[36:39], v[204:207], v[136:139], v[36:39]
  ds_read_b128 v[184:187], v3 offset:46080
  v_mfma_f32_16x16x32_bf16 v[40:43], v[208:211], v[136:139], v[40:43]
  ds_read_b128 v[188:191], v3 offset:47104
  v_mfma_f32_16x16x32_bf16 v[44:47], v[212:215], v[136:139], v[44:47]
  ds_read_b128 v[192:195], v3 offset:48128
  v_mfma_f32_16x16x32_bf16 v[48:51], v[216:219], v[136:139], v[48:51]
  ds_read_b128 v[196:199], v3 offset:49152
  v_mfma_f32_16x16x32_bf16 v[52:55], v[220:223], v[136:139], v[52:55]
  ds_read_b128 v[200:203], v3 offset:50176
  s_waitcnt vmcnt(20) lgkmcnt(5)
  v_mfma_f32_16x16x32_bf16 v[36:39], v[224:227], v[140:143], v[36:39]
  ds_read_b128 v[204:207], v3 offset:51200
  v_mfma_f32_16x16x32_bf16 v[40:43], v[228:231], v[140:143], v[40:43]
  ds_read_b128 v[208:211], v3 offset:52224
  v_mfma_f32_16x16x32_bf16 v[44:47], v[232:235], v[140:143], v[44:47]
  ds_read_b128 v[212:215], v3 offset:53248
  v_mfma_f32_16x16x32_bf16 v[48:51], v[236:239], v[140:143], v[48:51]
  ds_read_b128 v[216:219], v3 offset:54272
  v_mfma_f32_16x16x32_bf16 v[52:55], v[240:243], v[140:143], v[52:55]
  ds_read_b128 v[220:223], v3 offset:55296
  s_waitcnt vmcnt(19) lgkmcnt(5)
  v_mfma_f32_16x16x32_bf16 v[36:39], v[184:187], v[144:147], v[36:39]
  ds_read_b128 v[224:227], v3 offset:56320
  v_mfma_f32_16x16x32_bf16 v[40:43], v[188:191], v[144:147], v[40:43]
  ds_read_b128 v[228:231], v3 offset:57344
  v_mfma_f32_16x16x32_bf16 v[44:47], v[192:195], v[144:147], v[44:47]
  ds_read_b128 v[232:235], v3 offset:58368
  v_mfma_f32_16x16x32_bf16 v[48:51], v[196:199], v[144:147], v[48:51]
  ds_read_b128 v[236:239], v3 offset:59392
  v_mfma_f32_16x16x32_bf16 v[52:55], v[200:203], v[144:147], v[52:55]
  ds_read_b128 v[240:243], v3 offset:60416
  s_waitcnt vmcnt(18) lgkmcnt(5)
  v_mfma_f32_16x16x32_bf16 v[36:39], v[204:207], v[148:151], v[36:39]
  ds_read_b128 v[184:187], v4 offset:0
  v_mfma_f32_16x16x32_bf16 v[40:43], v[208:211], v[148:151], v[40:43]
  ds_read_b128 v[188:191], v4 offset:1024
  v_mfma_f32_16x16x32_bf16 v[44:47], v[212:215], v[148:151], v[44:47]
  ds_read_b128 v[192:195], v4 offset:2048
  v_mfma_f32_16x16x32_bf16 v[48:51], v[216:219], v[148:151], v[48:51]
  ds_read_b128 v[196:199], v4 offset:3072
  v_mfma_f32_16x16x32_bf16 v[52:55], v[220:223], v[148:151], v[52:55]
  ds_read_b128 v[200:203], v4 offset:4096
  s_waitcnt vmcnt(17) lgkmcnt(5)
  v_mfma_f32_16x16x32_bf16 v[36:39], v[224:227], v[152:155], v[36:39]
  ds_read_b128 v[204:207], v4 offset:5120
  v_mfma_f32_16x16x32_bf16 v[40:43], v[228:231], v[152:155], v[40:43]
  ds_read_b128 v[208:211], v4 offset:6144
  v_mfma_f32_16x16x32_bf16 v[44:47], v[232:235], v[152:155], v[44:47]
  ds_read_b128 v[212:215], v4 offset:7168
  v_mfma_f32_16x16x32_bf16 v[48:51], v[236:239], v[152:155], v[48:51]
  ds_read_b128 v[216:219], v4 offset:8192
  v_mfma_f32_16x16x32_bf16 v[52:55], v[240:243], v[152:155], v[52:55]
  ds_read_b128 v[220:223], v4 offset:9216
  s_waitcnt vmcnt(16) lgkmcnt(5)
  v_mfma_f32_16x16x32_bf16 v[36:39], v[184:187], v[156:159], v[36:39]
  ds_read_b128 v[224:227], v4 offset:10240
  v_mfma_f32_16x16x32_bf16 v[40:43], v[188:191], v[156:159], v[40:43]
  ds_read_b128 v[228:231], v4 offset:11264
  v_mfma_f32_16x16x32_bf16 v[44:47], v[192:195], v[156:159], v[44:47]
  ds_read_b128 v[232:235], v4 offset:12288
  v_mfma_f32_16x16x32_bf16 v[48:51], v[196:199], v[156:159], v[48:51]
  ds_read_b128 v[236:239], v4 offset:13312
  v_mfma_f32_16x16x32_bf16 v[52:55], v[200:203], v[156:159], v[52:55]
  ds_read_b128 v[240:243], v4 offset:14336
  s_waitcnt vmcnt(15) lgkmcnt(5)
  v_mfma_f32_16x16x32_bf16 v[36:39], v[204:207], v[160:163], v[36:39]
  ds_read_b128 v[184:187], v4 offset:15360
  v_mfma_f32_16x16x32_bf16 v[40:43], v[208:211], v[160:163], v[40:43]
  ds_read_b128 v[188:191], v4 offset:16384
  v_mfma_f32_16x16x32_bf16 v[44:47], v[212:215], v[160:163], v[44:47]
  ds_read_b128 v[192:195], v4 offset:17408
  v_mfma_f32_16x16x32_bf16 v[48:51], v[216:219], v[160:163], v[48:51]
  ds_read_b128 v[196:199], v4 offset:18432
  v_mfma_f32_16x16x32_bf16 v[52:55], v[220:223], v[160:163], v[52:55]
  ds_read_b128 v[200:203], v4 offset:19456
  s_waitcnt vmcnt(14) lgkmcnt(5)
  v_mfma_f32_16x16x32_bf16 v[36:39], v[224:227], v[164:167], v[36:39]
  ds_read_b128 v[204:207], v4 offset:20480
  v_mfma_f32_16x16x32_bf16 v[40:43], v[228:231], v[164:167], v[40:43]
  ds_read_b128 v[208:211], v4 offset:21504
  v_mfma_f32_16x16x32_bf16 v[44:47], v[232:235], v[164:167], v[44:47]
  ds_read_b128 v[212:215], v4 offset:22528
  v_mfma_f32_16x16x32_bf16 v[48:51], v[236:239], v[164:167], v[48:51]
  ds_read_b128 v[216:219], v4 offset:23552
  v_mfma_f32_16x16x32_bf16 v[52:55], v[240:243], v[164:167], v[52:55]
  ds_read_b128 v[220:223], v4 offset:24576
  s_waitcnt vmcnt(13) lgkmcnt(5)
  v_mfma_f32_16x16x32_bf16 v[36:39], v[184:187], v[168:171], v[36:39]
  ds_read_b128 v[224:227], v4 offset:25600
  v_mfma_f32_16x16x32_bf16 v[40:43], v[188:191], v[168:171], v[40:43]
  ds_read_b128 v[228:231], v4 offset:26624
  v_mfma_f32_16x16x32_bf16 v[44:47], v[192:195], v[168:171], v[44:47]
  ds_read_b128 v[232:235], v4 offset:27648
  v_mfma_f32_16x16x32_bf16 v[48:51], v[196:199], v[168:171], v[48:51]
  ds_read_b128 v[236:239], v4 offset:28672
  v_mfma_f32_16x16x32_bf16 v[52:55], v[200:203], v[168:171], v[52:55]
  ds_read_b128 v[240:243], v4 offset:29696
  s_waitcnt vmcnt(9) lgkmcnt(5)
  v_mfma_f32_16x16x32_bf16 v[36:39], v[204:207], v[172:175], v[36:39]
  v_mfma_f32_16x16x32_bf16 v[40:43], v[208:211], v[172:175], v[40:43]
  v_mfma_f32_16x16x32_bf16 v[44:47], v[212:215], v[172:175], v[44:47]
  v_mfma_f32_16x16x32_bf16 v[48:51], v[216:219], v[172:175], v[48:51]
  v_mfma_f32_16x16x32_bf16 v[52:55], v[220:223], v[172:175], v[52:55]
  s_waitcnt vmcnt(5) lgkmcnt(0)
  v_mfma_f32_16x16x32_bf16 v[36:39], v[224:227], v[176:179], v[36:39]
  v_mfma_f32_16x16x32_bf16 v[40:43], v[228:231], v[176:179], v[40:43]
  v_mfma_f32_16x16x32_bf16 v[44:47], v[232:235], v[176:179], v[44:47]
  v_mfma_f32_16x16x32_bf16 v[48:51], v[236:239], v[176:179], v[48:51]
  v_mfma_f32_16x16x32_bf16 v[52:55], v[240:243], v[176:179], v[52:55]
wo_epi:
  s_waitcnt vmcnt(0)
  v_lshlrev_b32 v16, 16, v56
  v_and_b32 v17, 0xffff0000, v56
  v_lshlrev_b32 v18, 16, v57
  v_and_b32 v19, 0xffff0000, v57
  s_nop 3
  v_add_f32 v36, v36, v16
  v_add_f32 v37, v37, v17
  v_add_f32 v38, v38, v18
  v_add_f32 v39, v39, v19
  v_lshlrev_b32 v20, 16, v58
  v_and_b32 v21, 0xffff0000, v58
  v_lshlrev_b32 v22, 16, v59
  v_and_b32 v23, 0xffff0000, v59
  v_add_f32 v40, v40, v20
  v_add_f32 v41, v41, v21
  v_add_f32 v42, v42, v22
  v_add_f32 v43, v43, v23
  v_lshlrev_b32 v16, 16, v60
  v_and_b32 v17, 0xffff0000, v60
  v_lshlrev_b32 v18, 16, v61
  v_and_b32 v19, 0xffff0000, v61
  v_add_f32 v44, v44, v16
  v_add_f32 v45, v45, v17
  v_add_f32 v46, v46, v18
  v_add_f32 v47, v47, v19
  v_lshlrev_b32 v20, 16, v62
  v_and_b32 v21, 0xffff0000, v62
  v_lshlrev_b32 v22, 16, v63
  v_and_b32 v23, 0xffff0000, v63
  v_add_f32 v48, v48, v20
  v_add_f32 v49, v49, v21
  v_add_f32 v50, v50, v22
  v_add_f32 v51, v51, v23
  v_lshlrev_b32 v16, 16, v64
  v_and_b32 v17, 0xffff0000, v64
  v_lshlrev_b32 v18, 16, v65
  v_and_b32 v19, 0xffff0000, v65
  v_add_f32 v52, v52, v16
  v_add_f32 v53, v53, v17
  v_add_f32 v54, v54, v18
  v_add_f32 v55, v55, v19
  v_cvt_pk_bf16_f32 v108, v36, v37
  v_cvt_pk_bf16_f32 v109, v38, v39
  v_cvt_pk_bf16_f32 v110, v40, v41
  v_cvt_pk_bf16_f32 v111, v42, v43
  v_cvt_pk_bf16_f32 v112, v44, v45
  v_cvt_pk_bf16_f32 v113, v46, v47
  v_cvt_pk_bf16_f32 v114, v48, v49
  v_cvt_pk_bf16_f32 v115, v50, v51
  v_cvt_pk_bf16_f32 v116, v52, v53
  v_cvt_pk_bf16_f32 v117, v54, v55
  v_and_b32 v120, v116, v28
  v_and_b32 v121, v117, v28
  v_mov_b32 v24, 0
  v_mov_b32 v26, 0
  v_permlane16_swap_b32 v108, v110
  v_permlane16_swap_b32 v109, v111
  v_permlane16_swap_b32 v112, v114
  v_permlane16_swap_b32 v113, v115
  buffer_store_dwordx4 v[108:111], v6, s[16:19], s46 offen sc1
  buffer_store_dwordx4 v[112:115], v6, s[16:19], s47 offen sc1
  buffer_store_dwordx2 v[116:117], v7, s[16:19], s46 offen sc1
  v_dot2c_f32_bf16 v24, s29, v108
  v_dot2c_f32_bf16 v26, v108, v108
  v_dot2c_f32_bf16 v24, s29, v109
  v_dot2c_f32_bf16 v26, v109, v109
  v_dot2c_f32_bf16 v24, s29, v110
  v_dot2c_f32_bf16 v26, v110, v110
  v_dot2c_f32_bf16 v24, s29, v111
  v_dot2c_f32_bf16 v26, v111, v111
  v_dot2c_f32_bf16 v24, s29, v112
  v_dot2c_f32_bf16 v26, v112, v112
  v_dot2c_f32_bf16 v24, s29, v113
  v_dot2c_f32_bf16 v26, v113, v113
  v_dot2c_f32_bf16 v24, s29, v114
  v_dot2c_f32_bf16 v26, v114, v114
  v_dot2c_f32_bf16 v24, s29, v115
  v_dot2c_f32_bf16 v26, v115, v115
  v_dot2c_f32_bf16 v24, s29, v120
  v_dot2c_f32_bf16 v26, v120, v120
  v_dot2c_f32_bf16 v24, s29, v121
  v_dot2c_f32_bf16 v26, v121, v121
  s_nop 2
  v_mov_b32 v25, v24
  v_mov_b32 v27, v26
  s_nop 1
  v_permlane16_swap_b32 v24, v25
  v_permlane16_swap_b32 v26, v27
  s_nop 1
  v_add_f32 v24, v24, v25
  v_add_f32 v26, v26, v27
  v_mov_b32 v25, v24
  v_mov_b32 v27, v26
  s_nop 1
  v_permlane32_swap_b32 v24, v25
  v_permlane32_swap_b32 v26, v27
  s_nop 1
  v_add_f32 v24, v24, v25
  v_add_f32 v26, v26, v27
  v_mov_b32 v25, v26
  buffer_store_dwordx2 v[24:25], v29, s[8:11], 0 offen sc1
  s_and_b32 s31, s2, 7
  s_lshr_b32 s32, s2, 3
  s_lshr_b32 s35, s31, 1
  s_lshl_b32 s35, s35, 1
  s_and_b32 s33, s32, 1
  s_add_u32 s35, s35, s33
  s_lshr_b32 s30, s32, 1
  s_lshl_b32 s34, s30, 1
  s_and_b32 s33, s31, 1
  s_add_u32 s34, s34, s33
  s_lshl_b32 s24, s35, 2
  s_add_u32 s24, s24, s20
  s_mul_i32 s24, s24, 497664
  s_add_u32 s24, s24, 0x05000000
  s_add_u32 s4, s96, s24
  s_addc_u32 s5, s97, 0
  s_mov_b32 s6, 0x00079800
  s_mov_b32 s7, 0x00020000
  s_mov_b32 s23, 0
  buffer_load_dwordx4 v[112:115], v1, s[4:7], s23 offen sc1
  buffer_load_dwordx4 v[116:119], v1, s[4:7], s23 offen offset:1024 sc1
  buffer_load_dwordx4 v[120:123], v1, s[4:7], s23 offen offset:2048 sc1
  s_add_u32 s23, s23, 0xc00
  buffer_load_dwordx4 v[124:127], v1, s[4:7], s23 offen sc1
  buffer_load_dwordx4 v[128:131], v1, s[4:7], s23 offen offset:1024 sc1
  buffer_load_dwordx4 v[132:135], v1, s[4:7], s23 offen offset:2048 sc1
  s_add_u32 s23, s23, 0xc00
  buffer_load_dwordx4 v[136:139], v1, s[4:7], s23 offen sc1
  buffer_load_dwordx4 v[140:143], v1, s[4:7], s23 offen offset:1024 sc1
  buffer_load_dwordx4 v[144:147], v1, s[4:7], s23 offen offset:2048 sc1
  s_add_u32 s23, s23, 0xc00
  buffer_load_dwordx4 v[148:151], v1, s[4:7], s23 offen sc1
  buffer_load_dwordx4 v[152:155], v1, s[4:7], s23 offen offset:1024 sc1
  buffer_load_dwordx4 v[156:159], v1, s[4:7], s23 offen offset:2048 sc1
  s_add_u32 s23, s23, 0xc00
  s_waitcnt vmcnt(12)
  s_barrier
  s_cmp_lg_u32 s20, 0
  s_cbranch_scc1 pub8
  s_lshl_b32 s23, s21, 3
  s_add_u32 s23, s23, s22
  s_lshl_b32 s23, s23, 6
  s_add_u32 s23, s23, 49152
  s_add_u32 s23, s23, s14
  s_mov_b64 exec, 1
  v_mov_b32 v9, 0
  v_mov_b32 v10, s90
  v_mov_b32 v11, s91
  buffer_store_dwordx2 v[10:11], v9, s[92:95], s23 offen sc1
  s_mov_b64 exec, -1
pub8:
  s_and_b32 s45, s2, 7
  s_lshr_b32 s46, s2, 3
  s_lshr_b32 s22, s45, 1
  s_lshl_b32 s22, s22, 1
  s_and_b32 s47, s46, 1
  s_add_u32 s22, s22, s47
  s_lshr_b32 s44, s46, 1
  s_lshl_b32 s21, s44, 1
  s_and_b32 s47, s45, 1
  s_add_u32 s21, s21, s47
  s_mov_b32 s29, 0x3f803f80
  v_lshrrev_b32 v64, 4, v0
  v_and_b32 v65, 15, v0
  s_lshl_b32 s38, s20, 8
  v_lshlrev_b32 v66, 10, v64
  v_lshl_add_u32 v66, v65, 4, v66
  v_add_u32 v2, s38, v66
  s_mul_i32 s39, s21, 73728
  s_add_u32 s39, s39, s3
  s_add_u32 s39, s39, 0x00b00000
  s_add_u32 s8, s96, s39
  s_addc_u32 s9, s97, 0
  s_mov_b32 s10, 0x00012000
  s_mov_b32 s11, 0x00020000
  s_lshl_b32 s24, s22, 2
  s_add_u32 s24, s24, s20
  s_mul_i32 s24, s24, 497664
  s_add_u32 s24, s24, 0x05000000
  s_add_u32 s4, s96, s24
  s_addc_u32 s5, s97, 0
  s_mov_b32 s6, 0x00079800
  s_mov_b32 s7, 0x00020000
  s_lshl_b32 s41, s22, 5
  s_add_u32 s41, s41, s21
  s_mul_i32 s41, s41, 73728
  s_add_u32 s41, s41, s3
  s_add_u32 s41, s41, 0x01100000
  s_add_u32 s16, s96, s41
  s_addc_u32 s17, s97, 0
  s_mov_b32 s18, 0x00012000
  s_mov_b32 s19, 0x00020000
  s_mov_b32 s27, 0
  s_mov_b32 s40, 0
  v_and_b32 v68, 1, v64
  v_lshrrev_b32 v67, 1, v64
  v_add_u32 v3, 36864, v1
  s_lshr_b32 s41, s20, 1
  s_lshl_b32 s41, s41, 12
  s_and_b32 s42, s20, 1
  s_lshl_b32 s42, s42, 3
  s_add_u32 s41, s41, s42
  v_add_u32 v6, s41, v1
  s_lshl_b32 s41, s20, 10
  v_add_u32 v8, s41, v1
  v_lshlrev_b32 v7, 10, v67
  v_lshl_add_u32 v7, v68, 8, v7
  v_lshl_add_u32 v7, v65, 4, v7
  s_lshl_b32 s41, s20, 11
  v_add_u32 v7, s41, v7
  v_mov_b32 v4, 0xbdd2d3e8
  s_cmp_eq_u32 s3, 0
  s_cselect_b32 s31, 0, 0x4000
  s_lshl_b32 s30, s21, 9
  s_add_u32 s31, s31, s30
  s_add_u32 s31, s31, 196608
  s_lshl_b32 s30, s22, 2
  s_add_u32 s30, s30, s20
  s_lshl_b32 s30, s30, 3
  s_add_u32 s30, s30, s31
  s_lshl_b32 s42, s21, 12
  s_add_u32 s42, s42, s3
  s_add_u32 s42, s42, 0x02700000
  s_add_u32 s32, s96, s42
  s_addc_u32 s33, s97, 0
  s_mov_b32 s34, 0x00001000
  s_mov_b32 s35, 0x00020000
  s_lshl_b32 s42, s20, 7
  v_lshlrev_b32 v66, 3, v65
  v_lshl_add_u32 v66, v64, 10, v66
  v_add_u32 v66, s42, v66
  s_mov_b32 s23, 12288
  buffer_load_dwordx4 v[160:163], v1, s[4:7], s23 offen sc1
  buffer_load_dwordx4 v[164:167], v1, s[4:7], s23 offen offset:1024 sc1
  buffer_load_dwordx4 v[168:171], v1, s[4:7], s23 offen offset:2048 sc1
  s_add_u32 s23, s23, 0xc00
  buffer_load_dwordx4 v[172:175], v1, s[4:7], s23 offen sc1
  buffer_load_dwordx4 v[176:179], v1, s[4:7], s23 offen offset:1024 sc1
  buffer_load_dwordx4 v[180:183], v1, s[4:7], s23 offen offset:2048 sc1
  s_add_u32 s23, s23, 0xc00
  s_mov_b32 s26, s23
  s_cmp_lg_u32 s3, 0
  s_cbranch_scc1 ffn_nojs
  s_cmp_lt_u32 s74, 2
  s_cselect_b64 s[80:81], s[60:61], s[72:73]
  s_cselect_b64 s[84:85], s[64:65], s[72:73]
  s_mov_b64 s[36:37], s[72:73]
  s_lshl_b32 s88, s20, 10
  s_mov_b32 s38, 0x00510000
  s_mov_b32 s39, 0x00020000
  s_mov_b32 s82, 0x00510000
  s_mov_b32 s83, 0x00020000
  s_mov_b32 s86, 0x00510000
  s_mov_b32 s87, 0x00020000
  s_add_u32 s76, s74, 128
  s_mul_i32 s78, s76, 3641
  s_lshr_b32 s78, s78, 16
  s_mul_i32 s79, s78, 18
  s_sub_u32 s79, s76, s79
  s_mul_i32 s79, s79, 294912
  s_lshl_b32 s78, s78, 7
  s_add_u32 s78, s78, s79
  s_mul_i32 s79, s75, 1152
  s_add_u32 s78, s78, s79
  s_mov_b32 s44, s78
  s_mov_b32 s45, s78
  s_add_u32 s76, s74, 128
  s_lshl_b32 s46, s76, 11
  s_add_u32 s76, s74, 0xfffffffe
  s_lshl_b32 s76, s76, 1
  s_mul_i32 s77, s76, 3641
  s_lshr_b32 s77, s77, 16
  s_mul_i32 s79, s77, 18
  s_sub_u32 s79, s76, s79
  s_mul_i32 s79, s79, 36864
  s_lshl_b32 s77, s77, 7
  s_add_u32 s77, s77, s79
  s_mul_i32 s79, s75, 663552
  s_add_u32 s77, s77, s79
  s_add_u32 s76, s74, 160
  s_mul_i32 s78, s76, 3641
  s_lshr_b32 s78, s78, 16
  s_mul_i32 s79, s78, 18
  s_sub_u32 s79, s76, s79
  s_mul_i32 s79, s79, 294912
  s_lshl_b32 s78, s78, 7
  s_add_u32 s78, s78, s79
  s_mul_i32 s79, s75, 1152
  s_add_u32 s78, s78, s79
  s_cmp_lt_u32 s74, 2
  s_cselect_b32 s78, s78, s77
  s_cselect_b32 s79, 0, 36864
  s_add_u32 s77, s78, s79
  s_mov_b32 s47, s78
  s_mov_b32 s48, s77
  s_add_u32 s76, s74, 160
  s_lshl_b32 s49, s76, 11
  s_add_u32 s76, s74, 0x0000001e
  s_lshl_b32 s76, s76, 1
  s_mul_i32 s78, s76, 3641
  s_lshr_b32 s78, s78, 16
  s_mul_i32 s79, s78, 18
  s_sub_u32 s79, s76, s79
  s_mul_i32 s79, s79, 36864
  s_lshl_b32 s78, s78, 7
  s_add_u32 s78, s78, s79
  s_mul_i32 s79, s75, 663552
  s_add_u32 s78, s78, s79
  s_add_u32 s77, s78, 36864
  s_mov_b32 s50, s78
  s_mov_b32 s51, s77
  s_add_u32 s76, s74, 192
  s_lshl_b32 s52, s76, 11
  s_add_u32 s76, s74, 0x0000003e
  s_lshl_b32 s76, s76, 1
  s_mul_i32 s78, s76, 3641
  s_lshr_b32 s78, s78, 16
  s_mul_i32 s79, s78, 18
  s_sub_u32 s79, s76, s79
  s_mul_i32 s79, s79, 36864
  s_lshl_b32 s78, s78, 7
  s_add_u32 s78, s78, s79
  s_mul_i32 s79, s75, 663552
  s_add_u32 s78, s78, s79
  s_add_u32 s77, s78, 36864
  s_mov_b32 s53, s78
  s_mov_b32 s54, s77
  s_add_u32 s76, s74, 224
  s_lshl_b32 s55, s76, 11
  s_cmp_lt_u32 s76, 243
  s_cselect_b32 s56, 497664, 0
ffn_nojs:
  s_cmp_lg_u32 s20, 0
  s_cbranch_scc1 wt9_d
  v_and_b32 v9, 7, v0
  s_lshl_b32 s23, s21, 3
  v_add_u32 v9, s23, v9
  v_lshlrev_b32 v9, 6, v9
  s_add_u32 s23, s14, 0x0000c000
  v_add_u32 v9, s23, v9
  s_mov_b32 s23, 0x10000
wt9_l:
  buffer_load_dwordx2 v[10:11], v9, s[92:95], 0 offen sc1
  s_waitcnt vmcnt(0)
  v_cmp_ne_u64 vcc, s[90:91], v[10:11]
  s_sub_u32 s23, s23, 1
  s_cselect_b64 s[24:25], 0, -1
  s_nop 1
  s_and_b64 vcc, vcc, s[24:25]
  s_cbranch_vccnz wt9_l
wt9_d:
  s_barrier
  s_mov_b32 s23, s26
  buffer_load_dwordx2 v[88:89], v66, s[32:35], 0 offen sc1
  buffer_load_dwordx2 v[90:91], v66, s[32:35], 0 offen offset:512 sc1
  buffer_load_dwordx4 v[184:187], v2, s[8:11], s40 offen sc1
  s_add_u32 s40, s40, 0x1000
  buffer_load_dwordx4 v[188:191], v2, s[8:11], s40 offen sc1
  s_add_u32 s40, s40, 0x1000
  buffer_load_dwordx4 v[192:195], v2, s[8:11], s40 offen sc1
  s_add_u32 s40, s40, 0x1000
  buffer_load_dwordx4 v[196:199], v2, s[8:11], s40 offen sc1
  s_add_u32 s40, s40, 0x1000
  buffer_load_dwordx4 v[200:203], v2, s[8:11], s40 offen sc1
  s_add_u32 s40, s40, 0x1000
  buffer_load_dwordx4 v[204:207], v2, s[8:11], s40 offen sc1
  s_add_u32 s40, s40, 0x1000
  buffer_load_dwordx4 v[208:211], v2, s[8:11], s40 offen sc1
  s_add_u32 s40, s40, 0x1000
  buffer_load_dwordx4 v[212:215], v2, s[8:11], s40 offen sc1
  s_add_u32 s40, s40, 0x1000
  s_waitcnt vmcnt(8)
  v_add_f32 v80, v88, v90
  v_add_f32 v82, v89, v91
  v_mov_b32 v81, v80
  v_mov_b32 v83, v82
  s_nop 1
  buffer_load_dwordx4 v[216:219], v2, s[8:11], s40 offen sc1
  s_add_u32 s40, s40, 0x1000
  v_permlane16_swap_b32 v80, v81
  v_permlane16_swap_b32 v82, v83
  buffer_load_dwordx4 v[220:223], v2, s[8:11], s40 offen sc1
  s_add_u32 s40, s40, 0x1000
  s_nop 1
  v_add_f32 v80, v80, v81
  v_add_f32 v82, v82, v83
  buffer_load_dwordx4 v[224:227], v2, s[8:11], s40 offen sc1
  s_add_u32 s40, s40, 0x1000
  v_mov_b32 v81, v80
  v_mov_b32 v83, v82
  buffer_load_dwordx4 v[228:231], v2, s[8:11], s40 offen sc1
  s_add_u32 s40, s40, 0x1000
  s_nop 1
  v_permlane32_swap_b32 v80, v81
  v_permlane32_swap_b32 v82, v83
  buffer_load_dwordx4 v[232:235], v2, s[8:11], s40 offen sc1
  s_add_u32 s40, s40, 0x1000
  s_nop 1
  v_add_f32 v80, v80, v81
  buffer_load_dwordx4 v[236:239], v2, s[8:11], s40 offen sc1
  s_add_u32 s40, s40, 0x1000
  v_add_f32 v82, v82, v83
  v_mul_f32 v80, 0x3ae38e39, v80
  v_mul_f32 v82, 0x3ae38e39, v82
  buffer_load_dwordx4 v[240:243], v2, s[8:11], s40 offen sc1
  s_add_u32 s40, s40, 0x1000
  v_fma_f32 v82, -v80, v80, v82
  v_max_f32 v82, 0, v82
  buffer_load_dwordx4 v[244:247], v2, s[8:11], s40 offen sc1
  s_add_u32 s40, s40, 0x1000
  v_add_f32 v82, 0x3727c5ac, v82
  v_rsq_f32 v84, v82
  s_nop 0
  buffer_load_dwordx4 v[248:251], v2, s[8:11], s40 offen sc1
  s_add_u32 s40, s40, 0x1000
  v_mul_f32 v86, v80, v84
  v_sub_f32 v86, 0, v86
  buffer_load_dwordx4 v[252:255], v2, s[8:11], s40 offen sc1
  s_waitcnt vmcnt(17)
  v_lshlrev_b32 v88, 16, v184
  v_and_b32 v89, 0xffff0000, v184
  v_lshlrev_b32 v90, 16, v185
  v_and_b32 v91, 0xffff0000, v185
  v_lshlrev_b32 v92, 16, v186
  v_and_b32 v93, 0xffff0000, v186
  v_lshlrev_b32 v94, 16, v187
  v_and_b32 v95, 0xffff0000, v187
  v_pk_fma_f32 v[88:89], v[88:89], v[84:85], v[86:87] op_sel_hi:[1,0,0]
  v_pk_fma_f32 v[90:91], v[90:91], v[84:85], v[86:87] op_sel_hi:[1,0,0]
  v_pk_fma_f32 v[92:93], v[92:93], v[84:85], v[86:87] op_sel_hi:[1,0,0]
  v_pk_fma_f32 v[94:95], v[94:95], v[84:85], v[86:87] op_sel_hi:[1,0,0]
  v_cvt_pk_bf16_f32 v184, v88, v89
  v_cvt_pk_bf16_f32 v185, v90, v91
  v_cvt_pk_bf16_f32 v186, v92, v93
  v_cvt_pk_bf16_f32 v187, v94, v95
  ds_write_b128 v8, v[184:187] offset:0
  s_waitcnt vmcnt(16)
  v_lshlrev_b32 v88, 16, v188
  v_and_b32 v89, 0xffff0000, v188
  v_lshlrev_b32 v90, 16, v189
  v_and_b32 v91, 0xffff0000, v189
  v_lshlrev_b32 v92, 16, v190
  v_and_b32 v93, 0xffff0000, v190
  v_lshlrev_b32 v94, 16, v191
  v_and_b32 v95, 0xffff0000, v191
  v_pk_fma_f32 v[88:89], v[88:89], v[84:85], v[86:87] op_sel_hi:[1,0,0]
  v_pk_fma_f32 v[90:91], v[90:91], v[84:85], v[86:87] op_sel_hi:[1,0,0]
  v_pk_fma_f32 v[92:93], v[92:93], v[84:85], v[86:87] op_sel_hi:[1,0,0]
  v_pk_fma_f32 v[94:95], v[94:95], v[84:85], v[86:87] op_sel_hi:[1,0,0]
  v_cvt_pk_bf16_f32 v188, v88, v89
  v_cvt_pk_bf16_f32 v189, v90, v91
  v_cvt_pk_bf16_f32 v190, v92, v93
  v_cvt_pk_bf16_f32 v191, v94, v95
  ds_write_b128 v8, v[188:191] offset:4096
  s_waitcnt vmcnt(15)
  v_lshlrev_b32 v88, 16, v192
  v_and_b32 v89, 0xffff0000, v192
  v_lshlrev_b32 v90, 16, v193
  v_and_b32 v91, 0xffff0000, v193
  v_lshlrev_b32 v92, 16, v194
  v_and_b32 v93, 0xffff0000, v194
  v_lshlrev_b32 v94, 16, v195
  v_and_b32 v95, 0xffff0000, v195
  v_pk_fma_f32 v[88:89], v[88:89], v[84:85], v[86:87] op_sel_hi:[1,0,0]
  v_pk_fma_f32 v[90:91], v[90:91], v[84:85], v[86:87] op_sel_hi:[1,0,0]
  v_pk_fma_f32 v[92:93], v[92:93], v[84:85], v[86:87] op_sel_hi:[1,0,0]
  v_pk_fma_f32 v[94:95], v[94:95], v[84:85], v[86:87] op_sel_hi:[1,0,0]
  v_cvt_pk_bf16_f32 v192, v88, v89
  v_cvt_pk_bf16_f32 v193, v90, v91
  v_cvt_pk_bf16_f32 v194, v92, v93
  v_cvt_pk_bf16_f32 v195, v94, v95
  ds_write_b128 v8, v[192:195] offset:8192
  s_waitcnt vmcnt(14)
  v_lshlrev_b32 v88, 16, v196
  v_and_b32 v89, 0xffff0000, v196
  v_lshlrev_b32 v90, 16, v197
  v_and_b32 v91, 0xffff0000, v197
  v_lshlrev_b32 v92, 16, v198
  v_and_b32 v93, 0xffff0000, v198
  v_lshlrev_b32 v94, 16, v199
  v_and_b32 v95, 0xffff0000, v199
  v_pk_fma_f32 v[88:89], v[88:89], v[84:85], v[86:87] op_sel_hi:[1,0,0]
  v_pk_fma_f32 v[90:91], v[90:91], v[84:85], v[86:87] op_sel_hi:[1,0,0]
  v_pk_fma_f32 v[92:93], v[92:93], v[84:85], v[86:87] op_sel_hi:[1,0,0]
  v_pk_fma_f32 v[94:95], v[94:95], v[84:85], v[86:87] op_sel_hi:[1,0,0]
  v_cvt_pk_bf16_f32 v196, v88, v89
  v_cvt_pk_bf16_f32 v197, v90, v91
  v_cvt_pk_bf16_f32 v198, v92, v93
  v_cvt_pk_bf16_f32 v199, v94, v95
  ds_write_b128 v8, v[196:199] offset:12288
  s_waitcnt vmcnt(13)
  v_lshlrev_b32 v88, 16, v200
  v_and_b32 v89, 0xffff0000, v200
  v_lshlrev_b32 v90, 16, v201
  v_and_b32 v91, 0xffff0000, v201
  v_lshlrev_b32 v92, 16, v202
  v_and_b32 v93, 0xffff0000, v202
  v_lshlrev_b32 v94, 16, v203
  v_and_b32 v95, 0xffff0000, v203
  v_pk_fma_f32 v[88:89], v[88:89], v[84:85], v[86:87] op_sel_hi:[1,0,0]
  v_pk_fma_f32 v[90:91], v[90:91], v[84:85], v[86:87] op_sel_hi:[1,0,0]
  v_pk_fma_f32 v[92:93], v[92:93], v[84:85], v[86:87] op_sel_hi:[1,0,0]
  v_pk_fma_f32 v[94:95], v[94:95], v[84:85], v[86:87] op_sel_hi:[1,0,0]
  v_cvt_pk_bf16_f32 v200, v88, v89
  v_cvt_pk_bf16_f32 v201, v90, v91
  v_cvt_pk_bf16_f32 v202, v92, v93
  v_cvt_pk_bf16_f32 v203, v94, v95
  ds_write_b128 v8, v[200:203] offset:16384
  s_waitcnt vmcnt(12)
  v_lshlrev_b32 v88, 16, v204
  v_and_b32 v89, 0xffff0000, v204
  v_lshlrev_b32 v90, 16, v205
  v_and_b32 v91, 0xffff0000, v205
  v_lshlrev_b32 v92, 16, v206
  v_and_b32 v93, 0xffff0000, v206
  v_lshlrev_b32 v94, 16, v207
  v_and_b32 v95, 0xffff0000, v207
  v_pk_fma_f32 v[88:89], v[88:89], v[84:85], v[86:87] op_sel_hi:[1,0,0]
  v_pk_fma_f32 v[90:91], v[90:91], v[84:85], v[86:87] op_sel_hi:[1,0,0]
  v_pk_fma_f32 v[92:93], v[92:93], v[84:85], v[86:87] op_sel_hi:[1,0,0]
  v_pk_fma_f32 v[94:95], v[94:95], v[84:85], v[86:87] op_sel_hi:[1,0,0]
  v_cvt_pk_bf16_f32 v204, v88, v89
  v_cvt_pk_bf16_f32 v205, v90, v91
  v_cvt_pk_bf16_f32 v206, v92, v93
  v_cvt_pk_bf16_f32 v207, v94, v95
  ds_write_b128 v8, v[204:207] offset:20480
  s_waitcnt lgkmcnt(0)
  s_barrier
  ds_read_b128 a[0:3], v1 offset:0
  ds_read_b128 a[4:7], v1 offset:1024
  ds_read_b128 a[8:11], v1 offset:2048
  ds_read_b128 a[12:15], v1 offset:3072
  ds_read_b128 a[16:19], v1 offset:4096
  ds_read_b128 a[20:23], v1 offset:5120
  ds_read_b128 a[24:27], v1 offset:6144
  ds_read_b128 a[28:31], v1 offset:7168
  ds_read_b128 a[32:35], v1 offset:8192
  ds_read_b128 a[36:39], v1 offset:9216
  ds_read_b128 a[40:43], v1 offset:10240
  ds_read_b128 a[44:47], v1 offset:11264
  s_waitcnt lgkmcnt(6)
  ds_read_b128 a[48:51], v1 offset:12288
  ds_read_b128 a[52:55], v1 offset:13312
  ds_read_b128 a[56:59], v1 offset:14336
  ds_read_b128 a[60:63], v1 offset:15360
  ds_read_b128 a[64:67], v1 offset:16384
  ds_read_b128 a[68:71], v1 offset:17408
  ds_read_b128 a[72:75], v1 offset:18432
  ds_read_b128 a[76:79], v1 offset:19456
  ds_read_b128 a[80:83], v1 offset:20480
  ds_read_b128 a[84:87], v1 offset:21504
  ds_read_b128 a[88:91], v1 offset:22528
  ds_read_b128 a[92:95], v1 offset:23552
  s_waitcnt lgkmcnt(6)
  s_waitcnt lgkmcnt(8)
  s_waitcnt vmcnt(17)
  v_mfma_f32_16x16x32_bf16 v[48:51], v[112:115], a[0:3], 0
  v_mfma_f32_16x16x32_bf16 v[52:55], v[112:115], a[4:7], 0
  s_waitcnt vmcnt(11)
  v_lshlrev_b32 v88, 16, v208
  v_and_b32 v89, 0xffff0000, v208
  v_lshlrev_b32 v90, 16, v209
  v_and_b32 v91, 0xffff0000, v209
  v_mfma_f32_16x16x32_bf16 v[56:59], v[112:115], a[8:11], 0
  v_lshlrev_b32 v92, 16, v210
  v_and_b32 v93, 0xffff0000, v210
  v_lshlrev_b32 v94, 16, v211
  v_and_b32 v95, 0xffff0000, v211
  v_mfma_f32_16x16x32_bf16 v[60:63], v[112:115], a[12:15], 0
  buffer_load_dwordx4 v[112:115], v1, s[4:7], s23 offen sc1
  v_fma_f32 v88, v88, v84, v86
  v_fma_f32 v89, v89, v84, v86
  s_waitcnt lgkmcnt(0)
  s_waitcnt vmcnt(17)
  v_mfma_f32_16x16x32_bf16 v[76:79], v[116:119], a[12:15], 0
  v_fma_f32 v90, v90, v84, v86
  v_fma_f32 v91, v91, v84, v86
  v_fma_f32 v92, v92, v84, v86
  v_fma_f32 v93, v93, v84, v86
  v_fma_f32 v94, v94, v84, v86
  v_mfma_f32_16x16x32_bf16 v[72:75], v[116:119], a[8:11], 0
  v_fma_f32 v95, v95, v84, v86
  v_cvt_pk_bf16_f32 v208, v88, v89
  v_cvt_pk_bf16_f32 v209, v90, v91
  v_cvt_pk_bf16_f32 v210, v92, v93
  v_mfma_f32_16x16x32_bf16 v[68:71], v[116:119], a[4:7], 0
  v_cvt_pk_bf16_f32 v211, v94, v95
  ds_write_b128 v8, v[208:211] offset:24576
  s_waitcnt vmcnt(11)
  v_lshlrev_b32 v88, 16, v212
  v_mfma_f32_16x16x32_bf16 v[64:67], v[116:119], a[0:3], 0
  buffer_load_dwordx4 v[116:119], v1, s[4:7], s23 offen offset:1024 sc1
  v_and_b32 v89, 0xffff0000, v212
  v_lshlrev_b32 v90, 16, v213
  s_waitcnt vmcnt(17)
  v_mfma_f32_16x16x32_bf16 v[48:51], v[120:123], a[16:19], v[48:51]
  v_and_b32 v91, 0xffff0000, v213
  v_lshlrev_b32 v92, 16, v214
  v_and_b32 v93, 0xffff0000, v214
  v_lshlrev_b32 v94, 16, v215
  v_and_b32 v95, 0xffff0000, v215
  v_mfma_f32_16x16x32_bf16 v[52:55], v[120:123], a[20:23], v[52:55]
  v_fma_f32 v88, v88, v84, v86
  v_fma_f32 v89, v89, v84, v86
  v_fma_f32 v90, v90, v84, v86
  v_fma_f32 v91, v91, v84, v86
  v_mfma_f32_16x16x32_bf16 v[56:59], v[120:123], a[24:27], v[56:59]
  v_fma_f32 v92, v92, v84, v86
  v_fma_f32 v93, v93, v84, v86
  v_fma_f32 v94, v94, v84, v86
  v_fma_f32 v95, v95, v84, v86
  v_cvt_pk_bf16_f32 v212, v88, v89
  v_mfma_f32_16x16x32_bf16 v[60:63], v[120:123], a[28:31], v[60:63]
  buffer_load_dwordx4 v[120:123], v1, s[4:7], s23 offen offset:2048 sc1
  s_add_u32 s23, s23, 0xc00
  v_cvt_pk_bf16_f32 v213, v90, v91
  v_cvt_pk_bf16_f32 v214, v92, v93
  s_waitcnt vmcnt(17)
  v_mfma_f32_16x16x32_bf16 v[76:79], v[124:127], a[28:31], v[76:79]
  v_cvt_pk_bf16_f32 v215, v94, v95
  ds_write_b128 v8, v[212:215] offset:28672
  s_waitcnt vmcnt(12)
  v_lshlrev_b32 v88, 16, v216
  v_mfma_f32_16x16x32_bf16 v[72:75], v[124:127], a[24:27], v[72:75]
  v_and_b32 v89, 0xffff0000, v216
  v_lshlrev_b32 v90, 16, v217
  v_and_b32 v91, 0xffff0000, v217
  v_lshlrev_b32 v92, 16, v218
  v_mfma_f32_16x16x32_bf16 v[68:71], v[124:127], a[20:23], v[68:71]
  v_and_b32 v93, 0xffff0000, v218
  v_lshlrev_b32 v94, 16, v219
  v_and_b32 v95, 0xffff0000, v219
  v_fma_f32 v88, v88, v84, v86
  v_fma_f32 v89, v89, v84, v86
  v_mfma_f32_16x16x32_bf16 v[64:67], v[124:127], a[16:19], v[64:67]
  buffer_load_dwordx4 v[124:127], v1, s[4:7], s23 offen sc1
  v_fma_f32 v90, v90, v84, v86
  v_fma_f32 v91, v91, v84, v86
  s_waitcnt vmcnt(17)
  v_mfma_f32_16x16x32_bf16 v[48:51], v[128:131], a[32:35], v[48:51]
  v_fma_f32 v92, v92, v84, v86
  v_fma_f32 v93, v93, v84, v86
  v_fma_f32 v94, v94, v84, v86
  v_fma_f32 v95, v95, v84, v86
  v_mfma_f32_16x16x32_bf16 v[52:55], v[128:131], a[36:39], v[52:55]
  v_cvt_pk_bf16_f32 v216, v88, v89
  v_cvt_pk_bf16_f32 v217, v90, v91
  v_cvt_pk_bf16_f32 v218, v92, v93
  v_cvt_pk_bf16_f32 v219, v94, v95
  v_mfma_f32_16x16x32_bf16 v[56:59], v[128:131], a[40:43], v[56:59]
  ds_write_b128 v8, v[216:219] offset:32768
  s_waitcnt vmcnt(12)
  v_lshlrev_b32 v88, 16, v220
  v_and_b32 v89, 0xffff0000, v220
  v_mfma_f32_16x16x32_bf16 v[60:63], v[128:131], a[44:47], v[60:63]
  buffer_load_dwordx4 v[128:131], v1, s[4:7], s23 offen offset:1024 sc1
  v_lshlrev_b32 v90, 16, v221
  v_and_b32 v91, 0xffff0000, v221
  v_lshlrev_b32 v92, 16, v222
  s_waitcnt vmcnt(17)
  v_mfma_f32_16x16x32_bf16 v[76:79], v[132:135], a[44:47], v[76:79]
  v_and_b32 v93, 0xffff0000, v222
  v_lshlrev_b32 v94, 16, v223
  v_and_b32 v95, 0xffff0000, v223
  v_fma_f32 v88, v88, v84, v86
  v_mfma_f32_16x16x32_bf16 v[72:75], v[132:135], a[40:43], v[72:75]
  v_fma_f32 v89, v89, v84, v86
  v_fma_f32 v90, v90, v84, v86
  v_fma_f32 v91, v91, v84, v86
  v_fma_f32 v92, v92, v84, v86
  v_fma_f32 v93, v93, v84, v86
  v_mfma_f32_16x16x32_bf16 v[68:71], v[132:135], a[36:39], v[68:71]
  v_fma_f32 v94, v94, v84, v86
  v_fma_f32 v95, v95, v84, v86
  v_cvt_pk_bf16_f32 v220, v88, v89
  v_cvt_pk_bf16_f32 v221, v90, v91
  v_mfma_f32_16x16x32_bf16 v[64:67], v[132:135], a[32:35], v[64:67]
  buffer_load_dwordx4 v[132:135], v1, s[4:7], s23 offen offset:2048 sc1
  s_add_u32 s23, s23, 0xc00
  v_cvt_pk_bf16_f32 v222, v92, v93
  v_cvt_pk_bf16_f32 v223, v94, v95
  s_waitcnt vmcnt(17)
  v_mfma_f32_16x16x32_bf16 v[48:51], v[136:139], a[48:51], v[48:51]
  ds_write_b128 v8, v[220:223] offset:36864
  s_waitcnt vmcnt(13)
  v_lshlrev_b32 v88, 16, v224
  v_and_b32 v89, 0xffff0000, v224
  v_mfma_f32_16x16x32_bf16 v[52:55], v[136:139], a[52:55], v[52:55]
  v_lshlrev_b32 v90, 16, v225
  v_and_b32 v91, 0xffff0000, v225
  v_lshlrev_b32 v92, 16, v226
  v_and_b32 v93, 0xffff0000, v226
  v_lshlrev_b32 v94, 16, v227
  v_mfma_f32_16x16x32_bf16 v[56:59], v[136:139], a[56:59], v[56:59]
  v_and_b32 v95, 0xffff0000, v227
  v_fma_f32 v88, v88, v84, v86
  v_fma_f32 v89, v89, v84, v86
  v_fma_f32 v90, v90, v84, v86
  v_mfma_f32_16x16x32_bf16 v[60:63], v[136:139], a[60:63], v[60:63]
  buffer_load_dwordx4 v[136:139], v1, s[4:7], s23 offen sc1
  v_fma_f32 v91, v91, v84, v86
  v_fma_f32 v92, v92, v84, v86
  s_waitcnt vmcnt(17)
  v_mfma_f32_16x16x32_bf16 v[76:79], v[140:143], a[60:63], v[76:79]
  v_fma_f32 v93, v93, v84, v86
  v_fma_f32 v94, v94, v84, v86
  v_fma_f32 v95, v95, v84, v86
  v_cvt_pk_bf16_f32 v224, v88, v89
  v_cvt_pk_bf16_f32 v225, v90, v91
  v_mfma_f32_16x16x32_bf16 v[72:75], v[140:143], a[56:59], v[72:75]
  v_cvt_pk_bf16_f32 v226, v92, v93
  v_cvt_pk_bf16_f32 v227, v94, v95
  ds_write_b128 v8, v[224:227] offset:40960
  v_mfma_f32_16x16x32_bf16 v[68:71], v[140:143], a[52:55], v[68:71]
  s_waitcnt vmcnt(13)
  v_lshlrev_b32 v88, 16, v228
  v_and_b32 v89, 0xffff0000, v228
  v_lshlrev_b32 v90, 16, v229
  v_and_b32 v91, 0xffff0000, v229
  v_mfma_f32_16x16x32_bf16 v[64:67], v[140:143], a[48:51], v[64:67]
  buffer_load_dwordx4 v[140:143], v1, s[4:7], s23 offen offset:1024 sc1
  v_lshlrev_b32 v92, 16, v230
  v_and_b32 v93, 0xffff0000, v230
  s_waitcnt vmcnt(17)
  v_mfma_f32_16x16x32_bf16 v[48:51], v[144:147], a[64:67], v[48:51]
  v_lshlrev_b32 v94, 16, v231
  v_and_b32 v95, 0xffff0000, v231
  v_fma_f32 v88, v88, v84, v86
  v_fma_f32 v89, v89, v84, v86
  v_fma_f32 v90, v90, v84, v86
  v_mfma_f32_16x16x32_bf16 v[52:55], v[144:147], a[68:71], v[52:55]
  v_fma_f32 v91, v91, v84, v86
  v_fma_f32 v92, v92, v84, v86
  v_fma_f32 v93, v93, v84, v86
  v_fma_f32 v94, v94, v84, v86
  v_mfma_f32_16x16x32_bf16 v[56:59], v[144:147], a[72:75], v[56:59]
  v_fma_f32 v95, v95, v84, v86
  v_cvt_pk_bf16_f32 v228, v88, v89
  v_cvt_pk_bf16_f32 v229, v90, v91
  v_cvt_pk_bf16_f32 v230, v92, v93
  v_cvt_pk_bf16_f32 v231, v94, v95
  v_mfma_f32_16x16x32_bf16 v[60:63], v[144:147], a[76:79], v[60:63]
  buffer_load_dwordx4 v[144:147], v1, s[4:7], s23 offen offset:2048 sc1
  s_add_u32 s23, s23, 0xc00
  ds_write_b128 v8, v[228:231] offset:45056
  s_waitcnt vmcnt(17)
  v_mfma_f32_16x16x32_bf16 v[76:79], v[148:151], a[76:79], v[76:79]
  s_waitcnt lgkmcnt(0)
  s_barrier
  v_mfma_f32_16x16x32_bf16 v[72:75], v[148:151], a[72:75], v[72:75]
  ds_read_b128 a[96:99], v1 offset:24576
  ds_read_b128 a[100:103], v1 offset:25600
  ds_read_b128 a[104:107], v1 offset:26624
  v_mfma_f32_16x16x32_bf16 v[68:71], v[148:151], a[68:71], v[68:71]
  ds_read_b128 a[108:111], v1 offset:27648
  ds_read_b128 a[112:115], v1 offset:28672
  v_mfma_f32_16x16x32_bf16 v[64:67], v[148:151], a[64:67], v[64:67]
  buffer_load_dwordx4 v[148:151], v1, s[4:7], s23 offen sc1
  ds_read_b128 a[116:119], v1 offset:29696
  ds_read_b128 a[120:123], v1 offset:30720
  ds_read_b128 a[124:127], v1 offset:31744
  s_waitcnt vmcnt(17)
  v_mfma_f32_16x16x32_bf16 v[48:51], v[152:155], a[80:83], v[48:51]
  ds_read_b128 a[128:131], v1 offset:32768
  ds_read_b128 a[132:135], v1 offset:33792
  v_mfma_f32_16x16x32_bf16 v[52:55], v[152:155], a[84:87], v[52:55]
  ds_read_b128 a[136:139], v1 offset:34816
  ds_read_b128 a[140:143], v1 offset:35840
  s_waitcnt lgkmcnt(6)
  v_mfma_f32_16x16x32_bf16 v[56:59], v[152:155], a[88:91], v[56:59]
  ds_read_b128 a[144:147], v3 offset:0
  ds_read_b128 a[148:151], v3 offset:1024
  ds_read_b128 a[152:155], v3 offset:2048
  v_mfma_f32_16x16x32_bf16 v[60:63], v[152:155], a[92:95], v[60:63]
  buffer_load_dwordx4 v[152:155], v1, s[4:7], s23 offen offset:1024 sc1
  ds_read_b128 a[156:159], v3 offset:3072
  ds_read_b128 a[160:163], v3 offset:4096
  s_waitcnt vmcnt(17)
  v_mfma_f32_16x16x32_bf16 v[76:79], v[156:159], a[92:95], v[76:79]
  ds_read_b128 a[164:167], v3 offset:5120
  ds_read_b128 a[168:171], v3 offset:6144
  ds_read_b128 a[172:175], v3 offset:7168
  v_mfma_f32_16x16x32_bf16 v[72:75], v[156:159], a[88:91], v[72:75]
  ds_read_b128 a[176:179], v3 offset:8192
  ds_read_b128 a[180:183], v3 offset:9216
  v_mfma_f32_16x16x32_bf16 v[68:71], v[156:159], a[84:87], v[68:71]
  ds_read_b128 a[184:187], v3 offset:10240
  ds_read_b128 a[188:191], v3 offset:11264
  s_waitcnt lgkmcnt(6)
  v_mfma_f32_16x16x32_bf16 v[64:67], v[156:159], a[80:83], v[64:67]
  buffer_load_dwordx4 v[156:159], v1, s[4:7], s23 offen offset:2048 sc1
  s_add_u32 s23, s23, 0xc00
  s_waitcnt lgkmcnt(8)
  s_waitcnt vmcnt(17)
  v_mfma_f32_16x16x32_bf16 v[48:51], v[160:163], a[96:99], v[48:51]
  v_mfma_f32_16x16x32_bf16 v[52:55], v[160:163], a[100:103], v[52:55]
  s_waitcnt vmcnt(17)
  v_lshlrev_b32 v88, 16, v232
  v_and_b32 v89, 0xffff0000, v232
  v_lshlrev_b32 v90, 16, v233
  v_and_b32 v91, 0xffff0000, v233
  v_mfma_f32_16x16x32_bf16 v[56:59], v[160:163], a[104:107], v[56:59]
  v_lshlrev_b32 v92, 16, v234
  v_and_b32 v93, 0xffff0000, v234
  v_lshlrev_b32 v94, 16, v235
  v_and_b32 v95, 0xffff0000, v235
  v_mfma_f32_16x16x32_bf16 v[60:63], v[160:163], a[108:111], v[60:63]
  buffer_load_dwordx4 v[160:163], v1, s[4:7], s23 offen sc1
  v_fma_f32 v88, v88, v84, v86
  v_fma_f32 v89, v89, v84, v86
  s_waitcnt lgkmcnt(0)
  s_waitcnt vmcnt(17)
  v_mfma_f32_16x16x32_bf16 v[76:79], v[164:167], a[108:111], v[76:79]
  v_fma_f32 v90, v90, v84, v86
  v_fma_f32 v91, v91, v84, v86
  v_fma_f32 v92, v92, v84, v86
  v_fma_f32 v93, v93, v84, v86
  v_fma_f32 v94, v94, v84, v86
  v_mfma_f32_16x16x32_bf16 v[72:75], v[164:167], a[104:107], v[72:75]
  v_fma_f32 v95, v95, v84, v86
  v_cvt_pk_bf16_f32 v232, v88, v89
  v_cvt_pk_bf16_f32 v233, v90, v91
  v_cvt_pk_bf16_f32 v234, v92, v93
  v_cvt_pk_bf16_f32 v235, v94, v95
  v_mfma_f32_16x16x32_bf16 v[68:71], v[164:167], a[100:103], v[68:71]
  ds_write_b128 v8, v[232:235] offset:49152
  s_waitcnt vmcnt(17)
  v_lshlrev_b32 v88, 16, v236
  v_mfma_f32_16x16x32_bf16 v[64:67], v[164:167], a[96:99], v[64:67]
  buffer_load_dwordx4 v[164:167], v1, s[4:7], s23 offen offset:1024 sc1
  v_and_b32 v89, 0xffff0000, v236
  v_lshlrev_b32 v90, 16, v237
  s_waitcnt vmcnt(17)
  v_mfma_f32_16x16x32_bf16 v[48:51], v[168:171], a[112:115], v[48:51]
  v_and_b32 v91, 0xffff0000, v237
  v_lshlrev_b32 v92, 16, v238
  v_and_b32 v93, 0xffff0000, v238
  v_lshlrev_b32 v94, 16, v239
  v_and_b32 v95, 0xffff0000, v239
  v_mfma_f32_16x16x32_bf16 v[52:55], v[168:171], a[116:119], v[52:55]
  v_fma_f32 v88, v88, v84, v86
  v_fma_f32 v89, v89, v84, v86
  v_fma_f32 v90, v90, v84, v86
  v_fma_f32 v91, v91, v84, v86
  v_mfma_f32_16x16x32_bf16 v[56:59], v[168:171], a[120:123], v[56:59]
  v_fma_f32 v92, v92, v84, v86
  v_fma_f32 v93, v93, v84, v86
  v_fma_f32 v94, v94, v84, v86
  v_fma_f32 v95, v95, v84, v86
  v_cvt_pk_bf16_f32 v236, v88, v89
  v_mfma_f32_16x16x32_bf16 v[60:63], v[168:171], a[124:127], v[60:63]
  buffer_load_dwordx4 v[168:171], v1, s[4:7], s23 offen offset:2048 sc1
  s_add_u32 s23, s23, 0xc00
  v_cvt_pk_bf16_f32 v237, v90, v91
  v_cvt_pk_bf16_f32 v238, v92, v93
  s_waitcnt vmcnt(17)
  v_mfma_f32_16x16x32_bf16 v[76:79], v[172:175], a[124:127], v[76:79]
  v_cvt_pk_bf16_f32 v239, v94, v95
  ds_write_b128 v8, v[236:239] offset:53248
  s_waitcnt vmcnt(18)
  v_lshlrev_b32 v88, 16, v240
  v_mfma_f32_16x16x32_bf16 v[72:75], v[172:175], a[120:123], v[72:75]
  v_and_b32 v89, 0xffff0000, v240
  v_lshlrev_b32 v90, 16, v241
  v_and_b32 v91, 0xffff0000, v241
  v_lshlrev_b32 v92, 16, v242
  v_mfma_f32_16x16x32_bf16 v[68:71], v[172:175], a[116:119], v[68:71]
  v_and_b32 v93, 0xffff0000, v242
  v_lshlrev_b32 v94, 16, v243
  v_and_b32 v95, 0xffff0000, v243
  v_fma_f32 v88, v88, v84, v86
  v_fma_f32 v89, v89, v84, v86
  v_mfma_f32_16x16x32_bf16 v[64:67], v[172:175], a[112:115], v[64:67]
  buffer_load_dwordx4 v[172:175], v1, s[4:7], s23 offen sc1
  v_fma_f32 v90, v90, v84, v86
  v_fma_f32 v91, v91, v84, v86
  s_waitcnt vmcnt(17)
  v_mfma_f32_16x16x32_bf16 v[48:51], v[176:179], a[128:131], v[48:51]
  v_fma_f32 v92, v92, v84, v86
  v_fma_f32 v93, v93, v84, v86
  v_fma_f32 v94, v94, v84, v86
  v_fma_f32 v95, v95, v84, v86
  v_cvt_pk_bf16_f32 v240, v88, v89
  v_mfma_f32_16x16x32_bf16 v[52:55], v[176:179], a[132:135], v[52:55]
  v_cvt_pk_bf16_f32 v241, v90, v91
  v_cvt_pk_bf16_f32 v242, v92, v93
  v_cvt_pk_bf16_f32 v243, v94, v95
  ds_write_b128 v8, v[240:243] offset:57344
  v_mfma_f32_16x16x32_bf16 v[56:59], v[176:179], a[136:139], v[56:59]
  s_waitcnt vmcnt(18)
  v_lshlrev_b32 v88, 16, v244
  v_and_b32 v89, 0xffff0000, v244
  v_lshlrev_b32 v90, 16, v245
  v_mfma_f32_16x16x32_bf16 v[60:63], v[176:179], a[140:143], v[60:63]
  buffer_load_dwordx4 v[176:179], v1, s[4:7], s23 offen offset:1024 sc1
  v_and_b32 v91, 0xffff0000, v245
  v_lshlrev_b32 v92, 16, v246
  s_waitcnt vmcnt(17)
  v_mfma_f32_16x16x32_bf16 v[76:79], v[180:183], a[140:143], v[76:79]
  v_and_b32 v93, 0xffff0000, v246
  v_lshlrev_b32 v94, 16, v247
  v_and_b32 v95, 0xffff0000, v247
  v_fma_f32 v88, v88, v84, v86
  v_fma_f32 v89, v89, v84, v86
  v_mfma_f32_16x16x32_bf16 v[72:75], v[180:183], a[136:139], v[72:75]
  v_fma_f32 v90, v90, v84, v86
  v_fma_f32 v91, v91, v84, v86
  v_fma_f32 v92, v92, v84, v86
  v_fma_f32 v93, v93, v84, v86
  v_mfma_f32_16x16x32_bf16 v[68:71], v[180:183], a[132:135], v[68:71]
  v_fma_f32 v94, v94, v84, v86
  v_fma_f32 v95, v95, v84, v86
  v_cvt_pk_bf16_f32 v244, v88, v89
  v_cvt_pk_bf16_f32 v245, v90, v91
  v_cvt_pk_bf16_f32 v246, v92, v93
  v_mfma_f32_16x16x32_bf16 v[64:67], v[180:183], a[128:131], v[64:67]
  buffer_load_dwordx4 v[180:183], v1, s[4:7], s23 offen offset:2048 sc1
  s_add_u32 s23, s23, 0xc00
  v_cvt_pk_bf16_f32 v247, v94, v95
  ds_write_b128 v8, v[244:247] offset:61440
  s_waitcnt vmcnt(17)
  v_mfma_f32_16x16x32_bf16 v[48:51], v[112:115], a[144:147], v[48:51]
  s_waitcnt vmcnt(19)
  v_lshlrev_b32 v88, 16, v248
  v_and_b32 v89, 0xffff0000, v248
  v_lshlrev_b32 v90, 16, v249
  v_mfma_f32_16x16x32_bf16 v[52:55], v[112:115], a[148:151], v[52:55]
  v_and_b32 v91, 0xffff0000, v249
  v_lshlrev_b32 v92, 16, v250
  v_and_b32 v93, 0xffff0000, v250
  v_lshlrev_b32 v94, 16, v251
  v_mfma_f32_16x16x32_bf16 v[56:59], v[112:115], a[152:155], v[56:59]
  v_and_b32 v95, 0xffff0000, v251
  v_fma_f32 v88, v88, v84, v86
  v_fma_f32 v89, v89, v84, v86
  v_fma_f32 v90, v90, v84, v86
  v_fma_f32 v91, v91, v84, v86
  v_mfma_f32_16x16x32_bf16 v[60:63], v[112:115], a[156:159], v[60:63]
  buffer_load_dwordx4 v[112:115], v1, s[4:7], s23 offen sc1
  v_fma_f32 v92, v92, v84, v86
  v_fma_f32 v93, v93, v84, v86
  s_waitcnt vmcnt(17)
  v_mfma_f32_16x16x32_bf16 v[76:79], v[116:119], a[156:159], v[76:79]
  v_fma_f32 v94, v94, v84, v86
  v_fma_f32 v95, v95, v84, v86
  v_cvt_pk_bf16_f32 v248, v88, v89
  v_cvt_pk_bf16_f32 v249, v90, v91
  v_cvt_pk_bf16_f32 v250, v92, v93
  v_mfma_f32_16x16x32_bf16 v[72:75], v[116:119], a[152:155], v[72:75]
  v_cvt_pk_bf16_f32 v251, v94, v95
  v_add_u32 v8, 0x10000, v8
  ds_write_b128 v8, v[248:251] offset:0
  v_mfma_f32_16x16x32_bf16 v[68:71], v[116:119], a[148:151], v[68:71]
  s_waitcnt vmcnt(19)
  v_lshlrev_b32 v88, 16, v252
  v_and_b32 v89, 0xffff0000, v252
  v_lshlrev_b32 v90, 16, v253
  v_and_b32 v91, 0xffff0000, v253
  v_mfma_f32_16x16x32_bf16 v[64:67], v[116:119], a[144:147], v[64:67]
  buffer_load_dwordx4 v[116:119], v1, s[4:7], s23 offen offset:1024 sc1
  v_lshlrev_b32 v92, 16, v254
  v_and_b32 v93, 0xffff0000, v254
  s_waitcnt vmcnt(17)
  v_mfma_f32_16x16x32_bf16 v[48:51], v[120:123], a[160:163], v[48:51]
  v_lshlrev_b32 v94, 16, v255
  v_and_b32 v95, 0xffff0000, v255
  v_fma_f32 v88, v88, v84, v86
  v_fma_f32 v89, v89, v84, v86
  v_fma_f32 v90, v90, v84, v86
  v_mfma_f32_16x16x32_bf16 v[52:55], v[120:123], a[164:167], v[52:55]
  v_fma_f32 v91, v91, v84, v86
  v_fma_f32 v92, v92, v84, v86
  v_fma_f32 v93, v93, v84, v86
  v_fma_f32 v94, v94, v84, v86
  v_mfma_f32_16x16x32_bf16 v[56:59], v[120:123], a[168:171], v[56:59]
  v_fma_f32 v95, v95, v84, v86
  v_cvt_pk_bf16_f32 v252, v88, v89
  v_cvt_pk_bf16_f32 v253, v90, v91
  v_cvt_pk_bf16_f32 v254, v92, v93
  v_cvt_pk_bf16_f32 v255, v94, v95
  v_mfma_f32_16x16x32_bf16 v[60:63], v[120:123], a[172:175], v[60:63]
  buffer_load_dwordx4 v[120:123], v1, s[4:7], s23 offen offset:2048 sc1
  s_add_u32 s23, s23, 0xc00
  ds_write_b128 v8, v[252:255] offset:4096
  s_waitcnt vmcnt(17)
  v_mfma_f32_16x16x32_bf16 v[76:79], v[124:127], a[172:175], v[76:79]
  s_waitcnt lgkmcnt(0)
  s_barrier
  v_mfma_f32_16x16x32_bf16 v[72:75], v[124:127], a[168:171], v[72:75]
  ds_read_b128 a[192:195], v3 offset:12288
  ds_read_b128 a[196:199], v3 offset:13312
  ds_read_b128 a[200:203], v3 offset:14336
  v_mfma_f32_16x16x32_bf16 v[68:71], v[124:127], a[164:167], v[68:71]
  ds_read_b128 a[204:207], v3 offset:15360
  ds_read_b128 a[208:211], v3 offset:16384
  v_mfma_f32_16x16x32_bf16 v[64:67], v[124:127], a[160:163], v[64:67]
  buffer_load_dwordx4 v[124:127], v1, s[4:7], s23 offen sc1
  ds_read_b128 a[212:215], v3 offset:17408
  ds_read_b128 a[216:219], v3 offset:18432
  ds_read_b128 a[220:223], v3 offset:19456
  s_waitcnt vmcnt(17)
  v_mfma_f32_16x16x32_bf16 v[48:51], v[128:131], a[176:179], v[48:51]
  ds_read_b128 a[224:227], v3 offset:20480
  ds_read_b128 a[228:231], v3 offset:21504
  v_mfma_f32_16x16x32_bf16 v[52:55], v[128:131], a[180:183], v[52:55]
  ds_read_b128 a[232:235], v3 offset:22528
  ds_read_b128 a[236:239], v3 offset:23552
  s_waitcnt lgkmcnt(6)
  v_mfma_f32_16x16x32_bf16 v[56:59], v[128:131], a[184:187], v[56:59]
  ds_read_b128 a[240:243], v3 offset:24576
  ds_read_b128 a[244:247], v3 offset:25600
  ds_read_b128 a[248:251], v3 offset:26624
  v_mfma_f32_16x16x32_bf16 v[60:63], v[128:131], a[188:191], v[60:63]
  buffer_load_dwordx4 v[128:131], v1, s[4:7], s23 offen offset:1024 sc1
  ds_read_b128 a[252:255], v3 offset:27648
  ds_read_b128 v[16:19], v3 offset:28672
  s_waitcnt vmcnt(17)
  v_mfma_f32_16x16x32_bf16 v[76:79], v[132:135], a[188:191], v[76:79]
  ds_read_b128 v[20:23], v3 offset:29696
  ds_read_b128 v[24:27], v3 offset:30720
  ds_read_b128 v[28:31], v3 offset:31744
  v_mfma_f32_16x16x32_bf16 v[72:75], v[132:135], a[184:187], v[72:75]
  ds_read_b128 v[32:35], v3 offset:32768
  ds_read_b128 v[36:39], v3 offset:33792
  v_mfma_f32_16x16x32_bf16 v[68:71], v[132:135], a[180:183], v[68:71]
  ds_read_b128 v[40:43], v3 offset:34816
  ds_read_b128 v[44:47], v3 offset:35840
  s_waitcnt lgkmcnt(6)
  v_mfma_f32_16x16x32_bf16 v[64:67], v[132:135], a[176:179], v[64:67]
  buffer_load_dwordx4 v[132:135], v1, s[4:7], s23 offen offset:2048 sc1
  s_add_u32 s23, s23, 0xc00
  s_waitcnt lgkmcnt(8)
  s_waitcnt vmcnt(17)
  v_mfma_f32_16x16x32_bf16 v[48:51], v[136:139], a[192:195], v[48:51]
  v_mfma_f32_16x16x32_bf16 v[52:55], v[136:139], a[196:199], v[52:55]
  v_mfma_f32_16x16x32_bf16 v[56:59], v[136:139], a[200:203], v[56:59]
  v_mfma_f32_16x16x32_bf16 v[60:63], v[136:139], a[204:207], v[60:63]
  buffer_load_dwordx4 v[136:139], v1, s[4:7], s23 offen sc1
  s_waitcnt lgkmcnt(0)
  s_waitcnt vmcnt(17)
  v_mfma_f32_16x16x32_bf16 v[76:79], v[140:143], a[204:207], v[76:79]
  v_mfma_f32_16x16x32_bf16 v[72:75], v[140:143], a[200:203], v[72:75]
  v_mfma_f32_16x16x32_bf16 v[68:71], v[140:143], a[196:199], v[68:71]
  v_mfma_f32_16x16x32_bf16 v[64:67], v[140:143], a[192:195], v[64:67]
  buffer_load_dwordx4 v[140:143], v1, s[4:7], s23 offen offset:1024 sc1
  s_waitcnt vmcnt(17)
  v_mfma_f32_16x16x32_bf16 v[48:51], v[144:147], a[208:211], v[48:51]
  v_mfma_f32_16x16x32_bf16 v[52:55], v[144:147], a[212:215], v[52:55]
  v_mfma_f32_16x16x32_bf16 v[56:59], v[144:147], a[216:219], v[56:59]
  v_mfma_f32_16x16x32_bf16 v[60:63], v[144:147], a[220:223], v[60:63]
  buffer_load_dwordx4 v[144:147], v1, s[4:7], s23 offen offset:2048 sc1
  s_add_u32 s23, s23, 0xc00
  s_waitcnt vmcnt(17)
  v_mfma_f32_16x16x32_bf16 v[76:79], v[148:151], a[220:223], v[76:79]
  v_mfma_f32_16x16x32_bf16 v[72:75], v[148:151], a[216:219], v[72:75]
  v_mfma_f32_16x16x32_bf16 v[68:71], v[148:151], a[212:215], v[68:71]
  v_mfma_f32_16x16x32_bf16 v[64:67], v[148:151], a[208:211], v[64:67]
  buffer_load_dwordx4 v[148:151], v1, s[4:7], s23 offen sc1
  s_waitcnt vmcnt(17)
  v_mfma_f32_16x16x32_bf16 v[48:51], v[152:155], a[224:227], v[48:51]
  v_mfma_f32_16x16x32_bf16 v[52:55], v[152:155], a[228:231], v[52:55]
  v_mfma_f32_16x16x32_bf16 v[56:59], v[152:155], a[232:235], v[56:59]
  v_mfma_f32_16x16x32_bf16 v[60:63], v[152:155], a[236:239], v[60:63]
  buffer_load_dwordx4 v[152:155], v1, s[4:7], s23 offen offset:1024 sc1
  s_waitcnt vmcnt(17)
  v_mfma_f32_16x16x32_bf16 v[76:79], v[156:159], a[236:239], v[76:79]
  v_mfma_f32_16x16x32_bf16 v[72:75], v[156:159], a[232:235], v[72:75]
  v_mfma_f32_16x16x32_bf16 v[68:71], v[156:159], a[228:231], v[68:71]
  v_mfma_f32_16x16x32_bf16 v[64:67], v[156:159], a[224:227], v[64:67]
  buffer_load_dwordx4 v[156:159], v1, s[4:7], s23 offen offset:2048 sc1
  s_add_u32 s23, s23, 0xc00
  s_waitcnt vmcnt(17)
  v_mfma_f32_16x16x32_bf16 v[48:51], v[160:163], a[240:243], v[48:51]
  v_mfma_f32_16x16x32_bf16 v[52:55], v[160:163], a[244:247], v[52:55]
  v_mfma_f32_16x16x32_bf16 v[56:59], v[160:163], a[248:251], v[56:59]
  v_mfma_f32_16x16x32_bf16 v[60:63], v[160:163], a[252:255], v[60:63]
  buffer_load_dwordx4 v[160:163], v1, s[4:7], s23 offen sc1
  s_waitcnt vmcnt(17)
  v_mfma_f32_16x16x32_bf16 v[76:79], v[164:167], a[252:255], v[76:79]
  v_mfma_f32_16x16x32_bf16 v[72:75], v[164:167], a[248:251], v[72:75]
  v_mfma_f32_16x16x32_bf16 v[68:71], v[164:167], a[244:247], v[68:71]
  v_mfma_f32_16x16x32_bf16 v[64:67], v[164:167], a[240:243], v[64:67]
  buffer_load_dwordx4 v[164:167], v1, s[4:7], s23 offen offset:1024 sc1
  s_waitcnt vmcnt(17)
  v_mfma_f32_16x16x32_bf16 v[48:51], v[168:171], v[16:19], v[48:51]
  v_mfma_f32_16x16x32_bf16 v[52:55], v[168:171], v[20:23], v[52:55]
  v_mfma_f32_16x16x32_bf16 v[56:59], v[168:171], v[24:27], v[56:59]
  v_mfma_f32_16x16x32_bf16 v[60:63], v[168:171], v[28:31], v[60:63]
  buffer_load_dwordx4 v[168:171], v1, s[4:7], s23 offen offset:2048 sc1
  s_add_u32 s23, s23, 0xc00
  s_waitcnt vmcnt(17)
  v_mfma_f32_16x16x32_bf16 v[76:79], v[172:175], v[28:31], v[76:79]
  v_mfma_f32_16x16x32_bf16 v[72:75], v[172:175], v[24:27], v[72:75]
  v_mfma_f32_16x16x32_bf16 v[68:71], v[172:175], v[20:23], v[68:71]
  v_mfma_f32_16x16x32_bf16 v[64:67], v[172:175], v[16:19], v[64:67]
  buffer_load_dwordx4 v[172:175], v1, s[4:7], s23 offen sc1
  s_waitcnt vmcnt(17)
  v_mfma_f32_16x16x32_bf16 v[48:51], v[176:179], v[32:35], v[48:51]
  v_mfma_f32_16x16x32_bf16 v[52:55], v[176:179], v[36:39], v[52:55]
  v_mfma_f32_16x16x32_bf16 v[56:59], v[176:179], v[40:43], v[56:59]
  v_mfma_f32_16x16x32_bf16 v[60:63], v[176:179], v[44:47], v[60:63]
  buffer_load_dwordx4 v[176:179], v1, s[4:7], s23 offen offset:1024 sc1
  s_waitcnt vmcnt(17)
  v_mfma_f32_16x16x32_bf16 v[76:79], v[180:183], v[44:47], v[76:79]
  v_mfma_f32_16x16x32_bf16 v[72:75], v[180:183], v[40:43], v[72:75]
  v_mfma_f32_16x16x32_bf16 v[68:71], v[180:183], v[36:39], v[68:71]
  v_mfma_f32_16x16x32_bf16 v[64:67], v[180:183], v[32:35], v[64:67]
  buffer_load_dwordx4 v[180:183], v1, s[4:7], s23 offen offset:2048 sc1
  s_add_u32 s23, s23, 0xc00
  s_barrier
  s_mov_b32 s25, 4
  s_mov_b32 s26, 99
  s_cmp_lg_u32 s3, 0
  s_cbranch_scc1 ffn_loopA_odd
  s_waitcnt vmcnt(17)
  v_mfma_f32_16x16x32_bf16 v[80:83], v[112:115], a[0:3], 0
  v_mfma_f32_16x16x32_bf16 v[84:87], v[112:115], a[4:7], 0
  v_mfma_f32_16x16x32_bf16 v[88:91], v[112:115], a[8:11], 0
  v_lshrrev_b32 v250, 4, v0
  v_bfe_u32 v251, v0, 2, 2
  v_and_b32 v252, 7, v0
  v_lshlrev_b32 v253, 1, v250
  v_xor_b32 v253, v253, v252
  v_lshlrev_b32 v253, 4, v253
  v_lshrrev_b32 v254, 3, v0
  s_lshl_b32 s76, s20, 3
  v_add_u32 v254, s76, v254
  v_mul_u32_u24 v254, 1152, v254
  v_add_u32 v241, v253, v254
  v_add_u32 v243, 73728, v13
  v_add_u32 v246, 512, v243
  v_lshlrev_b32 v253, 9, v250
  v_sub_u32 v244, v243, v253
  v_add_u32 v247, 2048, v244
  s_cmp_lt_u32 s74, 2
  s_cselect_b64 vcc, -1, 0
  v_cndmask_b32 v242, v241, v12, vcc
  v_cndmask_b32 v245, v244, v243, vcc
  v_cndmask_b32 v248, v247, v246, vcc
  v_mfma_f32_16x16x32_bf16 v[92:95], v[112:115], a[12:15], 0
  buffer_load_dwordx4 v[112:115], v1, s[4:7], s23 offen sc1
  s_waitcnt vmcnt(17)
  v_mfma_f32_16x16x32_bf16 v[108:111], v[116:119], a[12:15], 0
  v_mfma_f32_16x16x32_bf16 v[104:107], v[116:119], a[8:11], 0
  v_mfma_f32_16x16x32_bf16 v[100:103], v[116:119], a[4:7], 0
  v_mul_f32 v184, v48, v48
  v_mul_f32 v185, v49, v49
  v_mfma_f32_16x16x32_bf16 v[96:99], v[116:119], a[0:3], 0
  buffer_load_dwordx4 v[116:119], v1, s[4:7], s23 offen offset:1024 sc1
  s_waitcnt vmcnt(17)
  v_mfma_f32_16x16x32_bf16 v[80:83], v[120:123], a[16:19], v[80:83]
  v_mul_f32 v186, v50, v50
  v_mfma_f32_16x16x32_bf16 v[84:87], v[120:123], a[20:23], v[84:87]
  v_mul_f32 v187, v51, v51
  v_fmaak_f32 v184, v184, v4, 0xc0135761
  v_mfma_f32_16x16x32_bf16 v[88:91], v[120:123], a[24:27], v[88:91]
  v_fmaak_f32 v185, v185, v4, 0xc0135761
  v_fmaak_f32 v186, v186, v4, 0xc0135761
  v_mfma_f32_16x16x32_bf16 v[92:95], v[120:123], a[28:31], v[92:95]
  buffer_load_dwordx4 v[120:123], v1, s[4:7], s23 offen offset:2048 sc1
  s_add_u32 s23, s23, 0xc00
  s_waitcnt vmcnt(17)
  v_mfma_f32_16x16x32_bf16 v[108:111], v[124:127], a[28:31], v[108:111]
  v_fmaak_f32 v187, v187, v4, 0xc0135761
  v_mul_f32 v184, v184, v48
  v_mfma_f32_16x16x32_bf16 v[104:107], v[124:127], a[24:27], v[104:107]
  v_mul_f32 v185, v185, v49
  v_mfma_f32_16x16x32_bf16 v[100:103], v[124:127], a[20:23], v[100:103]
  v_mul_f32 v186, v186, v50
  v_mul_f32 v187, v187, v51
  v_mfma_f32_16x16x32_bf16 v[96:99], v[124:127], a[16:19], v[96:99]
  buffer_load_dwordx4 v[124:127], v1, s[4:7], s23 offen sc1
  s_waitcnt vmcnt(17)
  v_mfma_f32_16x16x32_bf16 v[80:83], v[128:131], a[32:35], v[80:83]
  v_exp_f32 v184, v184
  v_mfma_f32_16x16x32_bf16 v[84:87], v[128:131], a[36:39], v[84:87]
  v_mul_f32 v48, v48, v64
  v_mfma_f32_16x16x32_bf16 v[88:91], v[128:131], a[40:43], v[88:91]
  v_exp_f32 v185, v185
  v_mfma_f32_16x16x32_bf16 v[92:95], v[128:131], a[44:47], v[92:95]
  buffer_load_dwordx4 v[128:131], v1, s[4:7], s23 offen offset:1024 sc1
  s_waitcnt vmcnt(17)
  v_mfma_f32_16x16x32_bf16 v[108:111], v[132:135], a[44:47], v[108:111]
  v_mul_f32 v49, v49, v65
  v_exp_f32 v186, v186
  v_mfma_f32_16x16x32_bf16 v[104:107], v[132:135], a[40:43], v[104:107]
  v_mul_f32 v50, v50, v66
  v_mfma_f32_16x16x32_bf16 v[100:103], v[132:135], a[36:39], v[100:103]
  v_exp_f32 v187, v187
  v_mfma_f32_16x16x32_bf16 v[96:99], v[132:135], a[32:35], v[96:99]
  buffer_load_dwordx4 v[132:135], v1, s[4:7], s23 offen offset:2048 sc1
  s_add_u32 s23, s23, 0xc00
  s_waitcnt vmcnt(17)
  v_mfma_f32_16x16x32_bf16 v[80:83], v[136:139], a[48:51], v[80:83]
  v_mul_f32 v51, v51, v67
  s_add_u32 m0, s88, 73728
  v_mfma_f32_16x16x32_bf16 v[84:87], v[136:139], a[52:55], v[84:87]
  v_add_f32 v184, 1.0, v184
  v_add_f32 v185, 1.0, v185
  buffer_load_dwordx4 v12, s[60:63], s44 offen lds
  v_mfma_f32_16x16x32_bf16 v[88:91], v[136:139], a[56:59], v[88:91]
  v_add_f32 v186, 1.0, v186
  v_add_f32 v187, 1.0, v187
  v_mfma_f32_16x16x32_bf16 v[92:95], v[136:139], a[60:63], v[92:95]
  buffer_load_dwordx4 v[136:139], v1, s[4:7], s23 offen sc1
  s_waitcnt vmcnt(18)
  v_mfma_f32_16x16x32_bf16 v[108:111], v[140:143], a[60:63], v[108:111]
  v_rcp_f32 v184, v184
  v_mfma_f32_16x16x32_bf16 v[104:107], v[140:143], a[56:59], v[104:107]
  v_rcp_f32 v185, v185
  v_mfma_f32_16x16x32_bf16 v[100:103], v[140:143], a[52:55], v[100:103]
  v_mfma_f32_16x16x32_bf16 v[96:99], v[140:143], a[48:51], v[96:99]
  buffer_load_dwordx4 v[140:143], v1, s[4:7], s23 offen offset:1024 sc1
  s_waitcnt vmcnt(18)
  v_mfma_f32_16x16x32_bf16 v[80:83], v[144:147], a[64:67], v[80:83]
  v_rcp_f32 v186, v186
  v_mfma_f32_16x16x32_bf16 v[84:87], v[144:147], a[68:71], v[84:87]
  v_rcp_f32 v187, v187
  v_mfma_f32_16x16x32_bf16 v[88:91], v[144:147], a[72:75], v[88:91]
  v_mul_f32 v48, v48, v184
  v_mul_f32 v49, v49, v185
  v_mfma_f32_16x16x32_bf16 v[92:95], v[144:147], a[76:79], v[92:95]
  buffer_load_dwordx4 v[144:147], v1, s[4:7], s23 offen offset:2048 sc1
  s_add_u32 s23, s23, 0xc00
  s_waitcnt vmcnt(18)
  v_mfma_f32_16x16x32_bf16 v[108:111], v[148:151], a[76:79], v[108:111]
  v_mul_f32 v50, v50, v186
  v_mul_f32 v51, v51, v187
  s_add_u32 m0, s88, 77824
  v_mfma_f32_16x16x32_bf16 v[104:107], v[148:151], a[72:75], v[104:107]
  v_cvt_pk_bf16_f32 v192, v48, v49
  v_cvt_pk_bf16_f32 v193, v50, v51
  buffer_load_dwordx4 v12, s[64:67], s45 offen lds
  v_mfma_f32_16x16x32_bf16 v[100:103], v[148:151], a[68:71], v[100:103]
  ds_write_b64 v6, v[192:193] offset:0
  v_mfma_f32_16x16x32_bf16 v[96:99], v[148:151], a[64:67], v[96:99]
  buffer_load_dwordx4 v[148:151], v1, s[4:7], s23 offen sc1
  s_waitcnt vmcnt(19)
  v_mfma_f32_16x16x32_bf16 v[80:83], v[152:155], a[80:83], v[80:83]
  v_mul_f32 v188, v52, v52
  v_mfma_f32_16x16x32_bf16 v[84:87], v[152:155], a[84:87], v[84:87]
  v_mul_f32 v189, v53, v53
  v_mul_f32 v190, v54, v54
  v_mfma_f32_16x16x32_bf16 v[88:91], v[152:155], a[88:91], v[88:91]
  v_mul_f32 v191, v55, v55
  v_fmaak_f32 v188, v188, v4, 0xc0135761
  v_mfma_f32_16x16x32_bf16 v[92:95], v[152:155], a[92:95], v[92:95]
  buffer_load_dwordx4 v[152:155], v1, s[4:7], s23 offen offset:1024 sc1
  s_waitcnt vmcnt(19)
  v_mfma_f32_16x16x32_bf16 v[108:111], v[156:159], a[92:95], v[108:111]
  v_fmaak_f32 v189, v189, v4, 0xc0135761
  v_mfma_f32_16x16x32_bf16 v[104:107], v[156:159], a[88:91], v[104:107]
  v_fmaak_f32 v190, v190, v4, 0xc0135761
  v_fmaak_f32 v191, v191, v4, 0xc0135761
  v_mfma_f32_16x16x32_bf16 v[100:103], v[156:159], a[84:87], v[100:103]
  v_mul_f32 v188, v188, v52
  v_mul_f32 v189, v189, v53
  v_mfma_f32_16x16x32_bf16 v[96:99], v[156:159], a[80:83], v[96:99]
  buffer_load_dwordx4 v[156:159], v1, s[4:7], s23 offen offset:2048 sc1
  s_add_u32 s23, s23, 0xc00
  s_waitcnt vmcnt(19)
  v_mfma_f32_16x16x32_bf16 v[80:83], v[160:163], a[96:99], v[80:83]
  v_mul_f32 v190, v190, v54
  v_mul_f32 v191, v191, v55
  v_mfma_f32_16x16x32_bf16 v[84:87], v[160:163], a[100:103], v[84:87]
  v_exp_f32 v188, v188
  v_mfma_f32_16x16x32_bf16 v[88:91], v[160:163], a[104:107], v[88:91]
  v_mul_f32 v52, v52, v68
  v_mfma_f32_16x16x32_bf16 v[92:95], v[160:163], a[108:111], v[92:95]
  buffer_load_dwordx4 v[160:163], v1, s[4:7], s23 offen sc1
  s_waitcnt vmcnt(19)
  v_mfma_f32_16x16x32_bf16 v[108:111], v[164:167], a[108:111], v[108:111]
  v_exp_f32 v189, v189
  s_add_u32 m0, s88, 81920
  v_mfma_f32_16x16x32_bf16 v[104:107], v[164:167], a[104:107], v[104:107]
  v_mul_f32 v53, v53, v69
  buffer_load_dwordx4 v242, s[80:83], s47 offen lds
  v_mfma_f32_16x16x32_bf16 v[100:103], v[164:167], a[100:103], v[100:103]
  v_exp_f32 v190, v190
  v_mfma_f32_16x16x32_bf16 v[96:99], v[164:167], a[96:99], v[96:99]
  buffer_load_dwordx4 v[164:167], v1, s[4:7], s23 offen offset:1024 sc1
  s_waitcnt vmcnt(20)
  v_mfma_f32_16x16x32_bf16 v[80:83], v[168:171], a[112:115], v[80:83]
  v_mul_f32 v54, v54, v70
  v_mfma_f32_16x16x32_bf16 v[84:87], v[168:171], a[116:119], v[84:87]
  v_exp_f32 v191, v191
  v_mul_f32 v55, v55, v71
  v_mfma_f32_16x16x32_bf16 v[88:91], v[168:171], a[120:123], v[88:91]
  v_add_f32 v188, 1.0, v188
  v_mfma_f32_16x16x32_bf16 v[92:95], v[168:171], a[124:127], v[92:95]
  buffer_load_dwordx4 v[168:171], v1, s[4:7], s23 offen offset:2048 sc1
  s_add_u32 s23, s23, 0xc00
  s_waitcnt vmcnt(20)
  v_mfma_f32_16x16x32_bf16 v[108:111], v[172:175], a[124:127], v[108:111]
  v_add_f32 v189, 1.0, v189
  v_add_f32 v190, 1.0, v190
  v_mfma_f32_16x16x32_bf16 v[104:107], v[172:175], a[120:123], v[104:107]
  v_add_f32 v191, 1.0, v191
  v_mfma_f32_16x16x32_bf16 v[100:103], v[172:175], a[116:119], v[100:103]
  v_rcp_f32 v188, v188
  v_mfma_f32_16x16x32_bf16 v[96:99], v[172:175], a[112:115], v[96:99]
  buffer_load_dwordx4 v[172:175], v1, s[4:7], s23 offen sc1
  s_waitcnt vmcnt(20)
  v_mfma_f32_16x16x32_bf16 v[80:83], v[176:179], a[128:131], v[80:83]
  v_rcp_f32 v189, v189
  s_add_u32 m0, s88, 86016
  v_mfma_f32_16x16x32_bf16 v[84:87], v[176:179], a[132:135], v[84:87]
  v_rcp_f32 v190, v190
  buffer_load_dwordx4 v242, s[84:87], s48 offen lds
  v_mfma_f32_16x16x32_bf16 v[88:91], v[176:179], a[136:139], v[88:91]
  v_rcp_f32 v191, v191
  v_mfma_f32_16x16x32_bf16 v[92:95], v[176:179], a[140:143], v[92:95]
  buffer_load_dwordx4 v[176:179], v1, s[4:7], s23 offen offset:1024 sc1
  s_waitcnt vmcnt(21)
  v_mfma_f32_16x16x32_bf16 v[108:111], v[180:183], a[140:143], v[108:111]
  v_mul_f32 v52, v52, v188
  v_mul_f32 v53, v53, v189
  v_mfma_f32_16x16x32_bf16 v[104:107], v[180:183], a[136:139], v[104:107]
  v_mul_f32 v54, v54, v190
  v_mfma_f32_16x16x32_bf16 v[100:103], v[180:183], a[132:135], v[100:103]
  v_mul_f32 v55, v55, v191
  v_cvt_pk_bf16_f32 v194, v52, v53
  v_mfma_f32_16x16x32_bf16 v[96:99], v[180:183], a[128:131], v[96:99]
  buffer_load_dwordx4 v[180:183], v1, s[4:7], s23 offen offset:2048 sc1
  s_add_u32 s23, s23, 0xc00
  s_waitcnt vmcnt(21)
  v_mfma_f32_16x16x32_bf16 v[80:83], v[112:115], a[144:147], v[80:83]
  v_cvt_pk_bf16_f32 v195, v54, v55
  v_mfma_f32_16x16x32_bf16 v[84:87], v[112:115], a[148:151], v[84:87]
  ds_write_b64 v6, v[194:195] offset:1024
  v_mul_f32 v184, v56, v56
  v_mfma_f32_16x16x32_bf16 v[88:91], v[112:115], a[152:155], v[88:91]
  v_mul_f32 v185, v57, v57
  v_mfma_f32_16x16x32_bf16 v[92:95], v[112:115], a[156:159], v[92:95]
  buffer_load_dwordx4 v[112:115], v1, s[4:7], s23 offen sc1
  s_waitcnt vmcnt(21)
  v_mfma_f32_16x16x32_bf16 v[108:111], v[116:119], a[156:159], v[108:111]
  v_mul_f32 v186, v58, v58
  v_mul_f32 v187, v59, v59
  v_mfma_f32_16x16x32_bf16 v[104:107], v[116:119], a[152:155], v[104:107]
  v_fmaak_f32 v184, v184, v4, 0xc0135761
  v_fmaak_f32 v185, v185, v4, 0xc0135761
  v_mfma_f32_16x16x32_bf16 v[100:103], v[116:119], a[148:151], v[100:103]
  v_fmaak_f32 v186, v186, v4, 0xc0135761
  v_mfma_f32_16x16x32_bf16 v[96:99], v[116:119], a[144:147], v[96:99]
  buffer_load_dwordx4 v[116:119], v1, s[4:7], s23 offen offset:1024 sc1
  s_waitcnt vmcnt(21)
  v_mfma_f32_16x16x32_bf16 v[80:83], v[120:123], a[160:163], v[80:83]
  v_fmaak_f32 v187, v187, v4, 0xc0135761
  v_mul_f32 v184, v184, v56
  s_add_u32 m0, s88, 90112
  v_mfma_f32_16x16x32_bf16 v[84:87], v[120:123], a[164:167], v[84:87]
  v_mul_f32 v185, v185, v57
  v_mul_f32 v186, v186, v58
  buffer_load_dwordx4 v241, s[36:39], s50 offen lds
  v_mfma_f32_16x16x32_bf16 v[88:91], v[120:123], a[168:171], v[88:91]
  v_mul_f32 v187, v187, v59
  v_mfma_f32_16x16x32_bf16 v[92:95], v[120:123], a[172:175], v[92:95]
  buffer_load_dwordx4 v[120:123], v1, s[4:7], s23 offen offset:2048 sc1
  s_add_u32 s23, s23, 0xc00
  s_waitcnt vmcnt(22)
  v_mfma_f32_16x16x32_bf16 v[108:111], v[124:127], a[172:175], v[108:111]
  v_exp_f32 v184, v184
  v_mfma_f32_16x16x32_bf16 v[104:107], v[124:127], a[168:171], v[104:107]
  v_mul_f32 v56, v56, v72
  v_exp_f32 v185, v185
  v_mfma_f32_16x16x32_bf16 v[100:103], v[124:127], a[164:167], v[100:103]
  v_mul_f32 v57, v57, v73
  v_mfma_f32_16x16x32_bf16 v[96:99], v[124:127], a[160:163], v[96:99]
  buffer_load_dwordx4 v[124:127], v1, s[4:7], s23 offen sc1
  s_waitcnt vmcnt(22)
  v_mfma_f32_16x16x32_bf16 v[80:83], v[128:131], a[176:179], v[80:83]
  v_exp_f32 v186, v186
  v_mfma_f32_16x16x32_bf16 v[84:87], v[128:131], a[180:183], v[84:87]
  v_mul_f32 v58, v58, v74
  v_mfma_f32_16x16x32_bf16 v[88:91], v[128:131], a[184:187], v[88:91]
  v_exp_f32 v187, v187
  v_mfma_f32_16x16x32_bf16 v[92:95], v[128:131], a[188:191], v[92:95]
  buffer_load_dwordx4 v[128:131], v1, s[4:7], s23 offen offset:1024 sc1
  s_waitcnt vmcnt(22)
  v_mfma_f32_16x16x32_bf16 v[108:111], v[132:135], a[188:191], v[108:111]
  v_mul_f32 v59, v59, v75
  v_add_f32 v184, 1.0, v184
  s_add_u32 m0, s88, 94208
  v_mfma_f32_16x16x32_bf16 v[104:107], v[132:135], a[184:187], v[104:107]
  v_add_f32 v185, 1.0, v185
  v_add_f32 v186, 1.0, v186
  buffer_load_dwordx4 v241, s[36:39], s51 offen lds
  v_mfma_f32_16x16x32_bf16 v[100:103], v[132:135], a[180:183], v[100:103]
  v_add_f32 v187, 1.0, v187
  v_mfma_f32_16x16x32_bf16 v[96:99], v[132:135], a[176:179], v[96:99]
  buffer_load_dwordx4 v[132:135], v1, s[4:7], s23 offen offset:2048 sc1
  s_add_u32 s23, s23, 0xc00
  s_waitcnt vmcnt(22)
  v_mfma_f32_16x16x32_bf16 v[80:83], v[136:139], a[192:195], v[80:83]
  v_rcp_f32 v184, v184
  v_mfma_f32_16x16x32_bf16 v[84:87], v[136:139], a[196:199], v[84:87]
  v_rcp_f32 v185, v185
  v_mfma_f32_16x16x32_bf16 v[88:91], v[136:139], a[200:203], v[88:91]
  v_rcp_f32 v186, v186
  v_mfma_f32_16x16x32_bf16 v[92:95], v[136:139], a[204:207], v[92:95]
  buffer_load_dwordx4 v[136:139], v1, s[4:7], s23 offen sc1
  s_waitcnt vmcnt(22)
  v_mfma_f32_16x16x32_bf16 v[108:111], v[140:143], a[204:207], v[108:111]
  v_rcp_f32 v187, v187
  v_mfma_f32_16x16x32_bf16 v[104:107], v[140:143], a[200:203], v[104:107]
  v_mul_f32 v56, v56, v184
  v_mfma_f32_16x16x32_bf16 v[100:103], v[140:143], a[196:199], v[100:103]
  v_mul_f32 v57, v57, v185
  v_mul_f32 v58, v58, v186
  v_mfma_f32_16x16x32_bf16 v[96:99], v[140:143], a[192:195], v[96:99]
  buffer_load_dwordx4 v[140:143], v1, s[4:7], s23 offen offset:1024 sc1
  s_waitcnt vmcnt(22)
  v_mfma_f32_16x16x32_bf16 v[80:83], v[144:147], a[208:211], v[80:83]
  v_mul_f32 v59, v59, v187
  v_mfma_f32_16x16x32_bf16 v[84:87], v[144:147], a[212:215], v[84:87]
  v_cvt_pk_bf16_f32 v196, v56, v57
  v_cvt_pk_bf16_f32 v197, v58, v59
  v_mfma_f32_16x16x32_bf16 v[88:91], v[144:147], a[216:219], v[88:91]
  ds_write_b64 v6, v[196:197] offset:2048
  v_mfma_f32_16x16x32_bf16 v[92:95], v[144:147], a[220:223], v[92:95]
  buffer_load_dwordx4 v[144:147], v1, s[4:7], s23 offen offset:2048 sc1
  s_add_u32 s23, s23, 0xc00
  s_waitcnt vmcnt(21)
  v_mfma_f32_16x16x32_bf16 v[108:111], v[148:151], a[220:223], v[108:111]
  v_mul_f32 v188, v60, v60
  v_mul_f32 v189, v61, v61
  s_add_u32 m0, s88, 98304
  v_mfma_f32_16x16x32_bf16 v[104:107], v[148:151], a[216:219], v[104:107]
  v_mul_f32 v190, v62, v62
  buffer_load_dwordx4 v241, s[36:39], s53 offen lds
  v_mfma_f32_16x16x32_bf16 v[100:103], v[148:151], a[212:215], v[100:103]
  v_mul_f32 v191, v63, v63
  v_fmaak_f32 v188, v188, v4, 0xc0135761
  v_mfma_f32_16x16x32_bf16 v[96:99], v[148:151], a[208:211], v[96:99]
  buffer_load_dwordx4 v[148:151], v1, s[4:7], s23 offen sc1
  s_waitcnt vmcnt(22)
  v_mfma_f32_16x16x32_bf16 v[80:83], v[152:155], a[224:227], v[80:83]
  v_fmaak_f32 v189, v189, v4, 0xc0135761
  v_fmaak_f32 v190, v190, v4, 0xc0135761
  v_mfma_f32_16x16x32_bf16 v[84:87], v[152:155], a[228:231], v[84:87]
  v_fmaak_f32 v191, v191, v4, 0xc0135761
  v_mul_f32 v188, v188, v60
  v_mfma_f32_16x16x32_bf16 v[88:91], v[152:155], a[232:235], v[88:91]
  v_mul_f32 v189, v189, v61
  v_mfma_f32_16x16x32_bf16 v[92:95], v[152:155], a[236:239], v[92:95]
  buffer_load_dwordx4 v[152:155], v1, s[4:7], s23 offen offset:1024 sc1
  s_waitcnt vmcnt(22)
  v_mfma_f32_16x16x32_bf16 v[108:111], v[156:159], a[236:239], v[108:111]
  v_mul_f32 v190, v190, v62
  v_mul_f32 v191, v191, v63
  v_mfma_f32_16x16x32_bf16 v[104:107], v[156:159], a[232:235], v[104:107]
  v_exp_f32 v188, v188
  v_mfma_f32_16x16x32_bf16 v[100:103], v[156:159], a[228:231], v[100:103]
  v_mul_f32 v60, v60, v76
  v_mfma_f32_16x16x32_bf16 v[96:99], v[156:159], a[224:227], v[96:99]
  buffer_load_dwordx4 v[156:159], v1, s[4:7], s23 offen offset:2048 sc1
  s_add_u32 s23, s23, 0xc00
  s_waitcnt vmcnt(22)
  v_mfma_f32_16x16x32_bf16 v[80:83], v[160:163], a[240:243], v[80:83]
  v_exp_f32 v189, v189
  s_add_u32 m0, s88, 102400
  v_mfma_f32_16x16x32_bf16 v[84:87], v[160:163], a[244:247], v[84:87]
  v_mul_f32 v61, v61, v77
  buffer_load_dwordx4 v241, s[36:39], s54 offen lds
  v_mfma_f32_16x16x32_bf16 v[88:91], v[160:163], a[248:251], v[88:91]
  v_exp_f32 v190, v190
  v_mul_f32 v62, v62, v78
  v_mfma_f32_16x16x32_bf16 v[92:95], v[160:163], a[252:255], v[92:95]
  buffer_load_dwordx4 v[160:163], v1, s[4:7], s23 offen sc1
  s_waitcnt vmcnt(22)
  v_mfma_f32_16x16x32_bf16 v[108:111], v[164:167], a[252:255], v[108:111]
  v_exp_f32 v191, v191
  v_mfma_f32_16x16x32_bf16 v[104:107], v[164:167], a[248:251], v[104:107]
  v_mul_f32 v63, v63, v79
  v_mfma_f32_16x16x32_bf16 v[100:103], v[164:167], a[244:247], v[100:103]
  v_add_f32 v188, 1.0, v188
  v_add_f32 v189, 1.0, v189
  v_mfma_f32_16x16x32_bf16 v[96:99], v[164:167], a[240:243], v[96:99]
  buffer_load_dwordx4 v[164:167], v1, s[4:7], s23 offen offset:1024 sc1
  s_waitcnt vmcnt(22)
  v_mfma_f32_16x16x32_bf16 v[80:83], v[168:171], v[16:19], v[80:83]
  v_add_f32 v190, 1.0, v190
  v_add_f32 v191, 1.0, v191
  v_mfma_f32_16x16x32_bf16 v[84:87], v[168:171], v[20:23], v[84:87]
  v_rcp_f32 v188, v188
  v_mfma_f32_16x16x32_bf16 v[88:91], v[168:171], v[24:27], v[88:91]
  v_rcp_f32 v189, v189
  v_mfma_f32_16x16x32_bf16 v[92:95], v[168:171], v[28:31], v[92:95]
  buffer_load_dwordx4 v[168:171], v1, s[4:7], s23 offen offset:2048 sc1
  s_add_u32 s23, s23, 0xc00
  s_waitcnt vmcnt(22)
  v_mfma_f32_16x16x32_bf16 v[108:111], v[172:175], v[28:31], v[108:111]
  v_mfma_f32_16x16x32_bf16 v[104:107], v[172:175], v[24:27], v[104:107]
  v_rcp_f32 v190, v190
  v_mfma_f32_16x16x32_bf16 v[100:103], v[172:175], v[20:23], v[100:103]
  v_rcp_f32 v191, v191
  v_mfma_f32_16x16x32_bf16 v[96:99], v[172:175], v[16:19], v[96:99]
  buffer_load_dwordx4 v[172:175], v1, s[4:7], s23 offen sc1
  s_waitcnt vmcnt(21)
  v_mfma_f32_16x16x32_bf16 v[80:83], v[176:179], v[32:35], v[80:83]
  v_mul_f32 v60, v60, v188
  v_mul_f32 v61, v61, v189
  v_mfma_f32_16x16x32_bf16 v[84:87], v[176:179], v[36:39], v[84:87]
  v_mul_f32 v62, v62, v190
  v_mul_f32 v63, v63, v191
  v_mfma_f32_16x16x32_bf16 v[88:91], v[176:179], v[40:43], v[88:91]
  v_cvt_pk_bf16_f32 v198, v60, v61
  v_cvt_pk_bf16_f32 v199, v62, v63
  v_mfma_f32_16x16x32_bf16 v[92:95], v[176:179], v[44:47], v[92:95]
  buffer_load_dwordx4 v[176:179], v1, s[4:7], s23 offen offset:1024 sc1
  s_waitcnt vmcnt(21)
  v_mfma_f32_16x16x32_bf16 v[108:111], v[180:183], v[44:47], v[108:111]
  ds_write_b64 v6, v[198:199] offset:3072
  v_mfma_f32_16x16x32_bf16 v[104:107], v[180:183], v[40:43], v[104:107]
  v_add_u32 v6, 0x2000, v6
  v_mfma_f32_16x16x32_bf16 v[100:103], v[180:183], v[36:39], v[100:103]
  v_mfma_f32_16x16x32_bf16 v[96:99], v[180:183], v[32:35], v[96:99]
  buffer_load_dwordx4 v[180:183], v1, s[4:7], s23 offen offset:2048 sc1
  s_add_u32 s23, s23, 0xc00
  s_waitcnt vmcnt(17)
  v_mfma_f32_16x16x32_bf16 v[48:51], v[112:115], a[0:3], 0
  v_mfma_f32_16x16x32_bf16 v[52:55], v[112:115], a[4:7], 0
  v_mfma_f32_16x16x32_bf16 v[56:59], v[112:115], a[8:11], 0
  v_mfma_f32_16x16x32_bf16 v[60:63], v[112:115], a[12:15], 0
  buffer_load_dwordx4 v[112:115], v1, s[4:7], s23 offen sc1
  s_waitcnt vmcnt(17)
  v_mfma_f32_16x16x32_bf16 v[76:79], v[116:119], a[12:15], 0
  v_mfma_f32_16x16x32_bf16 v[72:75], v[116:119], a[8:11], 0
  v_mfma_f32_16x16x32_bf16 v[68:71], v[116:119], a[4:7], 0
  v_mul_f32 v184, v80, v80
  v_mul_f32 v185, v81, v81
  v_mfma_f32_16x16x32_bf16 v[64:67], v[116:119], a[0:3], 0
  buffer_load_dwordx4 v[116:119], v1, s[4:7], s23 offen offset:1024 sc1
  s_waitcnt vmcnt(17)
  v_mfma_f32_16x16x32_bf16 v[48:51], v[120:123], a[16:19], v[48:51]
  v_mul_f32 v186, v82, v82
  v_mfma_f32_16x16x32_bf16 v[52:55], v[120:123], a[20:23], v[52:55]
  v_mul_f32 v187, v83, v83
  v_fmaak_f32 v184, v184, v4, 0xc0135761
  v_mfma_f32_16x16x32_bf16 v[56:59], v[120:123], a[24:27], v[56:59]
  v_fmaak_f32 v185, v185, v4, 0xc0135761
  v_fmaak_f32 v186, v186, v4, 0xc0135761
  v_mfma_f32_16x16x32_bf16 v[60:63], v[120:123], a[28:31], v[60:63]
  buffer_load_dwordx4 v[120:123], v1, s[4:7], s23 offen offset:2048 sc1
  s_add_u32 s23, s23, 0xc00
  s_waitcnt vmcnt(17)
  v_mfma_f32_16x16x32_bf16 v[76:79], v[124:127], a[28:31], v[76:79]
  v_fmaak_f32 v187, v187, v4, 0xc0135761
  v_mul_f32 v184, v184, v80
  v_mfma_f32_16x16x32_bf16 v[72:75], v[124:127], a[24:27], v[72:75]
  v_mul_f32 v185, v185, v81
  v_mfma_f32_16x16x32_bf16 v[68:71], v[124:127], a[20:23], v[68:71]
  v_mul_f32 v186, v186, v82
  v_mul_f32 v187, v187, v83
  v_mfma_f32_16x16x32_bf16 v[64:67], v[124:127], a[16:19], v[64:67]
  buffer_load_dwordx4 v[124:127], v1, s[4:7], s23 offen sc1
  s_waitcnt vmcnt(17)
  v_mfma_f32_16x16x32_bf16 v[48:51], v[128:131], a[32:35], v[48:51]
  v_exp_f32 v184, v184
  v_mfma_f32_16x16x32_bf16 v[52:55], v[128:131], a[36:39], v[52:55]
  v_mul_f32 v80, v80, v96
  v_mfma_f32_16x16x32_bf16 v[56:59], v[128:131], a[40:43], v[56:59]
  v_exp_f32 v185, v185
  v_mfma_f32_16x16x32_bf16 v[60:63], v[128:131], a[44:47], v[60:63]
  buffer_load_dwordx4 v[128:131], v1, s[4:7], s23 offen offset:1024 sc1
  s_waitcnt vmcnt(17)
  v_mfma_f32_16x16x32_bf16 v[76:79], v[132:135], a[44:47], v[76:79]
  v_mul_f32 v81, v81, v97
  v_exp_f32 v186, v186
  v_mfma_f32_16x16x32_bf16 v[72:75], v[132:135], a[40:43], v[72:75]
  v_mul_f32 v82, v82, v98
  v_mfma_f32_16x16x32_bf16 v[68:71], v[132:135], a[36:39], v[68:71]
  v_exp_f32 v187, v187
  v_mfma_f32_16x16x32_bf16 v[64:67], v[132:135], a[32:35], v[64:67]
  buffer_load_dwordx4 v[132:135], v1, s[4:7], s23 offen offset:2048 sc1
  s_add_u32 s23, s23, 0xc00
  s_waitcnt vmcnt(17)
  v_mfma_f32_16x16x32_bf16 v[48:51], v[136:139], a[48:51], v[48:51]
  v_mul_f32 v83, v83, v99
  v_mfma_f32_16x16x32_bf16 v[52:55], v[136:139], a[52:55], v[52:55]
  v_add_f32 v184, 1.0, v184
  v_add_f32 v185, 1.0, v185
  v_mfma_f32_16x16x32_bf16 v[56:59], v[136:139], a[56:59], v[56:59]
  v_add_f32 v186, 1.0, v186
  v_add_f32 v187, 1.0, v187
  v_mfma_f32_16x16x32_bf16 v[60:63], v[136:139], a[60:63], v[60:63]
  buffer_load_dwordx4 v[136:139], v1, s[4:7], s23 offen sc1
  s_waitcnt vmcnt(17)
  v_mfma_f32_16x16x32_bf16 v[76:79], v[140:143], a[60:63], v[76:79]
  v_rcp_f32 v184, v184
  v_mfma_f32_16x16x32_bf16 v[72:75], v[140:143], a[56:59], v[72:75]
  v_rcp_f32 v185, v185
  v_mfma_f32_16x16x32_bf16 v[68:71], v[140:143], a[52:55], v[68:71]
  v_mfma_f32_16x16x32_bf16 v[64:67], v[140:143], a[48:51], v[64:67]
  buffer_load_dwordx4 v[140:143], v1, s[4:7], s23 offen offset:1024 sc1
  s_waitcnt vmcnt(17)
  v_mfma_f32_16x16x32_bf16 v[48:51], v[144:147], a[64:67], v[48:51]
  v_rcp_f32 v186, v186
  v_mfma_f32_16x16x32_bf16 v[52:55], v[144:147], a[68:71], v[52:55]
  v_rcp_f32 v187, v187
  v_mfma_f32_16x16x32_bf16 v[56:59], v[144:147], a[72:75], v[56:59]
  v_mul_f32 v80, v80, v184
  v_mul_f32 v81, v81, v185
  v_mfma_f32_16x16x32_bf16 v[60:63], v[144:147], a[76:79], v[60:63]
  buffer_load_dwordx4 v[144:147], v1, s[4:7], s23 offen offset:2048 sc1
  s_add_u32 s23, s23, 0xc00
  s_waitcnt vmcnt(17)
  v_mfma_f32_16x16x32_bf16 v[76:79], v[148:151], a[76:79], v[76:79]
  v_mul_f32 v82, v82, v186
  v_mul_f32 v83, v83, v187
  v_mfma_f32_16x16x32_bf16 v[72:75], v[148:151], a[72:75], v[72:75]
  v_cvt_pk_bf16_f32 v192, v80, v81
  v_cvt_pk_bf16_f32 v193, v82, v83
  v_mfma_f32_16x16x32_bf16 v[68:71], v[148:151], a[68:71], v[68:71]
  ds_write_b64 v6, v[192:193] offset:0
  v_mfma_f32_16x16x32_bf16 v[64:67], v[148:151], a[64:67], v[64:67]
  buffer_load_dwordx4 v[148:151], v1, s[4:7], s23 offen sc1
  s_waitcnt vmcnt(17)
  v_mfma_f32_16x16x32_bf16 v[48:51], v[152:155], a[80:83], v[48:51]
  v_mul_f32 v188, v84, v84
  v_mfma_f32_16x16x32_bf16 v[52:55], v[152:155], a[84:87], v[52:55]
  v_mul_f32 v189, v85, v85
  v_mul_f32 v190, v86, v86
  v_mfma_f32_16x16x32_bf16 v[56:59], v[152:155], a[88:91], v[56:59]
  v_mul_f32 v191, v87, v87
  v_fmaak_f32 v188, v188, v4, 0xc0135761
  v_mfma_f32_16x16x32_bf16 v[60:63], v[152:155], a[92:95], v[60:63]
  buffer_load_dwordx4 v[152:155], v1, s[4:7], s23 offen offset:1024 sc1
  s_waitcnt vmcnt(17)
  v_mfma_f32_16x16x32_bf16 v[76:79], v[156:159], a[92:95], v[76:79]
  v_fmaak_f32 v189, v189, v4, 0xc0135761
  v_mfma_f32_16x16x32_bf16 v[72:75], v[156:159], a[88:91], v[72:75]
  v_fmaak_f32 v190, v190, v4, 0xc0135761
  v_fmaak_f32 v191, v191, v4, 0xc0135761
  v_mfma_f32_16x16x32_bf16 v[68:71], v[156:159], a[84:87], v[68:71]
  v_mul_f32 v188, v188, v84
  v_mul_f32 v189, v189, v85
  v_mfma_f32_16x16x32_bf16 v[64:67], v[156:159], a[80:83], v[64:67]
  buffer_load_dwordx4 v[156:159], v1, s[4:7], s23 offen offset:2048 sc1
  s_add_u32 s23, s23, 0xc00
  s_waitcnt vmcnt(17)
  v_mfma_f32_16x16x32_bf16 v[48:51], v[160:163], a[96:99], v[48:51]
  v_mul_f32 v190, v190, v86
  v_mul_f32 v191, v191, v87
  v_mfma_f32_16x16x32_bf16 v[52:55], v[160:163], a[100:103], v[52:55]
  v_exp_f32 v188, v188
  v_mfma_f32_16x16x32_bf16 v[56:59], v[160:163], a[104:107], v[56:59]
  v_mul_f32 v84, v84, v100
  v_mfma_f32_16x16x32_bf16 v[60:63], v[160:163], a[108:111], v[60:63]
  buffer_load_dwordx4 v[160:163], v1, s[4:7], s23 offen sc1
  s_waitcnt vmcnt(17)
  v_mfma_f32_16x16x32_bf16 v[76:79], v[164:167], a[108:111], v[76:79]
  v_exp_f32 v189, v189
  v_mfma_f32_16x16x32_bf16 v[72:75], v[164:167], a[104:107], v[72:75]
  v_mul_f32 v85, v85, v101
  s_barrier
  v_mfma_f32_16x16x32_bf16 v[68:71], v[164:167], a[100:103], v[68:71]
  v_exp_f32 v190, v190
  v_mfma_f32_16x16x32_bf16 v[64:67], v[164:167], a[96:99], v[64:67]
  buffer_load_dwordx4 v[164:167], v1, s[4:7], s23 offen offset:1024 sc1
  s_waitcnt vmcnt(17)
  v_mfma_f32_16x16x32_bf16 v[48:51], v[168:171], a[112:115], v[48:51]
  v_mul_f32 v86, v86, v102
  ds_read_b64_tr_b16 v[200:201], v243 offset:0
  v_mfma_f32_16x16x32_bf16 v[52:55], v[168:171], a[116:119], v[52:55]
  v_exp_f32 v191, v191
  v_mul_f32 v87, v87, v103
  v_mfma_f32_16x16x32_bf16 v[56:59], v[168:171], a[120:123], v[56:59]
  v_add_f32 v188, 1.0, v188
  ds_read_b64_tr_b16 v[202:203], v246 offset:0
  v_mfma_f32_16x16x32_bf16 v[60:63], v[168:171], a[124:127], v[60:63]
  buffer_load_dwordx4 v[168:171], v1, s[4:7], s23 offen offset:2048 sc1
  s_add_u32 s23, s23, 0xc00
  s_waitcnt vmcnt(17)
  v_mfma_f32_16x16x32_bf16 v[76:79], v[172:175], a[124:127], v[76:79]
  v_add_f32 v189, 1.0, v189
  v_add_f32 v190, 1.0, v190
  ds_read_b64_tr_b16 v[204:205], v243 offset:4096
  v_mfma_f32_16x16x32_bf16 v[72:75], v[172:175], a[120:123], v[72:75]
  v_add_f32 v191, 1.0, v191
  v_mfma_f32_16x16x32_bf16 v[68:71], v[172:175], a[116:119], v[68:71]
  v_rcp_f32 v188, v188
  ds_read_b64_tr_b16 v[206:207], v246 offset:4096
  v_mfma_f32_16x16x32_bf16 v[64:67], v[172:175], a[112:115], v[64:67]
  buffer_load_dwordx4 v[172:175], v1, s[4:7], s23 offen sc1
  s_waitcnt vmcnt(17)
  v_mfma_f32_16x16x32_bf16 v[48:51], v[176:179], a[128:131], v[48:51]
  v_rcp_f32 v189, v189
  ds_read_b64_tr_b16 v[208:209], v245 offset:8192
  v_mfma_f32_16x16x32_bf16 v[52:55], v[176:179], a[132:135], v[52:55]
  v_rcp_f32 v190, v190
  v_mfma_f32_16x16x32_bf16 v[56:59], v[176:179], a[136:139], v[56:59]
  v_rcp_f32 v191, v191
  ds_read_b64_tr_b16 v[210:211], v248 offset:8192
  v_mfma_f32_16x16x32_bf16 v[60:63], v[176:179], a[140:143], v[60:63]
  buffer_load_dwordx4 v[176:179], v1, s[4:7], s23 offen offset:1024 sc1
  s_waitcnt vmcnt(17)
  v_mfma_f32_16x16x32_bf16 v[76:79], v[180:183], a[140:143], v[76:79]
  v_mul_f32 v84, v84, v188
  v_mul_f32 v85, v85, v189
  ds_read_b64_tr_b16 v[212:213], v245 offset:12288
  v_mfma_f32_16x16x32_bf16 v[72:75], v[180:183], a[136:139], v[72:75]
  v_mul_f32 v86, v86, v190
  v_mfma_f32_16x16x32_bf16 v[68:71], v[180:183], a[132:135], v[68:71]
  v_mul_f32 v87, v87, v191
  v_cvt_pk_bf16_f32 v194, v84, v85
  ds_read_b64_tr_b16 v[214:215], v248 offset:12288
  v_mfma_f32_16x16x32_bf16 v[64:67], v[180:183], a[128:131], v[64:67]
  buffer_load_dwordx4 v[180:183], v1, s[4:7], s23 offen offset:2048 sc1
  s_add_u32 s23, s23, 0xc00
  s_waitcnt vmcnt(17)
  v_mfma_f32_16x16x32_bf16 v[48:51], v[112:115], a[144:147], v[48:51]
  v_cvt_pk_bf16_f32 v195, v86, v87
  ds_read_b64_tr_b16 v[216:217], v244 offset:16384
  v_mfma_f32_16x16x32_bf16 v[52:55], v[112:115], a[148:151], v[52:55]
  ds_write_b64 v6, v[194:195] offset:1024
  v_mul_f32 v184, v88, v88
  v_mfma_f32_16x16x32_bf16 v[56:59], v[112:115], a[152:155], v[56:59]
  v_mul_f32 v185, v89, v89
  ds_read_b64_tr_b16 v[218:219], v247 offset:16384
  v_mfma_f32_16x16x32_bf16 v[60:63], v[112:115], a[156:159], v[60:63]
  buffer_load_dwordx4 v[112:115], v1, s[4:7], s23 offen sc1
  s_waitcnt vmcnt(17)
  v_mfma_f32_16x16x32_bf16 v[76:79], v[116:119], a[156:159], v[76:79]
  v_mul_f32 v186, v90, v90
  v_mul_f32 v187, v91, v91
  ds_read_b64_tr_b16 v[220:221], v244 offset:20480
  v_mfma_f32_16x16x32_bf16 v[72:75], v[116:119], a[152:155], v[72:75]
  v_fmaak_f32 v184, v184, v4, 0xc0135761
  v_fmaak_f32 v185, v185, v4, 0xc0135761
  v_mfma_f32_16x16x32_bf16 v[68:71], v[116:119], a[148:151], v[68:71]
  v_fmaak_f32 v186, v186, v4, 0xc0135761
  ds_read_b64_tr_b16 v[222:223], v247 offset:20480
  v_mfma_f32_16x16x32_bf16 v[64:67], v[116:119], a[144:147], v[64:67]
  buffer_load_dwordx4 v[116:119], v1, s[4:7], s23 offen offset:1024 sc1
  s_waitcnt vmcnt(17)
  v_mfma_f32_16x16x32_bf16 v[48:51], v[120:123], a[160:163], v[48:51]
  v_fmaak_f32 v187, v187, v4, 0xc0135761
  v_mul_f32 v184, v184, v88
  ds_read_b64_tr_b16 v[224:225], v244 offset:24576
  v_mfma_f32_16x16x32_bf16 v[52:55], v[120:123], a[164:167], v[52:55]
  v_mul_f32 v185, v185, v89
  v_mul_f32 v186, v186, v90
  v_mfma_f32_16x16x32_bf16 v[56:59], v[120:123], a[168:171], v[56:59]
  v_mul_f32 v187, v187, v91
  ds_read_b64_tr_b16 v[226:227], v247 offset:24576
  v_mfma_f32_16x16x32_bf16 v[60:63], v[120:123], a[172:175], v[60:63]
  buffer_load_dwordx4 v[120:123], v1, s[4:7], s23 offen offset:2048 sc1
  s_add_u32 s23, s23, 0xc00
  s_waitcnt vmcnt(17)
  v_mfma_f32_16x16x32_bf16 v[76:79], v[124:127], a[172:175], v[76:79]
  v_exp_f32 v184, v184
  ds_read_b64_tr_b16 v[228:229], v244 offset:28672
  v_mfma_f32_16x16x32_bf16 v[72:75], v[124:127], a[168:171], v[72:75]
  v_mul_f32 v88, v88, v104
  v_exp_f32 v185, v185
  v_mfma_f32_16x16x32_bf16 v[68:71], v[124:127], a[164:167], v[68:71]
  v_mul_f32 v89, v89, v105
  ds_read_b64_tr_b16 v[230:231], v247 offset:28672
  v_mfma_f32_16x16x32_bf16 v[64:67], v[124:127], a[160:163], v[64:67]
  buffer_load_dwordx4 v[124:127], v1, s[4:7], s23 offen sc1
  s_waitcnt vmcnt(17)
  v_mfma_f32_16x16x32_bf16 v[48:51], v[128:131], a[176:179], v[48:51]
  v_exp_f32 v186, v186
  v_mfma_f32_16x16x32_bf16 v[52:55], v[128:131], a[180:183], v[52:55]
  v_mul_f32 v90, v90, v106
  v_mfma_f32_16x16x32_bf16 v[56:59], v[128:131], a[184:187], v[56:59]
  v_exp_f32 v187, v187
  v_mfma_f32_16x16x32_bf16 v[60:63], v[128:131], a[188:191], v[60:63]
  buffer_load_dwordx4 v[128:131], v1, s[4:7], s23 offen offset:1024 sc1
  s_waitcnt vmcnt(17)
  v_mfma_f32_16x16x32_bf16 v[76:79], v[132:135], a[188:191], v[76:79]
  v_mul_f32 v91, v91, v107
  v_add_f32 v184, 1.0, v184
  v_mfma_f32_16x16x32_bf16 v[72:75], v[132:135], a[184:187], v[72:75]
  v_add_f32 v185, 1.0, v185
  v_add_f32 v186, 1.0, v186
  v_mfma_f32_16x16x32_bf16 v[68:71], v[132:135], a[180:183], v[68:71]
  v_add_f32 v187, 1.0, v187
  v_mfma_f32_16x16x32_bf16 v[64:67], v[132:135], a[176:179], v[64:67]
  buffer_load_dwordx4 v[132:135], v1, s[4:7], s23 offen offset:2048 sc1
  s_add_u32 s23, s23, 0xc00
  s_waitcnt vmcnt(17)
  v_mfma_f32_16x16x32_bf16 v[48:51], v[136:139], a[192:195], v[48:51]
  v_rcp_f32 v184, v184
  v_mfma_f32_16x16x32_bf16 v[52:55], v[136:139], a[196:199], v[52:55]
  v_rcp_f32 v185, v185
  s_waitcnt lgkmcnt(0)
  buffer_store_dwordx4 v[200:203], v1, s[68:71], s46 offen sc1
  v_mfma_f32_16x16x32_bf16 v[56:59], v[136:139], a[200:203], v[56:59]
  v_rcp_f32 v186, v186
  v_mfma_f32_16x16x32_bf16 v[60:63], v[136:139], a[204:207], v[60:63]
  buffer_load_dwordx4 v[136:139], v1, s[4:7], s23 offen sc1
  s_waitcnt vmcnt(18)
  v_mfma_f32_16x16x32_bf16 v[76:79], v[140:143], a[204:207], v[76:79]
  v_rcp_f32 v187, v187
  v_mfma_f32_16x16x32_bf16 v[72:75], v[140:143], a[200:203], v[72:75]
  v_mul_f32 v88, v88, v184
  buffer_store_dwordx4 v[204:207], v1, s[68:71], s46 offen offset:1024 sc1
  v_mfma_f32_16x16x32_bf16 v[68:71], v[140:143], a[196:199], v[68:71]
  v_mul_f32 v89, v89, v185
  v_mul_f32 v90, v90, v186
  v_mfma_f32_16x16x32_bf16 v[64:67], v[140:143], a[192:195], v[64:67]
  buffer_load_dwordx4 v[140:143], v1, s[4:7], s23 offen offset:1024 sc1
  s_waitcnt vmcnt(19)
  v_mfma_f32_16x16x32_bf16 v[48:51], v[144:147], a[208:211], v[48:51]
  v_mul_f32 v91, v91, v187
  v_mfma_f32_16x16x32_bf16 v[52:55], v[144:147], a[212:215], v[52:55]
  v_cvt_pk_bf16_f32 v196, v88, v89
  v_cvt_pk_bf16_f32 v197, v90, v91
  v_mfma_f32_16x16x32_bf16 v[56:59], v[144:147], a[216:219], v[56:59]
  ds_write_b64 v6, v[196:197] offset:2048
  v_mfma_f32_16x16x32_bf16 v[60:63], v[144:147], a[220:223], v[60:63]
  buffer_load_dwordx4 v[144:147], v1, s[4:7], s23 offen offset:2048 sc1
  s_add_u32 s23, s23, 0xc00
  s_waitcnt vmcnt(19)
  v_mfma_f32_16x16x32_bf16 v[76:79], v[148:151], a[220:223], v[76:79]
  v_mul_f32 v188, v92, v92
  v_mul_f32 v189, v93, v93
  v_mfma_f32_16x16x32_bf16 v[72:75], v[148:151], a[216:219], v[72:75]
  v_mul_f32 v190, v94, v94
  buffer_store_dwordx4 v[208:211], v1, s[68:71], s49 offen sc1
  v_mfma_f32_16x16x32_bf16 v[68:71], v[148:151], a[212:215], v[68:71]
  v_mul_f32 v191, v95, v95
  v_fmaak_f32 v188, v188, v4, 0xc0135761
  v_mfma_f32_16x16x32_bf16 v[64:67], v[148:151], a[208:211], v[64:67]
  buffer_load_dwordx4 v[148:151], v1, s[4:7], s23 offen sc1
  s_waitcnt vmcnt(20)
  v_mfma_f32_16x16x32_bf16 v[48:51], v[152:155], a[224:227], v[48:51]
  v_fmaak_f32 v189, v189, v4, 0xc0135761
  v_fmaak_f32 v190, v190, v4, 0xc0135761
  v_mfma_f32_16x16x32_bf16 v[52:55], v[152:155], a[228:231], v[52:55]
  v_fmaak_f32 v191, v191, v4, 0xc0135761
  v_mul_f32 v188, v188, v92
  buffer_store_dwordx4 v[212:215], v1, s[68:71], s49 offen offset:1024 sc1
  v_mfma_f32_16x16x32_bf16 v[56:59], v[152:155], a[232:235], v[56:59]
  v_mul_f32 v189, v189, v93
  v_mfma_f32_16x16x32_bf16 v[60:63], v[152:155], a[236:239], v[60:63]
  buffer_load_dwordx4 v[152:155], v1, s[4:7], s23 offen offset:1024 sc1
  s_waitcnt vmcnt(21)
  v_mfma_f32_16x16x32_bf16 v[76:79], v[156:159], a[236:239], v[76:79]
  v_mul_f32 v190, v190, v94
  v_mul_f32 v191, v191, v95
  v_mfma_f32_16x16x32_bf16 v[72:75], v[156:159], a[232:235], v[72:75]
  v_exp_f32 v188, v188
  v_mfma_f32_16x16x32_bf16 v[68:71], v[156:159], a[228:231], v[68:71]
  v_mul_f32 v92, v92, v108
  v_mfma_f32_16x16x32_bf16 v[64:67], v[156:159], a[224:227], v[64:67]
  buffer_load_dwordx4 v[156:159], v1, s[4:7], s23 offen offset:2048 sc1
  s_add_u32 s23, s23, 0xc00
  s_waitcnt vmcnt(21)
  v_mfma_f32_16x16x32_bf16 v[48:51], v[160:163], a[240:243], v[48:51]
  v_exp_f32 v189, v189
  v_mfma_f32_16x16x32_bf16 v[52:55], v[160:163], a[244:247], v[52:55]
  v_mul_f32 v93, v93, v109
  buffer_store_dwordx4 v[216:219], v1, s[68:71], s52 offen sc1
  v_mfma_f32_16x16x32_bf16 v[56:59], v[160:163], a[248:251], v[56:59]
  v_exp_f32 v190, v190
  v_mul_f32 v94, v94, v110
  v_mfma_f32_16x16x32_bf16 v[60:63], v[160:163], a[252:255], v[60:63]
  buffer_load_dwordx4 v[160:163], v1, s[4:7], s23 offen sc1
  s_waitcnt vmcnt(22)
  v_mfma_f32_16x16x32_bf16 v[76:79], v[164:167], a[252:255], v[76:79]
  v_exp_f32 v191, v191
  v_mfma_f32_16x16x32_bf16 v[72:75], v[164:167], a[248:251], v[72:75]
  v_mul_f32 v95, v95, v111
  buffer_store_dwordx4 v[220:223], v1, s[68:71], s52 offen offset:1024 sc1
  v_mfma_f32_16x16x32_bf16 v[68:71], v[164:167], a[244:247], v[68:71]
  v_add_f32 v188, 1.0, v188
  v_add_f32 v189, 1.0, v189
  v_mfma_f32_16x16x32_bf16 v[64:67], v[164:167], a[240:243], v[64:67]
  buffer_load_dwordx4 v[164:167], v1, s[4:7], s23 offen offset:1024 sc1
  s_waitcnt vmcnt(23)
  v_mfma_f32_16x16x32_bf16 v[48:51], v[168:171], v[16:19], v[48:51]
  v_add_f32 v190, 1.0, v190
  v_add_f32 v191, 1.0, v191
  v_mfma_f32_16x16x32_bf16 v[52:55], v[168:171], v[20:23], v[52:55]
  v_rcp_f32 v188, v188
  v_mfma_f32_16x16x32_bf16 v[56:59], v[168:171], v[24:27], v[56:59]
  v_rcp_f32 v189, v189
  v_mfma_f32_16x16x32_bf16 v[60:63], v[168:171], v[28:31], v[60:63]
  buffer_load_dwordx4 v[168:171], v1, s[4:7], s23 offen offset:2048 sc1
  s_add_u32 s23, s23, 0xc00
  s_waitcnt vmcnt(23)
  v_mfma_f32_16x16x32_bf16 v[76:79], v[172:175], v[28:31], v[76:79]
  v_mfma_f32_16x16x32_bf16 v[72:75], v[172:175], v[24:27], v[72:75]
  v_rcp_f32 v190, v190
  s_mov_b32 s70, s56
  buffer_store_dwordx4 v[224:227], v1, s[68:71], s55 offen sc1
  v_mfma_f32_16x16x32_bf16 v[68:71], v[172:175], v[20:23], v[68:71]
  v_rcp_f32 v191, v191
  v_mfma_f32_16x16x32_bf16 v[64:67], v[172:175], v[16:19], v[64:67]
  buffer_load_dwordx4 v[172:175], v1, s[4:7], s23 offen sc1
  s_waitcnt vmcnt(24)
  v_mfma_f32_16x16x32_bf16 v[48:51], v[176:179], v[32:35], v[48:51]
  v_mul_f32 v92, v92, v188
  v_mul_f32 v93, v93, v189
  v_mfma_f32_16x16x32_bf16 v[52:55], v[176:179], v[36:39], v[52:55]
  v_mul_f32 v94, v94, v190
  v_mul_f32 v95, v95, v191
  buffer_store_dwordx4 v[228:231], v1, s[68:71], s55 offen offset:1024 sc1
  v_mfma_f32_16x16x32_bf16 v[56:59], v[176:179], v[40:43], v[56:59]
  v_cvt_pk_bf16_f32 v198, v92, v93
  v_cvt_pk_bf16_f32 v199, v94, v95
  v_mfma_f32_16x16x32_bf16 v[60:63], v[176:179], v[44:47], v[60:63]
  buffer_load_dwordx4 v[176:179], v1, s[4:7], s23 offen offset:1024 sc1
  s_waitcnt vmcnt(25)
  v_mfma_f32_16x16x32_bf16 v[76:79], v[180:183], v[44:47], v[76:79]
  ds_write_b64 v6, v[198:199] offset:3072
  v_mfma_f32_16x16x32_bf16 v[72:75], v[180:183], v[40:43], v[72:75]
  v_add_u32 v6, 0x2000, v6
  v_mfma_f32_16x16x32_bf16 v[68:71], v[180:183], v[36:39], v[68:71]
  v_mfma_f32_16x16x32_bf16 v[64:67], v[180:183], v[32:35], v[64:67]
  buffer_load_dwordx4 v[180:183], v1, s[4:7], s23 offen offset:2048 sc1
  s_add_u32 s23, s23, 0xc00
  s_waitcnt vmcnt(17)
  v_mfma_f32_16x16x32_bf16 v[80:83], v[112:115], a[0:3], 0
  v_mfma_f32_16x16x32_bf16 v[84:87], v[112:115], a[4:7], 0
  v_mfma_f32_16x16x32_bf16 v[88:91], v[112:115], a[8:11], 0
  v_mfma_f32_16x16x32_bf16 v[92:95], v[112:115], a[12:15], 0
  buffer_load_dwordx4 v[112:115], v1, s[4:7], s23 offen sc1
  s_waitcnt vmcnt(17)
  v_mfma_f32_16x16x32_bf16 v[108:111], v[116:119], a[12:15], 0
  v_mfma_f32_16x16x32_bf16 v[104:107], v[116:119], a[8:11], 0
  v_mfma_f32_16x16x32_bf16 v[100:103], v[116:119], a[4:7], 0
  v_mul_f32 v184, v48, v48
  v_mul_f32 v185, v49, v49
  v_mfma_f32_16x16x32_bf16 v[96:99], v[116:119], a[0:3], 0
  buffer_load_dwordx4 v[116:119], v1, s[4:7], s23 offen offset:1024 sc1
  s_waitcnt vmcnt(17)
  v_mfma_f32_16x16x32_bf16 v[80:83], v[120:123], a[16:19], v[80:83]
  v_mul_f32 v186, v50, v50
  v_mfma_f32_16x16x32_bf16 v[84:87], v[120:123], a[20:23], v[84:87]
  v_mul_f32 v187, v51, v51
  v_fmaak_f32 v184, v184, v4, 0xc0135761
  v_mfma_f32_16x16x32_bf16 v[88:91], v[120:123], a[24:27], v[88:91]
  v_fmaak_f32 v185, v185, v4, 0xc0135761
  v_fmaak_f32 v186, v186, v4, 0xc0135761
  v_mfma_f32_16x16x32_bf16 v[92:95], v[120:123], a[28:31], v[92:95]
  buffer_load_dwordx4 v[120:123], v1, s[4:7], s23 offen offset:2048 sc1
  s_add_u32 s23, s23, 0xc00
  s_waitcnt vmcnt(17)
  v_mfma_f32_16x16x32_bf16 v[108:111], v[124:127], a[28:31], v[108:111]
  v_fmaak_f32 v187, v187, v4, 0xc0135761
  v_mul_f32 v184, v184, v48
  v_mfma_f32_16x16x32_bf16 v[104:107], v[124:127], a[24:27], v[104:107]
  v_mul_f32 v185, v185, v49
  v_mfma_f32_16x16x32_bf16 v[100:103], v[124:127], a[20:23], v[100:103]
  v_mul_f32 v186, v186, v50
  v_mul_f32 v187, v187, v51
  v_mfma_f32_16x16x32_bf16 v[96:99], v[124:127], a[16:19], v[96:99]
  buffer_load_dwordx4 v[124:127], v1, s[4:7], s23 offen sc1
  s_waitcnt vmcnt(17)
  v_mfma_f32_16x16x32_bf16 v[80:83], v[128:131], a[32:35], v[80:83]
  v_exp_f32 v184, v184
  v_mfma_f32_16x16x32_bf16 v[84:87], v[128:131], a[36:39], v[84:87]
  v_mul_f32 v48, v48, v64
  v_mfma_f32_16x16x32_bf16 v[88:91], v[128:131], a[40:43], v[88:91]
  v_exp_f32 v185, v185
  v_mfma_f32_16x16x32_bf16 v[92:95], v[128:131], a[44:47], v[92:95]
  buffer_load_dwordx4 v[128:131], v1, s[4:7], s23 offen offset:1024 sc1
  s_waitcnt vmcnt(17)
  v_mfma_f32_16x16x32_bf16 v[108:111], v[132:135], a[44:47], v[108:111]
  v_mul_f32 v49, v49, v65
  v_exp_f32 v186, v186
  v_mfma_f32_16x16x32_bf16 v[104:107], v[132:135], a[40:43], v[104:107]
  v_mul_f32 v50, v50, v66
  v_mfma_f32_16x16x32_bf16 v[100:103], v[132:135], a[36:39], v[100:103]
  v_exp_f32 v187, v187
  v_mfma_f32_16x16x32_bf16 v[96:99], v[132:135], a[32:35], v[96:99]
  buffer_load_dwordx4 v[132:135], v1, s[4:7], s23 offen offset:2048 sc1
  s_add_u32 s23, s23, 0xc00
  s_waitcnt vmcnt(17)
  v_mfma_f32_16x16x32_bf16 v[80:83], v[136:139], a[48:51], v[80:83]
  v_mul_f32 v51, v51, v67
  v_mfma_f32_16x16x32_bf16 v[84:87], v[136:139], a[52:55], v[84:87]
  v_add_f32 v184, 1.0, v184
  v_add_f32 v185, 1.0, v185
  v_mfma_f32_16x16x32_bf16 v[88:91], v[136:139], a[56:59], v[88:91]
  v_add_f32 v186, 1.0, v186
  v_add_f32 v187, 1.0, v187
  v_mfma_f32_16x16x32_bf16 v[92:95], v[136:139], a[60:63], v[92:95]
  buffer_load_dwordx4 v[136:139], v1, s[4:7], s23 offen sc1
  s_waitcnt vmcnt(17)
  v_mfma_f32_16x16x32_bf16 v[108:111], v[140:143], a[60:63], v[108:111]
  v_rcp_f32 v184, v184
  v_mfma_f32_16x16x32_bf16 v[104:107], v[140:143], a[56:59], v[104:107]
  v_rcp_f32 v185, v185
  v_mfma_f32_16x16x32_bf16 v[100:103], v[140:143], a[52:55], v[100:103]
  v_mfma_f32_16x16x32_bf16 v[96:99], v[140:143], a[48:51], v[96:99]
  buffer_load_dwordx4 v[140:143], v1, s[4:7], s23 offen offset:1024 sc1
  s_waitcnt vmcnt(17)
  v_mfma_f32_16x16x32_bf16 v[80:83], v[144:147], a[64:67], v[80:83]
  v_rcp_f32 v186, v186
  v_mfma_f32_16x16x32_bf16 v[84:87], v[144:147], a[68:71], v[84:87]
  v_rcp_f32 v187, v187
  v_mfma_f32_16x16x32_bf16 v[88:91], v[144:147], a[72:75], v[88:91]
  v_mul_f32 v48, v48, v184
  v_mul_f32 v49, v49, v185
  v_mfma_f32_16x16x32_bf16 v[92:95], v[144:147], a[76:79], v[92:95]
  buffer_load_dwordx4 v[144:147], v1, s[4:7], s23 offen offset:2048 sc1
  s_add_u32 s23, s23, 0xc00
  s_waitcnt vmcnt(17)
  v_mfma_f32_16x16x32_bf16 v[108:111], v[148:151], a[76:79], v[108:111]
  v_mul_f32 v50, v50, v186
  v_mul_f32 v51, v51, v187
  v_mfma_f32_16x16x32_bf16 v[104:107], v[148:151], a[72:75], v[104:107]
  v_cvt_pk_bf16_f32 v192, v48, v49
  v_cvt_pk_bf16_f32 v193, v50, v51
  v_mfma_f32_16x16x32_bf16 v[100:103], v[148:151], a[68:71], v[100:103]
  ds_write_b64 v6, v[192:193] offset:0
  v_mfma_f32_16x16x32_bf16 v[96:99], v[148:151], a[64:67], v[96:99]
  buffer_load_dwordx4 v[148:151], v1, s[4:7], s23 offen sc1
  s_waitcnt vmcnt(17)
  v_mfma_f32_16x16x32_bf16 v[80:83], v[152:155], a[80:83], v[80:83]
  v_mul_f32 v188, v52, v52
  v_mfma_f32_16x16x32_bf16 v[84:87], v[152:155], a[84:87], v[84:87]
  v_mul_f32 v189, v53, v53
  v_mul_f32 v190, v54, v54
  v_mfma_f32_16x16x32_bf16 v[88:91], v[152:155], a[88:91], v[88:91]
  v_mul_f32 v191, v55, v55
  v_fmaak_f32 v188, v188, v4, 0xc0135761
  v_mfma_f32_16x16x32_bf16 v[92:95], v[152:155], a[92:95], v[92:95]
  buffer_load_dwordx4 v[152:155], v1, s[4:7], s23 offen offset:1024 sc1
  s_waitcnt vmcnt(17)
  v_mfma_f32_16x16x32_bf16 v[108:111], v[156:159], a[92:95], v[108:111]
  v_fmaak_f32 v189, v189, v4, 0xc0135761
  v_mfma_f32_16x16x32_bf16 v[104:107], v[156:159], a[88:91], v[104:107]
  v_fmaak_f32 v190, v190, v4, 0xc0135761
  v_fmaak_f32 v191, v191, v4, 0xc0135761
  v_mfma_f32_16x16x32_bf16 v[100:103], v[156:159], a[84:87], v[100:103]
  v_mul_f32 v188, v188, v52
  v_mul_f32 v189, v189, v53
  v_mfma_f32_16x16x32_bf16 v[96:99], v[156:159], a[80:83], v[96:99]
  buffer_load_dwordx4 v[156:159], v1, s[4:7], s23 offen offset:2048 sc1
  s_add_u32 s23, s23, 0xc00
  s_waitcnt vmcnt(17)
  v_mfma_f32_16x16x32_bf16 v[80:83], v[160:163], a[96:99], v[80:83]
  v_mul_f32 v190, v190, v54
  v_mul_f32 v191, v191, v55
  v_mfma_f32_16x16x32_bf16 v[84:87], v[160:163], a[100:103], v[84:87]
  v_exp_f32 v188, v188
  v_mfma_f32_16x16x32_bf16 v[88:91], v[160:163], a[104:107], v[88:91]
  v_mul_f32 v52, v52, v68
  v_mfma_f32_16x16x32_bf16 v[92:95], v[160:163], a[108:111], v[92:95]
  buffer_load_dwordx4 v[160:163], v1, s[4:7], s23 offen sc1
  s_waitcnt vmcnt(17)
  v_mfma_f32_16x16x32_bf16 v[108:111], v[164:167], a[108:111], v[108:111]
  v_exp_f32 v189, v189
  v_mfma_f32_16x16x32_bf16 v[104:107], v[164:167], a[104:107], v[104:107]
  v_mul_f32 v53, v53, v69
  v_mfma_f32_16x16x32_bf16 v[100:103], v[164:167], a[100:103], v[100:103]
  v_exp_f32 v190, v190
  v_mfma_f32_16x16x32_bf16 v[96:99], v[164:167], a[96:99], v[96:99]
  buffer_load_dwordx4 v[164:167], v1, s[4:7], s23 offen offset:1024 sc1
  s_waitcnt vmcnt(17)
  v_mfma_f32_16x16x32_bf16 v[80:83], v[168:171], a[112:115], v[80:83]
  v_mul_f32 v54, v54, v70
  v_mfma_f32_16x16x32_bf16 v[84:87], v[168:171], a[116:119], v[84:87]
  v_exp_f32 v191, v191
  v_mul_f32 v55, v55, v71
  v_mfma_f32_16x16x32_bf16 v[88:91], v[168:171], a[120:123], v[88:91]
  v_add_f32 v188, 1.0, v188
  v_mfma_f32_16x16x32_bf16 v[92:95], v[168:171], a[124:127], v[92:95]
  buffer_load_dwordx4 v[168:171], v1, s[4:7], s23 offen offset:2048 sc1
  s_add_u32 s23, s23, 0xc00
  s_waitcnt vmcnt(17)
  v_mfma_f32_16x16x32_bf16 v[108:111], v[172:175], a[124:127], v[108:111]
  v_add_f32 v189, 1.0, v189
  v_add_f32 v190, 1.0, v190
  v_mfma_f32_16x16x32_bf16 v[104:107], v[172:175], a[120:123], v[104:107]
  v_add_f32 v191, 1.0, v191
  v_mfma_f32_16x16x32_bf16 v[100:103], v[172:175], a[116:119], v[100:103]
  v_rcp_f32 v188, v188
  v_mfma_f32_16x16x32_bf16 v[96:99], v[172:175], a[112:115], v[96:99]
  buffer_load_dwordx4 v[172:175], v1, s[4:7], s23 offen sc1
  s_waitcnt vmcnt(17)
  v_mfma_f32_16x16x32_bf16 v[80:83], v[176:179], a[128:131], v[80:83]
  v_rcp_f32 v189, v189
  v_mfma_f32_16x16x32_bf16 v[84:87], v[176:179], a[132:135], v[84:87]
  v_rcp_f32 v190, v190
  v_mfma_f32_16x16x32_bf16 v[88:91], v[176:179], a[136:139], v[88:91]
  v_rcp_f32 v191, v191
  v_mfma_f32_16x16x32_bf16 v[92:95], v[176:179], a[140:143], v[92:95]
  buffer_load_dwordx4 v[176:179], v1, s[4:7], s23 offen offset:1024 sc1
  s_waitcnt vmcnt(17)
  v_mfma_f32_16x16x32_bf16 v[108:111], v[180:183], a[140:143], v[108:111]
  v_mul_f32 v52, v52, v188
  v_mul_f32 v53, v53, v189
  v_mfma_f32_16x16x32_bf16 v[104:107], v[180:183], a[136:139], v[104:107]
  v_mul_f32 v54, v54, v190
  v_mfma_f32_16x16x32_bf16 v[100:103], v[180:183], a[132:135], v[100:103]
  v_mul_f32 v55, v55, v191
  v_cvt_pk_bf16_f32 v194, v52, v53
  v_mfma_f32_16x16x32_bf16 v[96:99], v[180:183], a[128:131], v[96:99]
  buffer_load_dwordx4 v[180:183], v1, s[4:7], s23 offen offset:2048 sc1
  s_add_u32 s23, s23, 0xc00
  s_waitcnt vmcnt(17)
  v_mfma_f32_16x16x32_bf16 v[80:83], v[112:115], a[144:147], v[80:83]
  v_cvt_pk_bf16_f32 v195, v54, v55
  v_mfma_f32_16x16x32_bf16 v[84:87], v[112:115], a[148:151], v[84:87]
  ds_write_b64 v6, v[194:195] offset:1024
  v_mul_f32 v184, v56, v56
  s_lshl_b32 s76, s2, 2
  s_add_u32 s76, s76, s20
  s_lshl_b32 s76, s76, 3
  s_add_u32 s76, s76, 229376
  s_mov_b64 exec, 1
  v_mov_b32 v9, 0
  v_mov_b32 v10, s90
  v_mov_b32 v11, s91
  buffer_store_dwordx2 v[10:11], v9, s[92:95], s76 offen sc1
  s_mov_b64 exec, -1
  v_mfma_f32_16x16x32_bf16 v[88:91], v[112:115], a[152:155], v[88:91]
  v_mul_f32 v185, v57, v57
  v_mfma_f32_16x16x32_bf16 v[92:95], v[112:115], a[156:159], v[92:95]
  buffer_load_dwordx4 v[112:115], v1, s[4:7], s23 offen sc1
  s_waitcnt vmcnt(18)
  v_mfma_f32_16x16x32_bf16 v[108:111], v[116:119], a[156:159], v[108:111]
  v_mul_f32 v186, v58, v58
  v_mul_f32 v187, v59, v59
  v_mfma_f32_16x16x32_bf16 v[104:107], v[116:119], a[152:155], v[104:107]
  v_fmaak_f32 v184, v184, v4, 0xc0135761
  v_fmaak_f32 v185, v185, v4, 0xc0135761
  v_mfma_f32_16x16x32_bf16 v[100:103], v[116:119], a[148:151], v[100:103]
  v_fmaak_f32 v186, v186, v4, 0xc0135761
  v_mfma_f32_16x16x32_bf16 v[96:99], v[116:119], a[144:147], v[96:99]
  buffer_load_dwordx4 v[116:119], v1, s[4:7], s23 offen offset:1024 sc1
  s_waitcnt vmcnt(18)
  v_mfma_f32_16x16x32_bf16 v[80:83], v[120:123], a[160:163], v[80:83]
  v_fmaak_f32 v187, v187, v4, 0xc0135761
  v_mul_f32 v184, v184, v56
  v_mfma_f32_16x16x32_bf16 v[84:87], v[120:123], a[164:167], v[84:87]
  v_mul_f32 v185, v185, v57
  v_mul_f32 v186, v186, v58
  v_mfma_f32_16x16x32_bf16 v[88:91], v[120:123], a[168:171], v[88:91]
  v_mul_f32 v187, v187, v59
  v_mfma_f32_16x16x32_bf16 v[92:95], v[120:123], a[172:175], v[92:95]
  buffer_load_dwordx4 v[120:123], v1, s[4:7], s23 offen offset:2048 sc1
  s_add_u32 s23, s23, 0xc00
  s_waitcnt vmcnt(18)
  v_mfma_f32_16x16x32_bf16 v[108:111], v[124:127], a[172:175], v[108:111]
  v_exp_f32 v184, v184
  v_mfma_f32_16x16x32_bf16 v[104:107], v[124:127], a[168:171], v[104:107]
  v_mul_f32 v56, v56, v72
  v_exp_f32 v185, v185
  v_mfma_f32_16x16x32_bf16 v[100:103], v[124:127], a[164:167], v[100:103]
  v_mul_f32 v57, v57, v73
  v_mfma_f32_16x16x32_bf16 v[96:99], v[124:127], a[160:163], v[96:99]
  buffer_load_dwordx4 v[124:127], v1, s[4:7], s23 offen sc1
  s_waitcnt vmcnt(18)
  v_mfma_f32_16x16x32_bf16 v[80:83], v[128:131], a[176:179], v[80:83]
  v_exp_f32 v186, v186
  v_mfma_f32_16x16x32_bf16 v[84:87], v[128:131], a[180:183], v[84:87]
  v_mul_f32 v58, v58, v74
  v_mfma_f32_16x16x32_bf16 v[88:91], v[128:131], a[184:187], v[88:91]
  v_exp_f32 v187, v187
  v_mfma_f32_16x16x32_bf16 v[92:95], v[128:131], a[188:191], v[92:95]
  buffer_load_dwordx4 v[128:131], v1, s[4:7], s23 offen offset:1024 sc1
  s_waitcnt vmcnt(18)
  v_mfma_f32_16x16x32_bf16 v[108:111], v[132:135], a[188:191], v[108:111]
  v_mul_f32 v59, v59, v75
  v_add_f32 v184, 1.0, v184
  v_mfma_f32_16x16x32_bf16 v[104:107], v[132:135], a[184:187], v[104:107]
  v_add_f32 v185, 1.0, v185
  v_add_f32 v186, 1.0, v186
  v_mfma_f32_16x16x32_bf16 v[100:103], v[132:135], a[180:183], v[100:103]
  v_add_f32 v187, 1.0, v187
  v_mfma_f32_16x16x32_bf16 v[96:99], v[132:135], a[176:179], v[96:99]
  buffer_load_dwordx4 v[132:135], v1, s[4:7], s23 offen offset:2048 sc1
  s_add_u32 s23, s23, 0xc00
  s_waitcnt vmcnt(18)
  v_mfma_f32_16x16x32_bf16 v[80:83], v[136:139], a[192:195], v[80:83]
  v_rcp_f32 v184, v184
  v_mfma_f32_16x16x32_bf16 v[84:87], v[136:139], a[196:199], v[84:87]
  v_rcp_f32 v185, v185
  v_mfma_f32_16x16x32_bf16 v[88:91], v[136:139], a[200:203], v[88:91]
  v_rcp_f32 v186, v186
  v_mfma_f32_16x16x32_bf16 v[92:95], v[136:139], a[204:207], v[92:95]
  buffer_load_dwordx4 v[136:139], v1, s[4:7], s23 offen sc1
  s_waitcnt vmcnt(18)
  v_mfma_f32_16x16x32_bf16 v[108:111], v[140:143], a[204:207], v[108:111]
  v_rcp_f32 v187, v187
  v_mfma_f32_16x16x32_bf16 v[104:107], v[140:143], a[200:203], v[104:107]
  v_mul_f32 v56, v56, v184
  v_mfma_f32_16x16x32_bf16 v[100:103], v[140:143], a[196:199], v[100:103]
  v_mul_f32 v57, v57, v185
  v_mul_f32 v58, v58, v186
  v_mfma_f32_16x16x32_bf16 v[96:99], v[140:143], a[192:195], v[96:99]
  buffer_load_dwordx4 v[140:143], v1, s[4:7], s23 offen offset:1024 sc1
  s_waitcnt vmcnt(18)
  v_mfma_f32_16x16x32_bf16 v[80:83], v[144:147], a[208:211], v[80:83]
  v_mul_f32 v59, v59, v187
  v_mfma_f32_16x16x32_bf16 v[84:87], v[144:147], a[212:215], v[84:87]
  v_cvt_pk_bf16_f32 v196, v56, v57
  v_cvt_pk_bf16_f32 v197, v58, v59
  v_mfma_f32_16x16x32_bf16 v[88:91], v[144:147], a[216:219], v[88:91]
  ds_write_b64 v6, v[196:197] offset:2048
  v_mfma_f32_16x16x32_bf16 v[92:95], v[144:147], a[220:223], v[92:95]
  buffer_load_dwordx4 v[144:147], v1, s[4:7], s23 offen offset:2048 sc1
  s_add_u32 s23, s23, 0xc00
  s_waitcnt vmcnt(18)
  v_mfma_f32_16x16x32_bf16 v[108:111], v[148:151], a[220:223], v[108:111]
  v_mul_f32 v188, v60, v60
  v_mul_f32 v189, v61, v61
  v_mfma_f32_16x16x32_bf16 v[104:107], v[148:151], a[216:219], v[104:107]
  v_mul_f32 v190, v62, v62
  v_mfma_f32_16x16x32_bf16 v[100:103], v[148:151], a[212:215], v[100:103]
  v_mul_f32 v191, v63, v63
  v_fmaak_f32 v188, v188, v4, 0xc0135761
  v_mfma_f32_16x16x32_bf16 v[96:99], v[148:151], a[208:211], v[96:99]
  buffer_load_dwordx4 v[148:151], v1, s[4:7], s23 offen sc1
  s_waitcnt vmcnt(18)
  v_mfma_f32_16x16x32_bf16 v[80:83], v[152:155], a[224:227], v[80:83]
  v_fmaak_f32 v189, v189, v4, 0xc0135761
  v_fmaak_f32 v190, v190, v4, 0xc0135761
  v_mfma_f32_16x16x32_bf16 v[84:87], v[152:155], a[228:231], v[84:87]
  v_fmaak_f32 v191, v191, v4, 0xc0135761
  v_mul_f32 v188, v188, v60
  v_mfma_f32_16x16x32_bf16 v[88:91], v[152:155], a[232:235], v[88:91]
  v_mul_f32 v189, v189, v61
  v_mfma_f32_16x16x32_bf16 v[92:95], v[152:155], a[236:239], v[92:95]
  buffer_load_dwordx4 v[152:155], v1, s[4:7], s23 offen offset:1024 sc1
  s_waitcnt vmcnt(18)
  v_mfma_f32_16x16x32_bf16 v[108:111], v[156:159], a[236:239], v[108:111]
  v_mul_f32 v190, v190, v62
  v_mul_f32 v191, v191, v63
  v_mfma_f32_16x16x32_bf16 v[104:107], v[156:159], a[232:235], v[104:107]
  v_exp_f32 v188, v188
  v_mfma_f32_16x16x32_bf16 v[100:103], v[156:159], a[228:231], v[100:103]
  v_mul_f32 v60, v60, v76
  v_mfma_f32_16x16x32_bf16 v[96:99], v[156:159], a[224:227], v[96:99]
  buffer_load_dwordx4 v[156:159], v1, s[4:7], s23 offen offset:2048 sc1
  s_add_u32 s23, s23, 0xc00
  s_waitcnt vmcnt(18)
  v_mfma_f32_16x16x32_bf16 v[80:83], v[160:163], a[240:243], v[80:83]
  v_exp_f32 v189, v189
  v_mfma_f32_16x16x32_bf16 v[84:87], v[160:163], a[244:247], v[84:87]
  v_mul_f32 v61, v61, v77
  v_mfma_f32_16x16x32_bf16 v[88:91], v[160:163], a[248:251], v[88:91]
  v_exp_f32 v190, v190
  v_mul_f32 v62, v62, v78
  v_mfma_f32_16x16x32_bf16 v[92:95], v[160:163], a[252:255], v[92:95]
  buffer_load_dwordx4 v[160:163], v1, s[4:7], s23 offen sc1
  s_waitcnt vmcnt(18)
  v_mfma_f32_16x16x32_bf16 v[108:111], v[164:167], a[252:255], v[108:111]
  v_exp_f32 v191, v191
  v_mfma_f32_16x16x32_bf16 v[104:107], v[164:167], a[248:251], v[104:107]
  v_mul_f32 v63, v63, v79
  v_mfma_f32_16x16x32_bf16 v[100:103], v[164:167], a[244:247], v[100:103]
  v_add_f32 v188, 1.0, v188
  v_add_f32 v189, 1.0, v189
  v_mfma_f32_16x16x32_bf16 v[96:99], v[164:167], a[240:243], v[96:99]
  buffer_load_dwordx4 v[164:167], v1, s[4:7], s23 offen offset:1024 sc1
  s_waitcnt vmcnt(18)
  v_mfma_f32_16x16x32_bf16 v[80:83], v[168:171], v[16:19], v[80:83]
  v_add_f32 v190, 1.0, v190
  v_add_f32 v191, 1.0, v191
  v_mfma_f32_16x16x32_bf16 v[84:87], v[168:171], v[20:23], v[84:87]
  v_rcp_f32 v188, v188
  v_mfma_f32_16x16x32_bf16 v[88:91], v[168:171], v[24:27], v[88:91]
  v_rcp_f32 v189, v189
  v_mfma_f32_16x16x32_bf16 v[92:95], v[168:171], v[28:31], v[92:95]
  buffer_load_dwordx4 v[168:171], v1, s[4:7], s23 offen offset:2048 sc1
  s_add_u32 s23, s23, 0xc00
  s_waitcnt vmcnt(18)
  v_mfma_f32_16x16x32_bf16 v[108:111], v[172:175], v[28:31], v[108:111]
  v_mfma_f32_16x16x32_bf16 v[104:107], v[172:175], v[24:27], v[104:107]
  v_rcp_f32 v190, v190
  v_mfma_f32_16x16x32_bf16 v[100:103], v[172:175], v[20:23], v[100:103]
  v_rcp_f32 v191, v191
  v_mfma_f32_16x16x32_bf16 v[96:99], v[172:175], v[16:19], v[96:99]
  buffer_load_dwordx4 v[172:175], v1, s[4:7], s23 offen sc1
  s_waitcnt vmcnt(18)
  v_mfma_f32_16x16x32_bf16 v[80:83], v[176:179], v[32:35], v[80:83]
  v_mul_f32 v60, v60, v188
  v_mul_f32 v61, v61, v189
  v_mfma_f32_16x16x32_bf16 v[84:87], v[176:179], v[36:39], v[84:87]
  v_mul_f32 v62, v62, v190
  v_mul_f32 v63, v63, v191
  v_mfma_f32_16x16x32_bf16 v[88:91], v[176:179], v[40:43], v[88:91]
  v_cvt_pk_bf16_f32 v198, v60, v61
  v_cvt_pk_bf16_f32 v199, v62, v63
  v_mfma_f32_16x16x32_bf16 v[92:95], v[176:179], v[44:47], v[92:95]
  buffer_load_dwordx4 v[176:179], v1, s[4:7], s23 offen offset:1024 sc1
  s_waitcnt vmcnt(18)
  v_mfma_f32_16x16x32_bf16 v[108:111], v[180:183], v[44:47], v[108:111]
  ds_write_b64 v6, v[198:199] offset:3072
  v_mfma_f32_16x16x32_bf16 v[104:107], v[180:183], v[40:43], v[104:107]
  v_add_u32 v6, 0x2000, v6
  v_mfma_f32_16x16x32_bf16 v[100:103], v[180:183], v[36:39], v[100:103]
  v_mfma_f32_16x16x32_bf16 v[96:99], v[180:183], v[32:35], v[96:99]
  buffer_load_dwordx4 v[180:183], v1, s[4:7], s23 offen offset:2048 sc1
  s_add_u32 s23, s23, 0xc00
  s_mov_b32 s25, 2
  s_mov_b32 s26, 2
  v_and_b32 v9, 31, v0
  v_lshlrev_b32 v9, 3, v9
  v_add_u32 v9, s22, v9
  v_lshlrev_b32 v9, 2, v9
  v_add_u32 v9, s20, v9
  v_lshlrev_b32 v9, 3, v9
  v_add_u32 v9, 229376, v9
ffn_loopA:
  s_waitcnt vmcnt(17)
  v_mfma_f32_16x16x32_bf16 v[48:51], v[112:115], a[0:3], 0
  v_mfma_f32_16x16x32_bf16 v[52:55], v[112:115], a[4:7], 0
  v_mfma_f32_16x16x32_bf16 v[56:59], v[112:115], a[8:11], 0
  v_mfma_f32_16x16x32_bf16 v[60:63], v[112:115], a[12:15], 0
  buffer_load_dwordx4 v[112:115], v1, s[4:7], s23 offen sc1
  s_waitcnt vmcnt(17)
  v_mfma_f32_16x16x32_bf16 v[76:79], v[116:119], a[12:15], 0
  v_mfma_f32_16x16x32_bf16 v[72:75], v[116:119], a[8:11], 0
  v_mfma_f32_16x16x32_bf16 v[68:71], v[116:119], a[4:7], 0
  v_mul_f32 v184, v80, v80
  v_mul_f32 v185, v81, v81
  v_mfma_f32_16x16x32_bf16 v[64:67], v[116:119], a[0:3], 0
  buffer_load_dwordx4 v[116:119], v1, s[4:7], s23 offen offset:1024 sc1
  s_waitcnt vmcnt(17)
  v_mfma_f32_16x16x32_bf16 v[48:51], v[120:123], a[16:19], v[48:51]
  v_mul_f32 v186, v82, v82
  v_mfma_f32_16x16x32_bf16 v[52:55], v[120:123], a[20:23], v[52:55]
  v_mul_f32 v187, v83, v83
  v_fmaak_f32 v184, v184, v4, 0xc0135761
  v_mfma_f32_16x16x32_bf16 v[56:59], v[120:123], a[24:27], v[56:59]
  v_fmaak_f32 v185, v185, v4, 0xc0135761
  v_fmaak_f32 v186, v186, v4, 0xc0135761
  v_mfma_f32_16x16x32_bf16 v[60:63], v[120:123], a[28:31], v[60:63]
  buffer_load_dwordx4 v[120:123], v1, s[4:7], s23 offen offset:2048 sc1
  s_add_u32 s23, s23, 0xc00
  s_waitcnt vmcnt(17)
  v_mfma_f32_16x16x32_bf16 v[76:79], v[124:127], a[28:31], v[76:79]
  v_fmaak_f32 v187, v187, v4, 0xc0135761
  v_mul_f32 v184, v184, v80
  v_mfma_f32_16x16x32_bf16 v[72:75], v[124:127], a[24:27], v[72:75]
  v_mul_f32 v185, v185, v81
  v_mfma_f32_16x16x32_bf16 v[68:71], v[124:127], a[20:23], v[68:71]
  v_mul_f32 v186, v186, v82
  v_mul_f32 v187, v187, v83
  v_mfma_f32_16x16x32_bf16 v[64:67], v[124:127], a[16:19], v[64:67]
  buffer_load_dwordx4 v[124:127], v1, s[4:7], s23 offen sc1
  s_waitcnt vmcnt(17)
  v_mfma_f32_16x16x32_bf16 v[48:51], v[128:131], a[32:35], v[48:51]
  v_exp_f32 v184, v184
  v_mfma_f32_16x16x32_bf16 v[52:55], v[128:131], a[36:39], v[52:55]
  v_mul_f32 v80, v80, v96
  v_mfma_f32_16x16x32_bf16 v[56:59], v[128:131], a[40:43], v[56:59]
  v_exp_f32 v185, v185
  v_mfma_f32_16x16x32_bf16 v[60:63], v[128:131], a[44:47], v[60:63]
  buffer_load_dwordx4 v[128:131], v1, s[4:7], s23 offen offset:1024 sc1
  s_waitcnt vmcnt(17)
  v_mfma_f32_16x16x32_bf16 v[76:79], v[132:135], a[44:47], v[76:79]
  v_mul_f32 v81, v81, v97
  v_exp_f32 v186, v186
  v_mfma_f32_16x16x32_bf16 v[72:75], v[132:135], a[40:43], v[72:75]
  v_mul_f32 v82, v82, v98
  v_mfma_f32_16x16x32_bf16 v[68:71], v[132:135], a[36:39], v[68:71]
  v_exp_f32 v187, v187
  v_mfma_f32_16x16x32_bf16 v[64:67], v[132:135], a[32:35], v[64:67]
  buffer_load_dwordx4 v[132:135], v1, s[4:7], s23 offen offset:2048 sc1
  s_add_u32 s23, s23, 0xc00
  s_waitcnt vmcnt(17)
  v_mfma_f32_16x16x32_bf16 v[48:51], v[136:139], a[48:51], v[48:51]
  v_mul_f32 v83, v83, v99
  v_mfma_f32_16x16x32_bf16 v[52:55], v[136:139], a[52:55], v[52:55]
  v_add_f32 v184, 1.0, v184
  v_add_f32 v185, 1.0, v185
  v_mfma_f32_16x16x32_bf16 v[56:59], v[136:139], a[56:59], v[56:59]
  v_add_f32 v186, 1.0, v186
  v_add_f32 v187, 1.0, v187
  v_mfma_f32_16x16x32_bf16 v[60:63], v[136:139], a[60:63], v[60:63]
  buffer_load_dwordx4 v[136:139], v1, s[4:7], s23 offen sc1
  s_waitcnt vmcnt(17)
  v_mfma_f32_16x16x32_bf16 v[76:79], v[140:143], a[60:63], v[76:79]
  v_rcp_f32 v184, v184
  v_mfma_f32_16x16x32_bf16 v[72:75], v[140:143], a[56:59], v[72:75]
  v_rcp_f32 v185, v185
  v_mfma_f32_16x16x32_bf16 v[68:71], v[140:143], a[52:55], v[68:71]
  v_mfma_f32_16x16x32_bf16 v[64:67], v[140:143], a[48:51], v[64:67]
  buffer_load_dwordx4 v[140:143], v1, s[4:7], s23 offen offset:1024 sc1
  s_waitcnt vmcnt(17)
  v_mfma_f32_16x16x32_bf16 v[48:51], v[144:147], a[64:67], v[48:51]
  v_rcp_f32 v186, v186
  v_mfma_f32_16x16x32_bf16 v[52:55], v[144:147], a[68:71], v[52:55]
  v_rcp_f32 v187, v187
  v_mfma_f32_16x16x32_bf16 v[56:59], v[144:147], a[72:75], v[56:59]
  v_mul_f32 v80, v80, v184
  v_mul_f32 v81, v81, v185
  v_mfma_f32_16x16x32_bf16 v[60:63], v[144:147], a[76:79], v[60:63]
  buffer_load_dwordx4 v[144:147], v1, s[4:7], s23 offen offset:2048 sc1
  s_add_u32 s23, s23, 0xc00
  s_waitcnt vmcnt(17)
  v_mfma_f32_16x16x32_bf16 v[76:79], v[148:151], a[76:79], v[76:79]
  v_mul_f32 v82, v82, v186
  v_mul_f32 v83, v83, v187
  v_mfma_f32_16x16x32_bf16 v[72:75], v[148:151], a[72:75], v[72:75]
  v_cvt_pk_bf16_f32 v192, v80, v81
  v_cvt_pk_bf16_f32 v193, v82, v83
  v_mfma_f32_16x16x32_bf16 v[68:71], v[148:151], a[68:71], v[68:71]
  ds_write_b64 v6, v[192:193] offset:0
  v_mfma_f32_16x16x32_bf16 v[64:67], v[148:151], a[64:67], v[64:67]
  buffer_load_dwordx4 v[148:151], v1, s[4:7], s23 offen sc1
  s_waitcnt vmcnt(17)
  v_mfma_f32_16x16x32_bf16 v[48:51], v[152:155], a[80:83], v[48:51]
  v_mul_f32 v188, v84, v84
  v_mfma_f32_16x16x32_bf16 v[52:55], v[152:155], a[84:87], v[52:55]
  v_mul_f32 v189, v85, v85
  v_mul_f32 v190, v86, v86
  v_mfma_f32_16x16x32_bf16 v[56:59], v[152:155], a[88:91], v[56:59]
  v_mul_f32 v191, v87, v87
  v_fmaak_f32 v188, v188, v4, 0xc0135761
  v_mfma_f32_16x16x32_bf16 v[60:63], v[152:155], a[92:95], v[60:63]
  buffer_load_dwordx4 v[152:155], v1, s[4:7], s23 offen offset:1024 sc1
  s_waitcnt vmcnt(17)
  v_mfma_f32_16x16x32_bf16 v[76:79], v[156:159], a[92:95], v[76:79]
  v_fmaak_f32 v189, v189, v4, 0xc0135761
  v_mfma_f32_16x16x32_bf16 v[72:75], v[156:159], a[88:91], v[72:75]
  v_fmaak_f32 v190, v190, v4, 0xc0135761
  v_fmaak_f32 v191, v191, v4, 0xc0135761
  v_mfma_f32_16x16x32_bf16 v[68:71], v[156:159], a[84:87], v[68:71]
  v_mul_f32 v188, v188, v84
  v_mul_f32 v189, v189, v85
  v_mfma_f32_16x16x32_bf16 v[64:67], v[156:159], a[80:83], v[64:67]
  buffer_load_dwordx4 v[156:159], v1, s[4:7], s23 offen offset:2048 sc1
  s_add_u32 s23, s23, 0xc00
  s_waitcnt vmcnt(17)
  v_mfma_f32_16x16x32_bf16 v[48:51], v[160:163], a[96:99], v[48:51]
  v_mul_f32 v190, v190, v86
  v_mul_f32 v191, v191, v87
  v_mfma_f32_16x16x32_bf16 v[52:55], v[160:163], a[100:103], v[52:55]
  v_exp_f32 v188, v188
  v_mfma_f32_16x16x32_bf16 v[56:59], v[160:163], a[104:107], v[56:59]
  v_mul_f32 v84, v84, v100
  v_mfma_f32_16x16x32_bf16 v[60:63], v[160:163], a[108:111], v[60:63]
  buffer_load_dwordx4 v[160:163], v1, s[4:7], s23 offen sc1
  s_waitcnt vmcnt(17)
  v_mfma_f32_16x16x32_bf16 v[76:79], v[164:167], a[108:111], v[76:79]
  v_exp_f32 v189, v189
  v_mfma_f32_16x16x32_bf16 v[72:75], v[164:167], a[104:107], v[72:75]
  v_mul_f32 v85, v85, v101
  v_mfma_f32_16x16x32_bf16 v[68:71], v[164:167], a[100:103], v[68:71]
  v_exp_f32 v190, v190
  v_mfma_f32_16x16x32_bf16 v[64:67], v[164:167], a[96:99], v[64:67]
  buffer_load_dwordx4 v[164:167], v1, s[4:7], s23 offen offset:1024 sc1
  s_waitcnt vmcnt(17)
  v_mfma_f32_16x16x32_bf16 v[48:51], v[168:171], a[112:115], v[48:51]
  v_mul_f32 v86, v86, v102
  v_mfma_f32_16x16x32_bf16 v[52:55], v[168:171], a[116:119], v[52:55]
  v_exp_f32 v191, v191
  v_mul_f32 v87, v87, v103
  v_mfma_f32_16x16x32_bf16 v[56:59], v[168:171], a[120:123], v[56:59]
  v_add_f32 v188, 1.0, v188
  v_mfma_f32_16x16x32_bf16 v[60:63], v[168:171], a[124:127], v[60:63]
  buffer_load_dwordx4 v[168:171], v1, s[4:7], s23 offen offset:2048 sc1
  s_add_u32 s23, s23, 0xc00
  s_waitcnt vmcnt(17)
  v_mfma_f32_16x16x32_bf16 v[76:79], v[172:175], a[124:127], v[76:79]
  v_add_f32 v189, 1.0, v189
  v_add_f32 v190, 1.0, v190
  v_mfma_f32_16x16x32_bf16 v[72:75], v[172:175], a[120:123], v[72:75]
  v_add_f32 v191, 1.0, v191
  v_mfma_f32_16x16x32_bf16 v[68:71], v[172:175], a[116:119], v[68:71]
  v_rcp_f32 v188, v188
  v_mfma_f32_16x16x32_bf16 v[64:67], v[172:175], a[112:115], v[64:67]
  buffer_load_dwordx4 v[172:175], v1, s[4:7], s23 offen sc1
  s_waitcnt vmcnt(17)
  v_mfma_f32_16x16x32_bf16 v[48:51], v[176:179], a[128:131], v[48:51]
  v_rcp_f32 v189, v189
  v_mfma_f32_16x16x32_bf16 v[52:55], v[176:179], a[132:135], v[52:55]
  v_rcp_f32 v190, v190
  v_mfma_f32_16x16x32_bf16 v[56:59], v[176:179], a[136:139], v[56:59]
  v_rcp_f32 v191, v191
  v_mfma_f32_16x16x32_bf16 v[60:63], v[176:179], a[140:143], v[60:63]
  buffer_load_dwordx4 v[176:179], v1, s[4:7], s23 offen offset:1024 sc1
  s_waitcnt vmcnt(17)
  v_mfma_f32_16x16x32_bf16 v[76:79], v[180:183], a[140:143], v[76:79]
  v_mul_f32 v84, v84, v188
  v_mul_f32 v85, v85, v189
  v_mfma_f32_16x16x32_bf16 v[72:75], v[180:183], a[136:139], v[72:75]
  v_mul_f32 v86, v86, v190
  v_mfma_f32_16x16x32_bf16 v[68:71], v[180:183], a[132:135], v[68:71]
  v_mul_f32 v87, v87, v191
  v_cvt_pk_bf16_f32 v194, v84, v85
  v_mfma_f32_16x16x32_bf16 v[64:67], v[180:183], a[128:131], v[64:67]
  buffer_load_dwordx4 v[180:183], v1, s[4:7], s23 offen offset:2048 sc1
  s_add_u32 s23, s23, 0xc00
  s_waitcnt vmcnt(17)
  v_mfma_f32_16x16x32_bf16 v[48:51], v[112:115], a[144:147], v[48:51]
  v_cvt_pk_bf16_f32 v195, v86, v87
  v_mfma_f32_16x16x32_bf16 v[52:55], v[112:115], a[148:151], v[52:55]
  ds_write_b64 v6, v[194:195] offset:1024
  v_mul_f32 v184, v88, v88
  v_mfma_f32_16x16x32_bf16 v[56:59], v[112:115], a[152:155], v[56:59]
  v_mul_f32 v185, v89, v89
  v_mfma_f32_16x16x32_bf16 v[60:63], v[112:115], a[156:159], v[60:63]
  buffer_load_dwordx4 v[112:115], v1, s[4:7], s23 offen sc1
  s_waitcnt vmcnt(17)
  v_mfma_f32_16x16x32_bf16 v[76:79], v[116:119], a[156:159], v[76:79]
  v_mul_f32 v186, v90, v90
  v_mul_f32 v187, v91, v91
  v_mfma_f32_16x16x32_bf16 v[72:75], v[116:119], a[152:155], v[72:75]
  v_fmaak_f32 v184, v184, v4, 0xc0135761
  v_fmaak_f32 v185, v185, v4, 0xc0135761
  v_mfma_f32_16x16x32_bf16 v[68:71], v[116:119], a[148:151], v[68:71]
  v_fmaak_f32 v186, v186, v4, 0xc0135761
  v_mfma_f32_16x16x32_bf16 v[64:67], v[116:119], a[144:147], v[64:67]
  buffer_load_dwordx4 v[116:119], v1, s[4:7], s23 offen offset:1024 sc1
  s_waitcnt vmcnt(17)
  v_mfma_f32_16x16x32_bf16 v[48:51], v[120:123], a[160:163], v[48:51]
  v_fmaak_f32 v187, v187, v4, 0xc0135761
  v_mul_f32 v184, v184, v88
  v_mfma_f32_16x16x32_bf16 v[52:55], v[120:123], a[164:167], v[52:55]
  v_mul_f32 v185, v185, v89
  v_mul_f32 v186, v186, v90
  v_mfma_f32_16x16x32_bf16 v[56:59], v[120:123], a[168:171], v[56:59]
  v_mul_f32 v187, v187, v91
  v_mfma_f32_16x16x32_bf16 v[60:63], v[120:123], a[172:175], v[60:63]
  buffer_load_dwordx4 v[120:123], v1, s[4:7], s23 offen offset:2048 sc1
  s_add_u32 s23, s23, 0xc00
  s_waitcnt vmcnt(17)
  v_mfma_f32_16x16x32_bf16 v[76:79], v[124:127], a[172:175], v[76:79]
  v_exp_f32 v184, v184
  v_mfma_f32_16x16x32_bf16 v[72:75], v[124:127], a[168:171], v[72:75]
  v_mul_f32 v88, v88, v104
  v_exp_f32 v185, v185
  v_mfma_f32_16x16x32_bf16 v[68:71], v[124:127], a[164:167], v[68:71]
  v_mul_f32 v89, v89, v105
  v_mfma_f32_16x16x32_bf16 v[64:67], v[124:127], a[160:163], v[64:67]
  buffer_load_dwordx4 v[124:127], v1, s[4:7], s23 offen sc1
  s_waitcnt vmcnt(17)
  v_mfma_f32_16x16x32_bf16 v[48:51], v[128:131], a[176:179], v[48:51]
  v_exp_f32 v186, v186
  v_mfma_f32_16x16x32_bf16 v[52:55], v[128:131], a[180:183], v[52:55]
  v_mul_f32 v90, v90, v106
  v_mfma_f32_16x16x32_bf16 v[56:59], v[128:131], a[184:187], v[56:59]
  v_exp_f32 v187, v187
  v_mfma_f32_16x16x32_bf16 v[60:63], v[128:131], a[188:191], v[60:63]
  buffer_load_dwordx4 v[128:131], v1, s[4:7], s23 offen offset:1024 sc1
  s_waitcnt vmcnt(17)
  v_mfma_f32_16x16x32_bf16 v[76:79], v[132:135], a[188:191], v[76:79]
  v_mul_f32 v91, v91, v107
  v_add_f32 v184, 1.0, v184
  v_mfma_f32_16x16x32_bf16 v[72:75], v[132:135], a[184:187], v[72:75]
  v_add_f32 v185, 1.0, v185
  v_add_f32 v186, 1.0, v186
  v_mfma_f32_16x16x32_bf16 v[68:71], v[132:135], a[180:183], v[68:71]
  v_add_f32 v187, 1.0, v187
  v_mfma_f32_16x16x32_bf16 v[64:67], v[132:135], a[176:179], v[64:67]
  buffer_load_dwordx4 v[132:135], v1, s[4:7], s23 offen offset:2048 sc1
  s_add_u32 s23, s23, 0xc00
  s_waitcnt vmcnt(17)
  v_mfma_f32_16x16x32_bf16 v[48:51], v[136:139], a[192:195], v[48:51]
  v_rcp_f32 v184, v184
  v_mfma_f32_16x16x32_bf16 v[52:55], v[136:139], a[196:199], v[52:55]
  v_rcp_f32 v185, v185
  v_mfma_f32_16x16x32_bf16 v[56:59], v[136:139], a[200:203], v[56:59]
  v_rcp_f32 v186, v186
  v_mfma_f32_16x16x32_bf16 v[60:63], v[136:139], a[204:207], v[60:63]
  buffer_load_dwordx4 v[136:139], v1, s[4:7], s23 offen sc1
  s_waitcnt vmcnt(17)
  v_mfma_f32_16x16x32_bf16 v[76:79], v[140:143], a[204:207], v[76:79]
  v_rcp_f32 v187, v187
  v_mfma_f32_16x16x32_bf16 v[72:75], v[140:143], a[200:203], v[72:75]
  v_mul_f32 v88, v88, v184
  v_mfma_f32_16x16x32_bf16 v[68:71], v[140:143], a[196:199], v[68:71]
  v_mul_f32 v89, v89, v185
  v_mul_f32 v90, v90, v186
  v_mfma_f32_16x16x32_bf16 v[64:67], v[140:143], a[192:195], v[64:67]
  buffer_load_dwordx4 v[140:143], v1, s[4:7], s23 offen offset:1024 sc1
  s_waitcnt vmcnt(17)
  v_mfma_f32_16x16x32_bf16 v[48:51], v[144:147], a[208:211], v[48:51]
  v_mul_f32 v91, v91, v187
  v_mfma_f32_16x16x32_bf16 v[52:55], v[144:147], a[212:215], v[52:55]
  v_cvt_pk_bf16_f32 v196, v88, v89
  v_cvt_pk_bf16_f32 v197, v90, v91
  v_mfma_f32_16x16x32_bf16 v[56:59], v[144:147], a[216:219], v[56:59]
  ds_write_b64 v6, v[196:197] offset:2048
  v_mfma_f32_16x16x32_bf16 v[60:63], v[144:147], a[220:223], v[60:63]
  buffer_load_dwordx4 v[144:147], v1, s[4:7], s23 offen offset:2048 sc1
  s_add_u32 s23, s23, 0xc00
  s_waitcnt vmcnt(17)
  v_mfma_f32_16x16x32_bf16 v[76:79], v[148:151], a[220:223], v[76:79]
  v_mul_f32 v188, v92, v92
  v_mul_f32 v189, v93, v93
  v_mfma_f32_16x16x32_bf16 v[72:75], v[148:151], a[216:219], v[72:75]
  v_mul_f32 v190, v94, v94
  v_mfma_f32_16x16x32_bf16 v[68:71], v[148:151], a[212:215], v[68:71]
  v_mul_f32 v191, v95, v95
  v_fmaak_f32 v188, v188, v4, 0xc0135761
  v_mfma_f32_16x16x32_bf16 v[64:67], v[148:151], a[208:211], v[64:67]
  buffer_load_dwordx4 v[148:151], v1, s[4:7], s23 offen sc1
  s_waitcnt vmcnt(17)
  v_mfma_f32_16x16x32_bf16 v[48:51], v[152:155], a[224:227], v[48:51]
  v_fmaak_f32 v189, v189, v4, 0xc0135761
  v_fmaak_f32 v190, v190, v4, 0xc0135761
  v_mfma_f32_16x16x32_bf16 v[52:55], v[152:155], a[228:231], v[52:55]
  v_fmaak_f32 v191, v191, v4, 0xc0135761
  v_mul_f32 v188, v188, v92
  v_mfma_f32_16x16x32_bf16 v[56:59], v[152:155], a[232:235], v[56:59]
  v_mul_f32 v189, v189, v93
  v_mfma_f32_16x16x32_bf16 v[60:63], v[152:155], a[236:239], v[60:63]
  buffer_load_dwordx4 v[152:155], v1, s[4:7], s23 offen offset:1024 sc1
  s_waitcnt vmcnt(17)
  v_mfma_f32_16x16x32_bf16 v[76:79], v[156:159], a[236:239], v[76:79]
  v_mul_f32 v190, v190, v94
  v_mul_f32 v191, v191, v95
  v_mfma_f32_16x16x32_bf16 v[72:75], v[156:159], a[232:235], v[72:75]
  v_exp_f32 v188, v188
  v_mfma_f32_16x16x32_bf16 v[68:71], v[156:159], a[228:231], v[68:71]
  v_mul_f32 v92, v92, v108
  v_mfma_f32_16x16x32_bf16 v[64:67], v[156:159], a[224:227], v[64:67]
  buffer_load_dwordx4 v[156:159], v1, s[4:7], s23 offen offset:2048 sc1
  s_add_u32 s23, s23, 0xc00
  s_waitcnt vmcnt(17)
  v_mfma_f32_16x16x32_bf16 v[48:51], v[160:163], a[240:243], v[48:51]
  v_exp_f32 v189, v189
  v_mfma_f32_16x16x32_bf16 v[52:55], v[160:163], a[244:247], v[52:55]
  v_mul_f32 v93, v93, v109
  v_mfma_f32_16x16x32_bf16 v[56:59], v[160:163], a[248:251], v[56:59]
  v_exp_f32 v190, v190
  v_mul_f32 v94, v94, v110
  v_mfma_f32_16x16x32_bf16 v[60:63], v[160:163], a[252:255], v[60:63]
  buffer_load_dwordx4 v[160:163], v1, s[4:7], s23 offen sc1
  s_waitcnt vmcnt(17)
  v_mfma_f32_16x16x32_bf16 v[76:79], v[164:167], a[252:255], v[76:79]
  v_exp_f32 v191, v191
  v_mfma_f32_16x16x32_bf16 v[72:75], v[164:167], a[248:251], v[72:75]
  v_mul_f32 v95, v95, v111
  v_mfma_f32_16x16x32_bf16 v[68:71], v[164:167], a[244:247], v[68:71]
  v_add_f32 v188, 1.0, v188
  v_add_f32 v189, 1.0, v189
  v_mfma_f32_16x16x32_bf16 v[64:67], v[164:167], a[240:243], v[64:67]
  buffer_load_dwordx4 v[164:167], v1, s[4:7], s23 offen offset:1024 sc1
  s_waitcnt vmcnt(17)
  v_mfma_f32_16x16x32_bf16 v[48:51], v[168:171], v[16:19], v[48:51]
  v_add_f32 v190, 1.0, v190
  v_add_f32 v191, 1.0, v191
  v_mfma_f32_16x16x32_bf16 v[52:55], v[168:171], v[20:23], v[52:55]
  v_rcp_f32 v188, v188
  v_mfma_f32_16x16x32_bf16 v[56:59], v[168:171], v[24:27], v[56:59]
  v_rcp_f32 v189, v189
  v_mfma_f32_16x16x32_bf16 v[60:63], v[168:171], v[28:31], v[60:63]
  buffer_load_dwordx4 v[168:171], v1, s[4:7], s23 offen offset:2048 sc1
  s_add_u32 s23, s23, 0xc00
  s_waitcnt vmcnt(17)
  v_mfma_f32_16x16x32_bf16 v[76:79], v[172:175], v[28:31], v[76:79]
  v_mfma_f32_16x16x32_bf16 v[72:75], v[172:175], v[24:27], v[72:75]
  v_rcp_f32 v190, v190
  v_mfma_f32_16x16x32_bf16 v[68:71], v[172:175], v[20:23], v[68:71]
  v_rcp_f32 v191, v191
  v_mfma_f32_16x16x32_bf16 v[64:67], v[172:175], v[16:19], v[64:67]
  buffer_load_dwordx4 v[172:175], v1, s[4:7], s23 offen sc1
  s_waitcnt vmcnt(17)
  v_mfma_f32_16x16x32_bf16 v[48:51], v[176:179], v[32:35], v[48:51]
  v_mul_f32 v92, v92, v188
  v_mul_f32 v93, v93, v189
  v_mfma_f32_16x16x32_bf16 v[52:55], v[176:179], v[36:39], v[52:55]
  v_mul_f32 v94, v94, v190
  v_mul_f32 v95, v95, v191
  v_mfma_f32_16x16x32_bf16 v[56:59], v[176:179], v[40:43], v[56:59]
  v_cvt_pk_bf16_f32 v198, v92, v93
  v_cvt_pk_bf16_f32 v199, v94, v95
  v_mfma_f32_16x16x32_bf16 v[60:63], v[176:179], v[44:47], v[60:63]
  buffer_load_dwordx4 v[176:179], v1, s[4:7], s23 offen offset:1024 sc1
  s_waitcnt vmcnt(17)
  v_mfma_f32_16x16x32_bf16 v[76:79], v[180:183], v[44:47], v[76:79]
  ds_write_b64 v6, v[198:199] offset:3072
  v_mfma_f32_16x16x32_bf16 v[72:75], v[180:183], v[40:43], v[72:75]
  v_add_u32 v6, 0x2000, v6
  v_mfma_f32_16x16x32_bf16 v[68:71], v[180:183], v[36:39], v[68:71]
  v_mfma_f32_16x16x32_bf16 v[64:67], v[180:183], v[32:35], v[64:67]
  buffer_load_dwordx4 v[180:183], v1, s[4:7], s23 offen offset:2048 sc1
  s_add_u32 s23, s23, 0xc00
ffn_loopA_odd:
  s_waitcnt vmcnt(17)
  v_mfma_f32_16x16x32_bf16 v[80:83], v[112:115], a[0:3], 0
  v_mfma_f32_16x16x32_bf16 v[84:87], v[112:115], a[4:7], 0
  s_cmp_lg_u32 s25, s26
  s_cbranch_scc1 jit_p0
  buffer_load_dwordx2 v[10:11], v9, s[92:95], 0 offen sc1
jit_p0:
  v_mfma_f32_16x16x32_bf16 v[88:91], v[112:115], a[8:11], 0
  v_mfma_f32_16x16x32_bf16 v[92:95], v[112:115], a[12:15], 0
  buffer_load_dwordx4 v[112:115], v1, s[4:7], s23 offen sc1
  s_waitcnt vmcnt(17)
  v_mfma_f32_16x16x32_bf16 v[108:111], v[116:119], a[12:15], 0
  v_mfma_f32_16x16x32_bf16 v[104:107], v[116:119], a[8:11], 0
  v_mfma_f32_16x16x32_bf16 v[100:103], v[116:119], a[4:7], 0
  v_mul_f32 v184, v48, v48
  v_mul_f32 v185, v49, v49
  v_mfma_f32_16x16x32_bf16 v[96:99], v[116:119], a[0:3], 0
  buffer_load_dwordx4 v[116:119], v1, s[4:7], s23 offen offset:1024 sc1
  s_waitcnt vmcnt(17)
  v_mfma_f32_16x16x32_bf16 v[80:83], v[120:123], a[16:19], v[80:83]
  v_mul_f32 v186, v50, v50
  v_mfma_f32_16x16x32_bf16 v[84:87], v[120:123], a[20:23], v[84:87]
  v_mul_f32 v187, v51, v51
  v_fmaak_f32 v184, v184, v4, 0xc0135761
  v_mfma_f32_16x16x32_bf16 v[88:91], v[120:123], a[24:27], v[88:91]
  v_fmaak_f32 v185, v185, v4, 0xc0135761
  v_fmaak_f32 v186, v186, v4, 0xc0135761
  v_mfma_f32_16x16x32_bf16 v[92:95], v[120:123], a[28:31], v[92:95]
  buffer_load_dwordx4 v[120:123], v1, s[4:7], s23 offen offset:2048 sc1
  s_add_u32 s23, s23, 0xc00
  s_waitcnt vmcnt(17)
  v_mfma_f32_16x16x32_bf16 v[108:111], v[124:127], a[28:31], v[108:111]
  v_fmaak_f32 v187, v187, v4, 0xc0135761
  v_mul_f32 v184, v184, v48
  v_mfma_f32_16x16x32_bf16 v[104:107], v[124:127], a[24:27], v[104:107]
  v_mul_f32 v185, v185, v49
  v_mfma_f32_16x16x32_bf16 v[100:103], v[124:127], a[20:23], v[100:103]
  v_mul_f32 v186, v186, v50
  v_mul_f32 v187, v187, v51
  v_mfma_f32_16x16x32_bf16 v[96:99], v[124:127], a[16:19], v[96:99]
  buffer_load_dwordx4 v[124:127], v1, s[4:7], s23 offen sc1
  s_waitcnt vmcnt(17)
  v_mfma_f32_16x16x32_bf16 v[80:83], v[128:131], a[32:35], v[80:83]
  v_exp_f32 v184, v184
  v_mfma_f32_16x16x32_bf16 v[84:87], v[128:131], a[36:39], v[84:87]
  v_mul_f32 v48, v48, v64
  v_mfma_f32_16x16x32_bf16 v[88:91], v[128:131], a[40:43], v[88:91]
  v_exp_f32 v185, v185
  v_mfma_f32_16x16x32_bf16 v[92:95], v[128:131], a[44:47], v[92:95]
  buffer_load_dwordx4 v[128:131], v1, s[4:7], s23 offen offset:1024 sc1
  s_waitcnt vmcnt(17)
  v_mfma_f32_16x16x32_bf16 v[108:111], v[132:135], a[44:47], v[108:111]
  v_mul_f32 v49, v49, v65
  v_exp_f32 v186, v186
  v_mfma_f32_16x16x32_bf16 v[104:107], v[132:135], a[40:43], v[104:107]
  v_mul_f32 v50, v50, v66
  v_mfma_f32_16x16x32_bf16 v[100:103], v[132:135], a[36:39], v[100:103]
  v_exp_f32 v187, v187
  v_mfma_f32_16x16x32_bf16 v[96:99], v[132:135], a[32:35], v[96:99]
  buffer_load_dwordx4 v[132:135], v1, s[4:7], s23 offen offset:2048 sc1
  s_add_u32 s23, s23, 0xc00
  s_waitcnt vmcnt(17)
  v_mfma_f32_16x16x32_bf16 v[80:83], v[136:139], a[48:51], v[80:83]
  v_mul_f32 v51, v51, v67
  v_mfma_f32_16x16x32_bf16 v[84:87], v[136:139], a[52:55], v[84:87]
  v_add_f32 v184, 1.0, v184
  v_add_f32 v185, 1.0, v185
  v_mfma_f32_16x16x32_bf16 v[88:91], v[136:139], a[56:59], v[88:91]
  v_add_f32 v186, 1.0, v186
  v_add_f32 v187, 1.0, v187
  v_mfma_f32_16x16x32_bf16 v[92:95], v[136:139], a[60:63], v[92:95]
  buffer_load_dwordx4 v[136:139], v1, s[4:7], s23 offen sc1
  s_waitcnt vmcnt(17)
  v_mfma_f32_16x16x32_bf16 v[108:111], v[140:143], a[60:63], v[108:111]
  v_rcp_f32 v184, v184
  v_mfma_f32_16x16x32_bf16 v[104:107], v[140:143], a[56:59], v[104:107]
  v_rcp_f32 v185, v185
  v_mfma_f32_16x16x32_bf16 v[100:103], v[140:143], a[52:55], v[100:103]
  v_mfma_f32_16x16x32_bf16 v[96:99], v[140:143], a[48:51], v[96:99]
  buffer_load_dwordx4 v[140:143], v1, s[4:7], s23 offen offset:1024 sc1
  s_waitcnt vmcnt(17)
  v_mfma_f32_16x16x32_bf16 v[80:83], v[144:147], a[64:67], v[80:83]
  v_rcp_f32 v186, v186
  v_mfma_f32_16x16x32_bf16 v[84:87], v[144:147], a[68:71], v[84:87]
  v_rcp_f32 v187, v187
  v_mfma_f32_16x16x32_bf16 v[88:91], v[144:147], a[72:75], v[88:91]
  v_mul_f32 v48, v48, v184
  v_mul_f32 v49, v49, v185
  v_mfma_f32_16x16x32_bf16 v[92:95], v[144:147], a[76:79], v[92:95]
  buffer_load_dwordx4 v[144:147], v1, s[4:7], s23 offen offset:2048 sc1
  s_add_u32 s23, s23, 0xc00
  s_waitcnt vmcnt(17)
  v_mfma_f32_16x16x32_bf16 v[108:111], v[148:151], a[76:79], v[108:111]
  v_mul_f32 v50, v50, v186
  v_mul_f32 v51, v51, v187
  v_mfma_f32_16x16x32_bf16 v[104:107], v[148:151], a[72:75], v[104:107]
  v_cvt_pk_bf16_f32 v192, v48, v49
  v_cvt_pk_bf16_f32 v193, v50, v51
  v_mfma_f32_16x16x32_bf16 v[100:103], v[148:151], a[68:71], v[100:103]
  ds_write_b64 v6, v[192:193] offset:0
  v_mfma_f32_16x16x32_bf16 v[96:99], v[148:151], a[64:67], v[96:99]
  buffer_load_dwordx4 v[148:151], v1, s[4:7], s23 offen sc1
  s_waitcnt vmcnt(17)
  v_mfma_f32_16x16x32_bf16 v[80:83], v[152:155], a[80:83], v[80:83]
  v_mul_f32 v188, v52, v52
  v_mfma_f32_16x16x32_bf16 v[84:87], v[152:155], a[84:87], v[84:87]
  v_mul_f32 v189, v53, v53
  v_mul_f32 v190, v54, v54
  v_mfma_f32_16x16x32_bf16 v[88:91], v[152:155], a[88:91], v[88:91]
  v_mul_f32 v191, v55, v55
  v_fmaak_f32 v188, v188, v4, 0xc0135761
  v_mfma_f32_16x16x32_bf16 v[92:95], v[152:155], a[92:95], v[92:95]
  buffer_load_dwordx4 v[152:155], v1, s[4:7], s23 offen offset:1024 sc1
  s_waitcnt vmcnt(17)
  v_mfma_f32_16x16x32_bf16 v[108:111], v[156:159], a[92:95], v[108:111]
  v_fmaak_f32 v189, v189, v4, 0xc0135761
  v_mfma_f32_16x16x32_bf16 v[104:107], v[156:159], a[88:91], v[104:107]
  v_fmaak_f32 v190, v190, v4, 0xc0135761
  v_fmaak_f32 v191, v191, v4, 0xc0135761
  v_mfma_f32_16x16x32_bf16 v[100:103], v[156:159], a[84:87], v[100:103]
  v_mul_f32 v188, v188, v52
  v_mul_f32 v189, v189, v53
  v_mfma_f32_16x16x32_bf16 v[96:99], v[156:159], a[80:83], v[96:99]
  buffer_load_dwordx4 v[156:159], v1, s[4:7], s23 offen offset:2048 sc1
  s_add_u32 s23, s23, 0xc00
  s_waitcnt vmcnt(17)
  v_mfma_f32_16x16x32_bf16 v[80:83], v[160:163], a[96:99], v[80:83]
  v_mul_f32 v190, v190, v54
  v_mul_f32 v191, v191, v55
  v_mfma_f32_16x16x32_bf16 v[84:87], v[160:163], a[100:103], v[84:87]
  v_exp_f32 v188, v188
  v_mfma_f32_16x16x32_bf16 v[88:91], v[160:163], a[104:107], v[88:91]
  v_mul_f32 v52, v52, v68
  v_mfma_f32_16x16x32_bf16 v[92:95], v[160:163], a[108:111], v[92:95]
  buffer_load_dwordx4 v[160:163], v1, s[4:7], s23 offen sc1
  s_waitcnt vmcnt(17)
  v_mfma_f32_16x16x32_bf16 v[108:111], v[164:167], a[108:111], v[108:111]
  v_exp_f32 v189, v189
  v_mfma_f32_16x16x32_bf16 v[104:107], v[164:167], a[104:107], v[104:107]
  v_mul_f32 v53, v53, v69
  v_mfma_f32_16x16x32_bf16 v[100:103], v[164:167], a[100:103], v[100:103]
  v_exp_f32 v190, v190
  v_mfma_f32_16x16x32_bf16 v[96:99], v[164:167], a[96:99], v[96:99]
  buffer_load_dwordx4 v[164:167], v1, s[4:7], s23 offen offset:1024 sc1
  s_waitcnt vmcnt(17)
  v_mfma_f32_16x16x32_bf16 v[80:83], v[168:171], a[112:115], v[80:83]
  v_mul_f32 v54, v54, v70
  v_mfma_f32_16x16x32_bf16 v[84:87], v[168:171], a[116:119], v[84:87]
  v_exp_f32 v191, v191
  v_mul_f32 v55, v55, v71
  v_mfma_f32_16x16x32_bf16 v[88:91], v[168:171], a[120:123], v[88:91]
  v_add_f32 v188, 1.0, v188
  v_mfma_f32_16x16x32_bf16 v[92:95], v[168:171], a[124:127], v[92:95]
  buffer_load_dwordx4 v[168:171], v1, s[4:7], s23 offen offset:2048 sc1
  s_add_u32 s23, s23, 0xc00
  s_waitcnt vmcnt(17)
  v_mfma_f32_16x16x32_bf16 v[108:111], v[172:175], a[124:127], v[108:111]
  v_add_f32 v189, 1.0, v189
  v_add_f32 v190, 1.0, v190
  v_mfma_f32_16x16x32_bf16 v[104:107], v[172:175], a[120:123], v[104:107]
  v_add_f32 v191, 1.0, v191
  v_mfma_f32_16x16x32_bf16 v[100:103], v[172:175], a[116:119], v[100:103]
  v_rcp_f32 v188, v188
  v_mfma_f32_16x16x32_bf16 v[96:99], v[172:175], a[112:115], v[96:99]
  buffer_load_dwordx4 v[172:175], v1, s[4:7], s23 offen sc1
  s_waitcnt vmcnt(17)
  v_mfma_f32_16x16x32_bf16 v[80:83], v[176:179], a[128:131], v[80:83]
  v_rcp_f32 v189, v189
  v_mfma_f32_16x16x32_bf16 v[84:87], v[176:179], a[132:135], v[84:87]
  v_rcp_f32 v190, v190
  v_mfma_f32_16x16x32_bf16 v[88:91], v[176:179], a[136:139], v[88:91]
  v_rcp_f32 v191, v191
  v_mfma_f32_16x16x32_bf16 v[92:95], v[176:179], a[140:143], v[92:95]
  buffer_load_dwordx4 v[176:179], v1, s[4:7], s23 offen offset:1024 sc1
  s_waitcnt vmcnt(17)
  v_mfma_f32_16x16x32_bf16 v[108:111], v[180:183], a[140:143], v[108:111]
  v_mul_f32 v52, v52, v188
  v_mul_f32 v53, v53, v189
  v_mfma_f32_16x16x32_bf16 v[104:107], v[180:183], a[136:139], v[104:107]
  v_mul_f32 v54, v54, v190
  v_mfma_f32_16x16x32_bf16 v[100:103], v[180:183], a[132:135], v[100:103]
  v_mul_f32 v55, v55, v191
  v_cvt_pk_bf16_f32 v194, v52, v53
  v_mfma_f32_16x16x32_bf16 v[96:99], v[180:183], a[128:131], v[96:99]
  buffer_load_dwordx4 v[180:183], v1, s[4:7], s23 offen offset:2048 sc1
  s_add_u32 s23, s23, 0xc00
  s_waitcnt vmcnt(17)
  v_mfma_f32_16x16x32_bf16 v[80:83], v[112:115], a[144:147], v[80:83]
  v_cvt_pk_bf16_f32 v195, v54, v55
  v_mfma_f32_16x16x32_bf16 v[84:87], v[112:115], a[148:151], v[84:87]
  ds_write_b64 v6, v[194:195] offset:1024
  v_mul_f32 v184, v56, v56
  v_mfma_f32_16x16x32_bf16 v[88:91], v[112:115], a[152:155], v[88:91]
  v_mul_f32 v185, v57, v57
  v_mfma_f32_16x16x32_bf16 v[92:95], v[112:115], a[156:159], v[92:95]
  buffer_load_dwordx4 v[112:115], v1, s[4:7], s23 offen sc1
  s_waitcnt vmcnt(17)
  v_mfma_f32_16x16x32_bf16 v[108:111], v[116:119], a[156:159], v[108:111]
  v_mul_f32 v186, v58, v58
  v_mul_f32 v187, v59, v59
  v_mfma_f32_16x16x32_bf16 v[104:107], v[116:119], a[152:155], v[104:107]
  v_fmaak_f32 v184, v184, v4, 0xc0135761
  v_fmaak_f32 v185, v185, v4, 0xc0135761
  v_mfma_f32_16x16x32_bf16 v[100:103], v[116:119], a[148:151], v[100:103]
  v_fmaak_f32 v186, v186, v4, 0xc0135761
  v_mfma_f32_16x16x32_bf16 v[96:99], v[116:119], a[144:147], v[96:99]
  buffer_load_dwordx4 v[116:119], v1, s[4:7], s23 offen offset:1024 sc1
  s_waitcnt vmcnt(17)
  v_mfma_f32_16x16x32_bf16 v[80:83], v[120:123], a[160:163], v[80:83]
  v_fmaak_f32 v187, v187, v4, 0xc0135761
  v_mul_f32 v184, v184, v56
  v_mfma_f32_16x16x32_bf16 v[84:87], v[120:123], a[164:167], v[84:87]
  v_mul_f32 v185, v185, v57
  v_mul_f32 v186, v186, v58
  v_mfma_f32_16x16x32_bf16 v[88:91], v[120:123], a[168:171], v[88:91]
  v_mul_f32 v187, v187, v59
  v_mfma_f32_16x16x32_bf16 v[92:95], v[120:123], a[172:175], v[92:95]
  buffer_load_dwordx4 v[120:123], v1, s[4:7], s23 offen offset:2048 sc1
  s_add_u32 s23, s23, 0xc00
  s_waitcnt vmcnt(17)
  v_mfma_f32_16x16x32_bf16 v[108:111], v[124:127], a[172:175], v[108:111]
  v_exp_f32 v184, v184
  v_mfma_f32_16x16x32_bf16 v[104:107], v[124:127], a[168:171], v[104:107]
  v_mul_f32 v56, v56, v72
  v_exp_f32 v185, v185
  v_mfma_f32_16x16x32_bf16 v[100:103], v[124:127], a[164:167], v[100:103]
  v_mul_f32 v57, v57, v73
  v_mfma_f32_16x16x32_bf16 v[96:99], v[124:127], a[160:163], v[96:99]
  buffer_load_dwordx4 v[124:127], v1, s[4:7], s23 offen sc1
  s_waitcnt vmcnt(17)
  v_mfma_f32_16x16x32_bf16 v[80:83], v[128:131], a[176:179], v[80:83]
  v_exp_f32 v186, v186
  v_mfma_f32_16x16x32_bf16 v[84:87], v[128:131], a[180:183], v[84:87]
  v_mul_f32 v58, v58, v74
  s_cmp_lg_u32 s25, s26
  s_cbranch_scc1 jit_p1
  s_mov_b32 s76, 0x10000
jit_l:
  v_cmp_ne_u64 vcc, s[90:91], v[10:11]
  s_sub_u32 s76, s76, 1
  s_cselect_b64 s[78:79], 0, -1
  s_nop 1
  s_and_b64 vcc, vcc, s[78:79]
  s_cbranch_vccz jit_p1
  buffer_load_dwordx2 v[10:11], v9, s[92:95], 0 offen sc1
  s_waitcnt vmcnt(0)
  s_branch jit_l
jit_p1:
  v_mfma_f32_16x16x32_bf16 v[88:91], v[128:131], a[184:187], v[88:91]
  v_exp_f32 v187, v187
  v_mfma_f32_16x16x32_bf16 v[92:95], v[128:131], a[188:191], v[92:95]
  buffer_load_dwordx4 v[128:131], v1, s[4:7], s23 offen offset:1024 sc1
  s_waitcnt vmcnt(17)
  v_mfma_f32_16x16x32_bf16 v[108:111], v[132:135], a[188:191], v[108:111]
  v_mul_f32 v59, v59, v75
  v_add_f32 v184, 1.0, v184
  v_mfma_f32_16x16x32_bf16 v[104:107], v[132:135], a[184:187], v[104:107]
  v_add_f32 v185, 1.0, v185
  v_add_f32 v186, 1.0, v186
  v_mfma_f32_16x16x32_bf16 v[100:103], v[132:135], a[180:183], v[100:103]
  v_add_f32 v187, 1.0, v187
  v_mfma_f32_16x16x32_bf16 v[96:99], v[132:135], a[176:179], v[96:99]
  buffer_load_dwordx4 v[132:135], v1, s[4:7], s23 offen offset:2048 sc1
  s_add_u32 s23, s23, 0xc00
  s_waitcnt vmcnt(17)
  v_mfma_f32_16x16x32_bf16 v[80:83], v[136:139], a[192:195], v[80:83]
  v_rcp_f32 v184, v184
  v_mfma_f32_16x16x32_bf16 v[84:87], v[136:139], a[196:199], v[84:87]
  v_rcp_f32 v185, v185
  v_mfma_f32_16x16x32_bf16 v[88:91], v[136:139], a[200:203], v[88:91]
  v_rcp_f32 v186, v186
  v_mfma_f32_16x16x32_bf16 v[92:95], v[136:139], a[204:207], v[92:95]
  buffer_load_dwordx4 v[136:139], v1, s[4:7], s23 offen sc1
  s_waitcnt vmcnt(17)
  v_mfma_f32_16x16x32_bf16 v[108:111], v[140:143], a[204:207], v[108:111]
  v_rcp_f32 v187, v187
  v_mfma_f32_16x16x32_bf16 v[104:107], v[140:143], a[200:203], v[104:107]
  v_mul_f32 v56, v56, v184
  v_mfma_f32_16x16x32_bf16 v[100:103], v[140:143], a[196:199], v[100:103]
  v_mul_f32 v57, v57, v185
  v_mul_f32 v58, v58, v186
  v_mfma_f32_16x16x32_bf16 v[96:99], v[140:143], a[192:195], v[96:99]
  buffer_load_dwordx4 v[140:143], v1, s[4:7], s23 offen offset:1024 sc1
  s_waitcnt vmcnt(17)
  v_mfma_f32_16x16x32_bf16 v[80:83], v[144:147], a[208:211], v[80:83]
  v_mul_f32 v59, v59, v187
  v_mfma_f32_16x16x32_bf16 v[84:87], v[144:147], a[212:215], v[84:87]
  v_cvt_pk_bf16_f32 v196, v56, v57
  v_cvt_pk_bf16_f32 v197, v58, v59
  v_mfma_f32_16x16x32_bf16 v[88:91], v[144:147], a[216:219], v[88:91]
  ds_write_b64 v6, v[196:197] offset:2048
  v_mfma_f32_16x16x32_bf16 v[92:95], v[144:147], a[220:223], v[92:95]
  buffer_load_dwordx4 v[144:147], v1, s[4:7], s23 offen offset:2048 sc1
  s_add_u32 s23, s23, 0xc00
  s_waitcnt vmcnt(17)
  v_mfma_f32_16x16x32_bf16 v[108:111], v[148:151], a[220:223], v[108:111]
  v_mul_f32 v188, v60, v60
  v_mul_f32 v189, v61, v61
  v_mfma_f32_16x16x32_bf16 v[104:107], v[148:151], a[216:219], v[104:107]
  v_mul_f32 v190, v62, v62
  v_mfma_f32_16x16x32_bf16 v[100:103], v[148:151], a[212:215], v[100:103]
  v_mul_f32 v191, v63, v63
  v_fmaak_f32 v188, v188, v4, 0xc0135761
  v_mfma_f32_16x16x32_bf16 v[96:99], v[148:151], a[208:211], v[96:99]
  buffer_load_dwordx4 v[148:151], v1, s[4:7], s23 offen sc1
  s_waitcnt vmcnt(17)
  v_mfma_f32_16x16x32_bf16 v[80:83], v[152:155], a[224:227], v[80:83]
  v_fmaak_f32 v189, v189, v4, 0xc0135761
  v_fmaak_f32 v190, v190, v4, 0xc0135761
  v_mfma_f32_16x16x32_bf16 v[84:87], v[152:155], a[228:231], v[84:87]
  v_fmaak_f32 v191, v191, v4, 0xc0135761
  v_mul_f32 v188, v188, v60
  v_mfma_f32_16x16x32_bf16 v[88:91], v[152:155], a[232:235], v[88:91]
  v_mul_f32 v189, v189, v61
  v_mfma_f32_16x16x32_bf16 v[92:95], v[152:155], a[236:239], v[92:95]
  buffer_load_dwordx4 v[152:155], v1, s[4:7], s23 offen offset:1024 sc1
  s_waitcnt vmcnt(17)
  v_mfma_f32_16x16x32_bf16 v[108:111], v[156:159], a[236:239], v[108:111]
  v_mul_f32 v190, v190, v62
  v_mul_f32 v191, v191, v63
  v_mfma_f32_16x16x32_bf16 v[104:107], v[156:159], a[232:235], v[104:107]
  v_exp_f32 v188, v188
  v_mfma_f32_16x16x32_bf16 v[100:103], v[156:159], a[228:231], v[100:103]
  v_mul_f32 v60, v60, v76
  v_mfma_f32_16x16x32_bf16 v[96:99], v[156:159], a[224:227], v[96:99]
  buffer_load_dwordx4 v[156:159], v1, s[4:7], s23 offen offset:2048 sc1
  s_add_u32 s23, s23, 0xc00
  s_waitcnt vmcnt(17)
  v_mfma_f32_16x16x32_bf16 v[80:83], v[160:163], a[240:243], v[80:83]
  v_exp_f32 v189, v189
  v_mfma_f32_16x16x32_bf16 v[84:87], v[160:163], a[244:247], v[84:87]
  v_mul_f32 v61, v61, v77
  v_mfma_f32_16x16x32_bf16 v[88:91], v[160:163], a[248:251], v[88:91]
  v_exp_f32 v190, v190
  v_mul_f32 v62, v62, v78
  v_mfma_f32_16x16x32_bf16 v[92:95], v[160:163], a[252:255], v[92:95]
  buffer_load_dwordx4 v[160:163], v1, s[4:7], s23 offen sc1
  s_waitcnt vmcnt(17)
  v_mfma_f32_16x16x32_bf16 v[108:111], v[164:167], a[252:255], v[108:111]
  v_exp_f32 v191, v191
  v_mfma_f32_16x16x32_bf16 v[104:107], v[164:167], a[248:251], v[104:107]
  v_mul_f32 v63, v63, v79
  v_mfma_f32_16x16x32_bf16 v[100:103], v[164:167], a[244:247], v[100:103]
  v_add_f32 v188, 1.0, v188
  v_add_f32 v189, 1.0, v189
  v_mfma_f32_16x16x32_bf16 v[96:99], v[164:167], a[240:243], v[96:99]
  buffer_load_dwordx4 v[164:167], v1, s[4:7], s23 offen offset:1024 sc1
  s_waitcnt vmcnt(17)
  v_mfma_f32_16x16x32_bf16 v[80:83], v[168:171], v[16:19], v[80:83]
  v_add_f32 v190, 1.0, v190
  v_add_f32 v191, 1.0, v191
  v_mfma_f32_16x16x32_bf16 v[84:87], v[168:171], v[20:23], v[84:87]
  v_rcp_f32 v188, v188
  v_mfma_f32_16x16x32_bf16 v[88:91], v[168:171], v[24:27], v[88:91]
  v_rcp_f32 v189, v189
  v_mfma_f32_16x16x32_bf16 v[92:95], v[168:171], v[28:31], v[92:95]
  buffer_load_dwordx4 v[168:171], v1, s[4:7], s23 offen offset:2048 sc1
  s_add_u32 s23, s23, 0xc00
  s_waitcnt vmcnt(17)
  v_mfma_f32_16x16x32_bf16 v[108:111], v[172:175], v[28:31], v[108:111]
  v_mfma_f32_16x16x32_bf16 v[104:107], v[172:175], v[24:27], v[104:107]
  v_rcp_f32 v190, v190
  v_mfma_f32_16x16x32_bf16 v[100:103], v[172:175], v[20:23], v[100:103]
  v_rcp_f32 v191, v191
  v_mfma_f32_16x16x32_bf16 v[96:99], v[172:175], v[16:19], v[96:99]
  buffer_load_dwordx4 v[172:175], v1, s[4:7], s23 offen sc1
  s_waitcnt vmcnt(17)
  v_mfma_f32_16x16x32_bf16 v[80:83], v[176:179], v[32:35], v[80:83]
  v_mul_f32 v60, v60, v188
  v_mul_f32 v61, v61, v189
  v_mfma_f32_16x16x32_bf16 v[84:87], v[176:179], v[36:39], v[84:87]
  v_mul_f32 v62, v62, v190
  v_mul_f32 v63, v63, v191
  v_mfma_f32_16x16x32_bf16 v[88:91], v[176:179], v[40:43], v[88:91]
  v_cvt_pk_bf16_f32 v198, v60, v61
  v_cvt_pk_bf16_f32 v199, v62, v63
  v_mfma_f32_16x16x32_bf16 v[92:95], v[176:179], v[44:47], v[92:95]
  buffer_load_dwordx4 v[176:179], v1, s[4:7], s23 offen offset:1024 sc1
  s_waitcnt vmcnt(17)
  v_mfma_f32_16x16x32_bf16 v[108:111], v[180:183], v[44:47], v[108:111]
  ds_write_b64 v6, v[198:199] offset:3072
  v_mfma_f32_16x16x32_bf16 v[104:107], v[180:183], v[40:43], v[104:107]
  v_add_u32 v6, 0x2000, v6
  v_mfma_f32_16x16x32_bf16 v[100:103], v[180:183], v[36:39], v[100:103]
  v_mfma_f32_16x16x32_bf16 v[96:99], v[180:183], v[32:35], v[96:99]
  buffer_load_dwordx4 v[180:183], v1, s[4:7], s23 offen offset:2048 sc1
  s_add_u32 s23, s23, 0xc00
  s_sub_u32 s25, s25, 1
  s_cmp_lg_u32 s25, 0
  s_cbranch_scc1 ffn_loopA
  s_mul_i32 s50, s20, 17408
  s_add_u32 s50, s50, 92160
  v_add_u32 v5, s50, v1
  s_sub_u32 s50, s50, 4096
  s_waitcnt lgkmcnt(0)
  s_barrier
  s_waitcnt vmcnt(17)
  v_mfma_f32_16x16x32_bf16 v[48:51], v[112:115], a[0:3], 0
  v_mfma_f32_16x16x32_bf16 v[52:55], v[112:115], a[4:7], 0
  v_mfma_f32_16x16x32_bf16 v[56:59], v[112:115], a[8:11], 0
  v_mfma_f32_16x16x32_bf16 v[60:63], v[112:115], a[12:15], 0
  buffer_load_dwordx4 v[112:115], v1, s[4:7], s23 offen sc1
  s_waitcnt vmcnt(17)
  v_mfma_f32_16x16x32_bf16 v[76:79], v[116:119], a[12:15], 0
  v_mfma_f32_16x16x32_bf16 v[72:75], v[116:119], a[8:11], 0
  s_mov_b32 s49, 356352
  buffer_load_dwordx4 v[200:203], v1, s[4:7], s49 offen sc1
  v_mfma_f32_16x16x32_bf16 v[68:71], v[116:119], a[4:7], 0
  v_mul_f32 v184, v80, v80
  v_mul_f32 v185, v81, v81
  v_mfma_f32_16x16x32_bf16 v[64:67], v[116:119], a[0:3], 0
  buffer_load_dwordx4 v[116:119], v1, s[4:7], s23 offen offset:1024 sc1
  s_waitcnt vmcnt(18)
  v_mfma_f32_16x16x32_bf16 v[48:51], v[120:123], a[16:19], v[48:51]
  v_mul_f32 v186, v82, v82
  ds_read_b128 a[0:3], v1 offset:0
  v_mfma_f32_16x16x32_bf16 v[52:55], v[120:123], a[20:23], v[52:55]
  v_mul_f32 v187, v83, v83
  v_fmaak_f32 v184, v184, v4, 0xc0135761
  v_mfma_f32_16x16x32_bf16 v[56:59], v[120:123], a[24:27], v[56:59]
  v_fmaak_f32 v185, v185, v4, 0xc0135761
  v_fmaak_f32 v186, v186, v4, 0xc0135761
  ds_read_b128 a[4:7], v1 offset:1024
  v_mfma_f32_16x16x32_bf16 v[60:63], v[120:123], a[28:31], v[60:63]
  buffer_load_dwordx4 v[120:123], v1, s[4:7], s23 offen offset:2048 sc1
  s_add_u32 s23, s23, 0xc00
  s_waitcnt vmcnt(18)
  v_mfma_f32_16x16x32_bf16 v[76:79], v[124:127], a[28:31], v[76:79]
  v_fmaak_f32 v187, v187, v4, 0xc0135761
  v_mul_f32 v184, v184, v80
  ds_read_b128 a[8:11], v1 offset:2048
  v_mfma_f32_16x16x32_bf16 v[72:75], v[124:127], a[24:27], v[72:75]
  v_mul_f32 v185, v185, v81
  s_mov_b32 s49, 364544
  buffer_load_dwordx4 v[204:207], v1, s[4:7], s49 offen sc1
  v_mfma_f32_16x16x32_bf16 v[68:71], v[124:127], a[20:23], v[68:71]
  v_mul_f32 v186, v186, v82
  v_mul_f32 v187, v187, v83
  ds_read_b128 a[12:15], v1 offset:3072
  v_mfma_f32_16x16x32_bf16 v[64:67], v[124:127], a[16:19], v[64:67]
  buffer_load_dwordx4 v[124:127], v1, s[4:7], s23 offen sc1
  s_waitcnt vmcnt(19)
  v_mfma_f32_16x16x32_bf16 v[48:51], v[128:131], a[32:35], v[48:51]
  v_exp_f32 v184, v184
  ds_read_b128 a[16:19], v1 offset:4096
  v_mfma_f32_16x16x32_bf16 v[52:55], v[128:131], a[36:39], v[52:55]
  v_mul_f32 v80, v80, v96
  v_mfma_f32_16x16x32_bf16 v[56:59], v[128:131], a[40:43], v[56:59]
  v_exp_f32 v185, v185
  ds_read_b128 a[20:23], v1 offset:5120
  v_mfma_f32_16x16x32_bf16 v[60:63], v[128:131], a[44:47], v[60:63]
  buffer_load_dwordx4 v[128:131], v1, s[4:7], s23 offen offset:1024 sc1
  s_waitcnt vmcnt(19)
  v_mfma_f32_16x16x32_bf16 v[76:79], v[132:135], a[44:47], v[76:79]
  v_mul_f32 v81, v81, v97
  v_exp_f32 v186, v186
  ds_read_b128 a[24:27], v1 offset:6144
  v_mfma_f32_16x16x32_bf16 v[72:75], v[132:135], a[40:43], v[72:75]
  v_mul_f32 v82, v82, v98
  s_mov_b32 s49, 372736
  buffer_load_dwordx4 v[208:211], v1, s[4:7], s49 offen sc1
  v_mfma_f32_16x16x32_bf16 v[68:71], v[132:135], a[36:39], v[68:71]
  v_exp_f32 v187, v187
  ds_read_b128 a[28:31], v1 offset:7168
  v_mfma_f32_16x16x32_bf16 v[64:67], v[132:135], a[32:35], v[64:67]
  buffer_load_dwordx4 v[132:135], v1, s[4:7], s23 offen offset:2048 sc1
  s_add_u32 s23, s23, 0xc00
  s_waitcnt lgkmcnt(4)
  s_waitcnt vmcnt(20)
  v_mfma_f32_16x16x32_bf16 v[48:51], v[136:139], a[48:51], v[48:51]
  v_mul_f32 v83, v83, v99
  ds_read_b128 a[32:35], v1 offset:8192
  v_mfma_f32_16x16x32_bf16 v[52:55], v[136:139], a[52:55], v[52:55]
  v_add_f32 v184, 1.0, v184
  v_add_f32 v185, 1.0, v185
  v_mfma_f32_16x16x32_bf16 v[56:59], v[136:139], a[56:59], v[56:59]
  v_add_f32 v186, 1.0, v186
  v_add_f32 v187, 1.0, v187
  ds_read_b128 a[36:39], v1 offset:9216
  v_mfma_f32_16x16x32_bf16 v[60:63], v[136:139], a[60:63], v[60:63]
  buffer_load_dwordx4 v[136:139], v1, s[4:7], s23 offen sc1
  s_waitcnt vmcnt(20)
  v_mfma_f32_16x16x32_bf16 v[76:79], v[140:143], a[60:63], v[76:79]
  v_rcp_f32 v184, v184
  ds_read_b128 a[40:43], v1 offset:10240
  v_mfma_f32_16x16x32_bf16 v[72:75], v[140:143], a[56:59], v[72:75]
  v_rcp_f32 v185, v185
  v_mfma_f32_16x16x32_bf16 v[68:71], v[140:143], a[52:55], v[68:71]
  ds_read_b128 a[44:47], v1 offset:11264
  v_mfma_f32_16x16x32_bf16 v[64:67], v[140:143], a[48:51], v[64:67]
  buffer_load_dwordx4 v[140:143], v1, s[4:7], s23 offen offset:1024 sc1
  s_waitcnt vmcnt(20)
  v_mfma_f32_16x16x32_bf16 v[48:51], v[144:147], a[64:67], v[48:51]
  v_rcp_f32 v186, v186
  ds_read_b128 a[48:51], v1 offset:12288
  v_mfma_f32_16x16x32_bf16 v[52:55], v[144:147], a[68:71], v[52:55]
  v_rcp_f32 v187, v187
  s_mov_b32 s49, 380928
  buffer_load_dwordx4 v[212:215], v1, s[4:7], s49 offen sc1
  v_mfma_f32_16x16x32_bf16 v[56:59], v[144:147], a[72:75], v[56:59]
  v_mul_f32 v80, v80, v184
  v_mul_f32 v81, v81, v185
  ds_read_b128 a[52:55], v1 offset:13312
  v_mfma_f32_16x16x32_bf16 v[60:63], v[144:147], a[76:79], v[60:63]
  buffer_load_dwordx4 v[144:147], v1, s[4:7], s23 offen offset:2048 sc1
  s_add_u32 s23, s23, 0xc00
  s_waitcnt vmcnt(21)
  v_mfma_f32_16x16x32_bf16 v[76:79], v[148:151], a[76:79], v[76:79]
  v_mul_f32 v82, v82, v186
  v_mul_f32 v83, v83, v187
  ds_read_b128 a[56:59], v1 offset:14336
  v_mfma_f32_16x16x32_bf16 v[72:75], v[148:151], a[72:75], v[72:75]
  v_cvt_pk_bf16_f32 v192, v80, v81
  v_cvt_pk_bf16_f32 v193, v82, v83
  v_mfma_f32_16x16x32_bf16 v[68:71], v[148:151], a[68:71], v[68:71]
  ds_write_b64 v6, v[192:193] offset:0
  ds_read_b128 a[60:63], v1 offset:15360
  v_mfma_f32_16x16x32_bf16 v[64:67], v[148:151], a[64:67], v[64:67]
  buffer_load_dwordx4 v[148:151], v1, s[4:7], s23 offen sc1
  s_waitcnt lgkmcnt(4)
  s_waitcnt vmcnt(21)
  v_mfma_f32_16x16x32_bf16 v[48:51], v[152:155], a[80:83], v[48:51]
  v_mul_f32 v188, v84, v84
  ds_read_b128 a[64:67], v1 offset:16384
  v_mfma_f32_16x16x32_bf16 v[52:55], v[152:155], a[84:87], v[52:55]
  v_mul_f32 v189, v85, v85
  v_mul_f32 v190, v86, v86
  s_mov_b32 s49, 389120
  buffer_load_dwordx4 v[216:219], v1, s[4:7], s49 offen sc1
  v_mfma_f32_16x16x32_bf16 v[56:59], v[152:155], a[88:91], v[56:59]
  v_mul_f32 v191, v87, v87
  v_fmaak_f32 v188, v188, v4, 0xc0135761
  ds_read_b128 a[68:71], v1 offset:17408
  v_mfma_f32_16x16x32_bf16 v[60:63], v[152:155], a[92:95], v[60:63]
  buffer_load_dwordx4 v[152:155], v1, s[4:7], s23 offen offset:1024 sc1
  s_waitcnt vmcnt(22)
  v_mfma_f32_16x16x32_bf16 v[76:79], v[156:159], a[92:95], v[76:79]
  v_fmaak_f32 v189, v189, v4, 0xc0135761
  ds_read_b128 a[72:75], v1 offset:18432
  v_mfma_f32_16x16x32_bf16 v[72:75], v[156:159], a[88:91], v[72:75]
  v_fmaak_f32 v190, v190, v4, 0xc0135761
  v_fmaak_f32 v191, v191, v4, 0xc0135761
  v_mfma_f32_16x16x32_bf16 v[68:71], v[156:159], a[84:87], v[68:71]
  v_mul_f32 v188, v188, v84
  v_mul_f32 v189, v189, v85
  ds_read_b128 a[76:79], v1 offset:19456
  v_mfma_f32_16x16x32_bf16 v[64:67], v[156:159], a[80:83], v[64:67]
  buffer_load_dwordx4 v[156:159], v1, s[4:7], s23 offen offset:2048 sc1
  s_add_u32 s23, s23, 0xc00
  s_waitcnt vmcnt(22)
  v_mfma_f32_16x16x32_bf16 v[48:51], v[160:163], a[96:99], v[48:51]
  v_mul_f32 v190, v190, v86
  v_mul_f32 v191, v191, v87
  ds_read_b128 a[80:83], v1 offset:20480
  v_mfma_f32_16x16x32_bf16 v[52:55], v[160:163], a[100:103], v[52:55]
  v_exp_f32 v188, v188
  v_mfma_f32_16x16x32_bf16 v[56:59], v[160:163], a[104:107], v[56:59]
  v_mul_f32 v84, v84, v100
  ds_read_b128 a[84:87], v1 offset:21504
  v_mfma_f32_16x16x32_bf16 v[60:63], v[160:163], a[108:111], v[60:63]
  buffer_load_dwordx4 v[160:163], v1, s[4:7], s23 offen sc1
  s_waitcnt vmcnt(22)
  v_mfma_f32_16x16x32_bf16 v[76:79], v[164:167], a[108:111], v[76:79]
  v_exp_f32 v189, v189
  ds_read_b128 a[88:91], v1 offset:22528
  v_mfma_f32_16x16x32_bf16 v[72:75], v[164:167], a[104:107], v[72:75]
  v_mul_f32 v85, v85, v101
  s_mov_b32 s49, 397312
  buffer_load_dwordx4 v[220:223], v1, s[4:7], s49 offen sc1
  v_mfma_f32_16x16x32_bf16 v[68:71], v[164:167], a[100:103], v[68:71]
  v_exp_f32 v190, v190
  ds_read_b128 a[92:95], v1 offset:23552
  v_mfma_f32_16x16x32_bf16 v[64:67], v[164:167], a[96:99], v[64:67]
  buffer_load_dwordx4 v[164:167], v1, s[4:7], s23 offen offset:1024 sc1
  s_waitcnt lgkmcnt(4)
  s_waitcnt vmcnt(23)
  v_mfma_f32_16x16x32_bf16 v[48:51], v[168:171], a[112:115], v[48:51]
  v_mul_f32 v86, v86, v102
  ds_read_b128 a[96:99], v1 offset:24576
  v_mfma_f32_16x16x32_bf16 v[52:55], v[168:171], a[116:119], v[52:55]
  v_exp_f32 v191, v191
  v_mul_f32 v87, v87, v103
  v_mfma_f32_16x16x32_bf16 v[56:59], v[168:171], a[120:123], v[56:59]
  v_add_f32 v188, 1.0, v188
  ds_read_b128 a[100:103], v1 offset:25600
  v_mfma_f32_16x16x32_bf16 v[60:63], v[168:171], a[124:127], v[60:63]
  buffer_load_dwordx4 v[168:171], v1, s[4:7], s23 offen offset:2048 sc1
  s_add_u32 s23, s23, 0xc00
  s_waitcnt vmcnt(23)
  v_mfma_f32_16x16x32_bf16 v[76:79], v[172:175], a[124:127], v[76:79]
  v_add_f32 v189, 1.0, v189
  v_add_f32 v190, 1.0, v190
  ds_read_b128 a[104:107], v1 offset:26624
  v_mfma_f32_16x16x32_bf16 v[72:75], v[172:175], a[120:123], v[72:75]
  v_add_f32 v191, 1.0, v191
  s_mov_b32 s49, 405504
  buffer_load_dwordx4 v[224:227], v1, s[4:7], s49 offen sc1
  v_mfma_f32_16x16x32_bf16 v[68:71], v[172:175], a[116:119], v[68:71]
  v_rcp_f32 v188, v188
  ds_read_b128 a[108:111], v1 offset:27648
  v_mfma_f32_16x16x32_bf16 v[64:67], v[172:175], a[112:115], v[64:67]
  buffer_load_dwordx4 v[172:175], v1, s[4:7], s23 offen sc1
  s_waitcnt vmcnt(24)
  v_mfma_f32_16x16x32_bf16 v[48:51], v[176:179], a[128:131], v[48:51]
  v_rcp_f32 v189, v189
  ds_read_b128 a[112:115], v1 offset:28672
  v_mfma_f32_16x16x32_bf16 v[52:55], v[176:179], a[132:135], v[52:55]
  v_rcp_f32 v190, v190
  v_mfma_f32_16x16x32_bf16 v[56:59], v[176:179], a[136:139], v[56:59]
  v_rcp_f32 v191, v191
  ds_read_b128 a[116:119], v1 offset:29696
  v_mfma_f32_16x16x32_bf16 v[60:63], v[176:179], a[140:143], v[60:63]
  buffer_load_dwordx4 v[176:179], v1, s[4:7], s23 offen offset:1024 sc1
  s_waitcnt vmcnt(24)
  v_mfma_f32_16x16x32_bf16 v[76:79], v[180:183], a[140:143], v[76:79]
  v_mul_f32 v84, v84, v188
  v_mul_f32 v85, v85, v189
  ds_read_b128 a[120:123], v1 offset:30720
  v_mfma_f32_16x16x32_bf16 v[72:75], v[180:183], a[136:139], v[72:75]
  v_mul_f32 v86, v86, v190
  v_mfma_f32_16x16x32_bf16 v[68:71], v[180:183], a[132:135], v[68:71]
  v_mul_f32 v87, v87, v191
  v_cvt_pk_bf16_f32 v194, v84, v85
  ds_read_b128 a[124:127], v1 offset:31744
  v_mfma_f32_16x16x32_bf16 v[64:67], v[180:183], a[128:131], v[64:67]
  buffer_load_dwordx4 v[180:183], v1, s[4:7], s23 offen offset:2048 sc1
  s_add_u32 s23, s23, 0xc00
  s_waitcnt lgkmcnt(4)
  s_waitcnt vmcnt(24)
  v_mfma_f32_16x16x32_bf16 v[48:51], v[112:115], a[144:147], v[48:51]
  v_cvt_pk_bf16_f32 v195, v86, v87
  ds_read_b128 a[128:131], v1 offset:32768
  v_mfma_f32_16x16x32_bf16 v[52:55], v[112:115], a[148:151], v[52:55]
  ds_write_b64 v6, v[194:195] offset:1024
  v_mul_f32 v184, v88, v88
  s_mov_b32 s49, 413696
  buffer_load_dwordx4 v[228:231], v1, s[4:7], s49 offen sc1
  v_mfma_f32_16x16x32_bf16 v[56:59], v[112:115], a[152:155], v[56:59]
  v_mul_f32 v185, v89, v89
  ds_read_b128 a[132:135], v1 offset:33792
  v_mfma_f32_16x16x32_bf16 v[60:63], v[112:115], a[156:159], v[60:63]
  buffer_load_dwordx4 v[112:115], v1, s[4:7], s23 offen sc1
  s_waitcnt vmcnt(24)
  v_mfma_f32_16x16x32_bf16 v[76:79], v[116:119], a[156:159], v[76:79]
  v_mul_f32 v186, v90, v90
  v_mul_f32 v187, v91, v91
  ds_read_b128 a[136:139], v1 offset:34816
  v_mfma_f32_16x16x32_bf16 v[72:75], v[116:119], a[152:155], v[72:75]
  v_fmaak_f32 v184, v184, v4, 0xc0135761
  v_fmaak_f32 v185, v185, v4, 0xc0135761
  v_mfma_f32_16x16x32_bf16 v[68:71], v[116:119], a[148:151], v[68:71]
  v_fmaak_f32 v186, v186, v4, 0xc0135761
  ds_read_b128 a[140:143], v1 offset:35840
  v_mfma_f32_16x16x32_bf16 v[64:67], v[116:119], a[144:147], v[64:67]
  buffer_load_dwordx4 v[116:119], v1, s[4:7], s23 offen offset:1024 sc1
  s_waitcnt vmcnt(24)
  v_mfma_f32_16x16x32_bf16 v[48:51], v[120:123], a[160:163], v[48:51]
  v_fmaak_f32 v187, v187, v4, 0xc0135761
  v_mul_f32 v184, v184, v88
  ds_read_b128 a[144:147], v3 offset:0
  v_mfma_f32_16x16x32_bf16 v[52:55], v[120:123], a[164:167], v[52:55]
  v_mul_f32 v185, v185, v89
  v_mul_f32 v186, v186, v90
  s_mov_b32 s49, 421888
  buffer_load_dwordx4 v[232:235], v1, s[4:7], s49 offen sc1
  v_mfma_f32_16x16x32_bf16 v[56:59], v[120:123], a[168:171], v[56:59]
  v_mul_f32 v187, v187, v91
  ds_read_b128 a[148:151], v3 offset:1024
  v_mfma_f32_16x16x32_bf16 v[60:63], v[120:123], a[172:175], v[60:63]
  buffer_load_dwordx4 v[120:123], v1, s[4:7], s23 offen offset:2048 sc1
  s_add_u32 s23, s23, 0xc00
  s_waitcnt vmcnt(24)
  v_mfma_f32_16x16x32_bf16 v[76:79], v[124:127], a[172:175], v[76:79]
  v_exp_f32 v184, v184
  ds_read_b128 a[152:155], v3 offset:2048
  v_mfma_f32_16x16x32_bf16 v[72:75], v[124:127], a[168:171], v[72:75]
  v_mul_f32 v88, v88, v104
  v_exp_f32 v185, v185
  v_mfma_f32_16x16x32_bf16 v[68:71], v[124:127], a[164:167], v[68:71]
  v_mul_f32 v89, v89, v105
  ds_read_b128 a[156:159], v3 offset:3072
  v_mfma_f32_16x16x32_bf16 v[64:67], v[124:127], a[160:163], v[64:67]
  buffer_load_dwordx4 v[124:127], v1, s[4:7], s23 offen sc1
  s_waitcnt lgkmcnt(4)
  s_waitcnt vmcnt(24)
  v_mfma_f32_16x16x32_bf16 v[48:51], v[128:131], a[176:179], v[48:51]
  v_exp_f32 v186, v186
  ds_read_b128 a[160:163], v3 offset:4096
  v_mfma_f32_16x16x32_bf16 v[52:55], v[128:131], a[180:183], v[52:55]
  v_mul_f32 v90, v90, v106
  s_mov_b32 s49, 430080
  buffer_load_dwordx4 v[236:239], v1, s[4:7], s49 offen sc1
  v_mfma_f32_16x16x32_bf16 v[56:59], v[128:131], a[184:187], v[56:59]
  v_exp_f32 v187, v187
  ds_read_b128 a[164:167], v3 offset:5120
  v_mfma_f32_16x16x32_bf16 v[60:63], v[128:131], a[188:191], v[60:63]
  buffer_load_dwordx4 v[128:131], v1, s[4:7], s23 offen offset:1024 sc1
  s_waitcnt vmcnt(24)
  v_mfma_f32_16x16x32_bf16 v[76:79], v[132:135], a[188:191], v[76:79]
  v_mul_f32 v91, v91, v107
  v_add_f32 v184, 1.0, v184
  ds_read_b128 a[168:171], v3 offset:6144
  v_mfma_f32_16x16x32_bf16 v[72:75], v[132:135], a[184:187], v[72:75]
  v_add_f32 v185, 1.0, v185
  v_add_f32 v186, 1.0, v186
  v_mfma_f32_16x16x32_bf16 v[68:71], v[132:135], a[180:183], v[68:71]
  v_add_f32 v187, 1.0, v187
  ds_read_b128 a[172:175], v3 offset:7168
  v_mfma_f32_16x16x32_bf16 v[64:67], v[132:135], a[176:179], v[64:67]
  buffer_load_dwordx4 v[132:135], v1, s[4:7], s23 offen offset:2048 sc1
  s_add_u32 s23, s23, 0xc00
  s_waitcnt vmcnt(24)
  v_mfma_f32_16x16x32_bf16 v[48:51], v[136:139], a[192:195], v[48:51]
  v_rcp_f32 v184, v184
  ds_read_b128 a[176:179], v3 offset:8192
  v_mfma_f32_16x16x32_bf16 v[52:55], v[136:139], a[196:199], v[52:55]
  v_rcp_f32 v185, v185
  v_mfma_f32_16x16x32_bf16 v[56:59], v[136:139], a[200:203], v[56:59]
  v_rcp_f32 v186, v186
  ds_read_b128 a[180:183], v3 offset:9216
  v_mfma_f32_16x16x32_bf16 v[60:63], v[136:139], a[204:207], v[60:63]
  buffer_load_dwordx4 v[136:139], v1, s[4:7], s23 offen sc1
  s_waitcnt vmcnt(24)
  v_mfma_f32_16x16x32_bf16 v[76:79], v[140:143], a[204:207], v[76:79]
  v_rcp_f32 v187, v187
  ds_read_b128 a[184:187], v3 offset:10240
  v_mfma_f32_16x16x32_bf16 v[72:75], v[140:143], a[200:203], v[72:75]
  v_mul_f32 v88, v88, v184
  s_mov_b32 s49, 438272
  buffer_load_dwordx4 v[240:243], v1, s[4:7], s49 offen sc1
  v_mfma_f32_16x16x32_bf16 v[68:71], v[140:143], a[196:199], v[68:71]
  v_mul_f32 v89, v89, v185
  v_mul_f32 v90, v90, v186
  ds_read_b128 a[188:191], v3 offset:11264
  v_mfma_f32_16x16x32_bf16 v[64:67], v[140:143], a[192:195], v[64:67]
  buffer_load_dwordx4 v[140:143], v1, s[4:7], s23 offen offset:1024 sc1
  s_waitcnt lgkmcnt(4)
  s_waitcnt vmcnt(24)
  v_mfma_f32_16x16x32_bf16 v[48:51], v[144:147], a[208:211], v[48:51]
  v_mul_f32 v91, v91, v187
  ds_read_b128 a[192:195], v3 offset:12288
  v_mfma_f32_16x16x32_bf16 v[52:55], v[144:147], a[212:215], v[52:55]
  v_cvt_pk_bf16_f32 v196, v88, v89
  v_cvt_pk_bf16_f32 v197, v90, v91
  v_mfma_f32_16x16x32_bf16 v[56:59], v[144:147], a[216:219], v[56:59]
  ds_write_b64 v6, v[196:197] offset:2048
  ds_read_b128 a[196:199], v3 offset:13312
  v_mfma_f32_16x16x32_bf16 v[60:63], v[144:147], a[220:223], v[60:63]
  buffer_load_dwordx4 v[144:147], v1, s[4:7], s23 offen offset:2048 sc1
  s_add_u32 s23, s23, 0xc00
  s_waitcnt vmcnt(24)
  v_mfma_f32_16x16x32_bf16 v[76:79], v[148:151], a[220:223], v[76:79]
  v_mul_f32 v188, v92, v92
  v_mul_f32 v189, v93, v93
  ds_read_b128 a[200:203], v3 offset:14336
  v_mfma_f32_16x16x32_bf16 v[72:75], v[148:151], a[216:219], v[72:75]
  v_mul_f32 v190, v94, v94
  s_mov_b32 s49, 446464
  buffer_load_dwordx4 v[244:247], v1, s[4:7], s49 offen sc1
  v_mfma_f32_16x16x32_bf16 v[68:71], v[148:151], a[212:215], v[68:71]
  v_mul_f32 v191, v95, v95
  v_fmaak_f32 v188, v188, v4, 0xc0135761
  ds_read_b128 a[204:207], v3 offset:15360
  v_mfma_f32_16x16x32_bf16 v[64:67], v[148:151], a[208:211], v[64:67]
  buffer_load_dwordx4 v[148:151], v1, s[4:7], s23 offen sc1
  s_waitcnt vmcnt(24)
  v_mfma_f32_16x16x32_bf16 v[48:51], v[152:155], a[224:227], v[48:51]
  v_fmaak_f32 v189, v189, v4, 0xc0135761
  v_fmaak_f32 v190, v190, v4, 0xc0135761
  ds_read_b128 a[208:211], v3 offset:16384
  v_mfma_f32_16x16x32_bf16 v[52:55], v[152:155], a[228:231], v[52:55]
  v_fmaak_f32 v191, v191, v4, 0xc0135761
  v_mul_f32 v188, v188, v92
  v_mfma_f32_16x16x32_bf16 v[56:59], v[152:155], a[232:235], v[56:59]
  v_mul_f32 v189, v189, v93
  ds_read_b128 a[212:215], v3 offset:17408
  v_mfma_f32_16x16x32_bf16 v[60:63], v[152:155], a[236:239], v[60:63]
  buffer_load_dwordx4 v[152:155], v1, s[4:7], s23 offen offset:1024 sc1
  s_waitcnt vmcnt(24)
  v_mfma_f32_16x16x32_bf16 v[76:79], v[156:159], a[236:239], v[76:79]
  v_mul_f32 v190, v190, v94
  v_mul_f32 v191, v191, v95
  ds_read_b128 a[216:219], v3 offset:18432
  v_mfma_f32_16x16x32_bf16 v[72:75], v[156:159], a[232:235], v[72:75]
  v_exp_f32 v188, v188
  v_mfma_f32_16x16x32_bf16 v[68:71], v[156:159], a[228:231], v[68:71]
  v_mul_f32 v92, v92, v108
  ds_read_b128 a[220:223], v3 offset:19456
  v_mfma_f32_16x16x32_bf16 v[64:67], v[156:159], a[224:227], v[64:67]
  buffer_load_dwordx4 v[156:159], v1, s[4:7], s23 offen offset:2048 sc1
  s_add_u32 s23, s23, 0xc00
  s_waitcnt lgkmcnt(4)
  s_waitcnt vmcnt(24)
  v_mfma_f32_16x16x32_bf16 v[48:51], v[160:163], a[240:243], v[48:51]
  v_exp_f32 v189, v189
  v_mfma_f32_16x16x32_bf16 v[52:55], v[160:163], a[244:247], v[52:55]
  v_mul_f32 v93, v93, v109
  s_mov_b32 s49, 454656
  buffer_load_dwordx4 v[248:251], v1, s[4:7], s49 offen sc1
  v_mfma_f32_16x16x32_bf16 v[56:59], v[160:163], a[248:251], v[56:59]
  v_exp_f32 v190, v190
  v_mul_f32 v94, v94, v110
  v_mfma_f32_16x16x32_bf16 v[60:63], v[160:163], a[252:255], v[60:63]
  buffer_load_dwordx4 v[160:163], v1, s[4:7], s23 offen sc1
  s_waitcnt vmcnt(24)
  v_mfma_f32_16x16x32_bf16 v[76:79], v[164:167], a[252:255], v[76:79]
  v_exp_f32 v191, v191
  v_mfma_f32_16x16x32_bf16 v[72:75], v[164:167], a[248:251], v[72:75]
  v_mul_f32 v95, v95, v111
  v_mfma_f32_16x16x32_bf16 v[68:71], v[164:167], a[244:247], v[68:71]
  v_add_f32 v188, 1.0, v188
  v_add_f32 v189, 1.0, v189
  v_mfma_f32_16x16x32_bf16 v[64:67], v[164:167], a[240:243], v[64:67]
  buffer_load_dwordx4 v[164:167], v1, s[4:7], s23 offen offset:1024 sc1
  s_waitcnt vmcnt(24)
  v_mfma_f32_16x16x32_bf16 v[48:51], v[168:171], v[16:19], v[48:51]
  v_add_f32 v190, 1.0, v190
  v_add_f32 v191, 1.0, v191
  v_mfma_f32_16x16x32_bf16 v[52:55], v[168:171], v[20:23], v[52:55]
  v_rcp_f32 v188, v188
  s_mov_b32 s49, 462848
  buffer_load_dwordx4 v[252:255], v1, s[4:7], s49 offen sc1
  v_mfma_f32_16x16x32_bf16 v[56:59], v[168:171], v[24:27], v[56:59]
  v_rcp_f32 v189, v189
  v_mfma_f32_16x16x32_bf16 v[60:63], v[168:171], v[28:31], v[60:63]
  buffer_load_dwordx4 v[168:171], v1, s[4:7], s23 offen offset:2048 sc1
  s_add_u32 s23, s23, 0xc00
  s_waitcnt vmcnt(24)
  v_mfma_f32_16x16x32_bf16 v[76:79], v[172:175], v[28:31], v[76:79]
  v_mfma_f32_16x16x32_bf16 v[72:75], v[172:175], v[24:27], v[72:75]
  v_rcp_f32 v190, v190
  v_mfma_f32_16x16x32_bf16 v[68:71], v[172:175], v[20:23], v[68:71]
  v_rcp_f32 v191, v191
  v_mfma_f32_16x16x32_bf16 v[64:67], v[172:175], v[16:19], v[64:67]
  buffer_load_dwordx4 v[172:175], v1, s[4:7], s23 offen sc1
  s_waitcnt vmcnt(24)
  v_mfma_f32_16x16x32_bf16 v[48:51], v[176:179], v[32:35], v[48:51]
  v_mul_f32 v92, v92, v188
  v_mul_f32 v93, v93, v189
  v_mfma_f32_16x16x32_bf16 v[52:55], v[176:179], v[36:39], v[52:55]
  v_mul_f32 v94, v94, v190
  v_mul_f32 v95, v95, v191
  v_mfma_f32_16x16x32_bf16 v[56:59], v[176:179], v[40:43], v[56:59]
  v_cvt_pk_bf16_f32 v198, v92, v93
  v_cvt_pk_bf16_f32 v199, v94, v95
  v_mfma_f32_16x16x32_bf16 v[60:63], v[176:179], v[44:47], v[60:63]
  buffer_load_dwordx4 v[176:179], v1, s[4:7], s23 offen offset:1024 sc1
  s_waitcnt vmcnt(24)
  v_mfma_f32_16x16x32_bf16 v[76:79], v[180:183], v[44:47], v[76:79]
  ds_write_b64 v6, v[198:199] offset:3072
  v_mfma_f32_16x16x32_bf16 v[72:75], v[180:183], v[40:43], v[72:75]
  v_add_u32 v6, 0x2000, v6
  v_mfma_f32_16x16x32_bf16 v[68:71], v[180:183], v[36:39], v[68:71]
  v_mfma_f32_16x16x32_bf16 v[64:67], v[180:183], v[32:35], v[64:67]
  buffer_load_dwordx4 v[180:183], v1, s[4:7], s23 offen offset:2048 sc1
  s_add_u32 s23, s23, 0xc00
  s_waitcnt lgkmcnt(0)
  s_waitcnt vmcnt(17)
  v_mfma_f32_16x16x32_bf16 v[80:83], v[112:115], a[0:3], 0
  v_mfma_f32_16x16x32_bf16 v[84:87], v[112:115], a[4:7], 0
  v_mfma_f32_16x16x32_bf16 v[88:91], v[112:115], a[8:11], 0
  v_mfma_f32_16x16x32_bf16 v[92:95], v[112:115], a[12:15], 0
  buffer_load_dwordx4 v[112:115], v1, s[4:7], s23 offen sc1
  s_waitcnt vmcnt(17)
  v_mfma_f32_16x16x32_bf16 v[80:83], v[116:119], a[16:19], v[80:83]
  v_mul_f32 v184, v48, v48
  v_mul_f32 v185, v49, v49
  v_mul_f32 v186, v50, v50
  v_mul_f32 v187, v51, v51
  v_fmaak_f32 v184, v184, v4, 0xc0135761
  v_mfma_f32_16x16x32_bf16 v[84:87], v[116:119], a[20:23], v[84:87]
  v_fmaak_f32 v185, v185, v4, 0xc0135761
  v_fmaak_f32 v186, v186, v4, 0xc0135761
  v_fmaak_f32 v187, v187, v4, 0xc0135761
  v_mul_f32 v184, v184, v48
  v_mul_f32 v185, v185, v49
  v_mfma_f32_16x16x32_bf16 v[88:91], v[116:119], a[24:27], v[88:91]
  v_mul_f32 v186, v186, v50
  v_mul_f32 v187, v187, v51
  v_exp_f32 v184, v184
  v_mul_f32 v48, v48, v64
  v_mfma_f32_16x16x32_bf16 v[92:95], v[116:119], a[28:31], v[92:95]
  buffer_load_dwordx4 v[116:119], v1, s[4:7], s23 offen offset:1024 sc1
  v_exp_f32 v185, v185
  v_mul_f32 v49, v49, v65
  s_waitcnt vmcnt(17)
  v_mfma_f32_16x16x32_bf16 v[80:83], v[120:123], a[32:35], v[80:83]
  v_exp_f32 v186, v186
  v_mul_f32 v50, v50, v66
  v_exp_f32 v187, v187
  v_mfma_f32_16x16x32_bf16 v[84:87], v[120:123], a[36:39], v[84:87]
  v_mul_f32 v51, v51, v67
  v_add_f32 v184, 1.0, v184
  v_add_f32 v185, 1.0, v185
  v_add_f32 v186, 1.0, v186
  v_add_f32 v187, 1.0, v187
  v_mfma_f32_16x16x32_bf16 v[88:91], v[120:123], a[40:43], v[88:91]
  v_rcp_f32 v184, v184
  v_rcp_f32 v185, v185
  v_mfma_f32_16x16x32_bf16 v[92:95], v[120:123], a[44:47], v[92:95]
  s_cmp_lg_u32 s3, 0
  s_cbranch_scc1 res_sk0
  s_add_u32 m0, s50, 2048
  s_nop 0
  buffer_load_dwordx4 v1, s[4:7], s23 offen offset:2048 sc1 lds
res_sk0:
  s_add_u32 s23, s23, 0xc00
  v_rcp_f32 v186, v186
  v_rcp_f32 v187, v187
  s_waitcnt vmcnt(16)
  v_mfma_f32_16x16x32_bf16 v[80:83], v[124:127], a[48:51], v[80:83]
  v_mul_f32 v48, v48, v184
  v_mul_f32 v49, v49, v185
  v_mul_f32 v50, v50, v186
  v_mul_f32 v51, v51, v187
  v_mfma_f32_16x16x32_bf16 v[84:87], v[124:127], a[52:55], v[84:87]
  v_cvt_pk_bf16_f32 v192, v48, v49
  v_cvt_pk_bf16_f32 v193, v50, v51
  ds_write_b64 v6, v[192:193] offset:0
  v_mul_f32 v188, v52, v52
  v_mfma_f32_16x16x32_bf16 v[88:91], v[124:127], a[56:59], v[88:91]
  v_mul_f32 v189, v53, v53
  v_mul_f32 v190, v54, v54
  v_mul_f32 v191, v55, v55
  v_fmaak_f32 v188, v188, v4, 0xc0135761
  v_fmaak_f32 v189, v189, v4, 0xc0135761
  v_mfma_f32_16x16x32_bf16 v[92:95], v[124:127], a[60:63], v[92:95]
  buffer_load_dwordx4 v[124:127], v1, s[4:7], s23 offen sc1
  v_fmaak_f32 v190, v190, v4, 0xc0135761
  v_fmaak_f32 v191, v191, v4, 0xc0135761
  v_mul_f32 v188, v188, v52
  s_waitcnt vmcnt(16)
  v_mfma_f32_16x16x32_bf16 v[80:83], v[128:131], a[64:67], v[80:83]
  v_mul_f32 v189, v189, v53
  v_mul_f32 v190, v190, v54
  v_mul_f32 v191, v191, v55
  v_exp_f32 v188, v188
  v_mfma_f32_16x16x32_bf16 v[84:87], v[128:131], a[68:71], v[84:87]
  v_mul_f32 v52, v52, v68
  v_exp_f32 v189, v189
  v_mul_f32 v53, v53, v69
  v_mfma_f32_16x16x32_bf16 v[88:91], v[128:131], a[72:75], v[88:91]
  v_exp_f32 v190, v190
  v_mul_f32 v54, v54, v70
  v_exp_f32 v191, v191
  v_mul_f32 v55, v55, v71
  v_mfma_f32_16x16x32_bf16 v[92:95], v[128:131], a[76:79], v[92:95]
  buffer_load_dwordx4 v[128:131], v1, s[4:7], s23 offen offset:1024 sc1
  v_add_f32 v188, 1.0, v188
  v_add_f32 v189, 1.0, v189
  s_waitcnt vmcnt(16)
  v_mfma_f32_16x16x32_bf16 v[80:83], v[132:135], a[80:83], v[80:83]
  v_add_f32 v190, 1.0, v190
  v_add_f32 v191, 1.0, v191
  v_rcp_f32 v188, v188
  v_rcp_f32 v189, v189
  v_mfma_f32_16x16x32_bf16 v[84:87], v[132:135], a[84:87], v[84:87]
  v_rcp_f32 v190, v190
  v_rcp_f32 v191, v191
  v_mfma_f32_16x16x32_bf16 v[88:91], v[132:135], a[88:91], v[88:91]
  v_mul_f32 v52, v52, v188
  v_mul_f32 v53, v53, v189
  v_mul_f32 v54, v54, v190
  v_mul_f32 v55, v55, v191
  v_cvt_pk_bf16_f32 v194, v52, v53
  v_mfma_f32_16x16x32_bf16 v[92:95], v[132:135], a[92:95], v[92:95]
  buffer_load_dwordx4 v[132:135], v1, s[4:7], s23 offen offset:2048 sc1
  s_add_u32 s23, s23, 0xc00
  v_cvt_pk_bf16_f32 v195, v54, v55
  ds_write_b64 v6, v[194:195] offset:1024
  s_waitcnt vmcnt(16)
  v_mfma_f32_16x16x32_bf16 v[80:83], v[136:139], a[96:99], v[80:83]
  v_mul_f32 v184, v56, v56
  v_mul_f32 v185, v57, v57
  v_mul_f32 v186, v58, v58
  v_mul_f32 v187, v59, v59
  v_fmaak_f32 v184, v184, v4, 0xc0135761
  v_mfma_f32_16x16x32_bf16 v[84:87], v[136:139], a[100:103], v[84:87]
  v_fmaak_f32 v185, v185, v4, 0xc0135761
  v_fmaak_f32 v186, v186, v4, 0xc0135761
  v_fmaak_f32 v187, v187, v4, 0xc0135761
  v_mul_f32 v184, v184, v56
  v_mul_f32 v185, v185, v57
  v_mfma_f32_16x16x32_bf16 v[88:91], v[136:139], a[104:107], v[88:91]
  v_mul_f32 v186, v186, v58
  v_mul_f32 v187, v187, v59
  v_exp_f32 v184, v184
  v_mul_f32 v56, v56, v72
  v_mfma_f32_16x16x32_bf16 v[92:95], v[136:139], a[108:111], v[92:95]
  v_exp_f32 v185, v185
  v_mul_f32 v57, v57, v73
  s_waitcnt vmcnt(15)
  v_mfma_f32_16x16x32_bf16 v[80:83], v[140:143], a[112:115], v[80:83]
  v_exp_f32 v186, v186
  v_mul_f32 v58, v58, v74
  v_exp_f32 v187, v187
  v_mfma_f32_16x16x32_bf16 v[84:87], v[140:143], a[116:119], v[84:87]
  v_mul_f32 v59, v59, v75
  v_add_f32 v184, 1.0, v184
  v_add_f32 v185, 1.0, v185
  v_add_f32 v186, 1.0, v186
  v_add_f32 v187, 1.0, v187
  v_mfma_f32_16x16x32_bf16 v[88:91], v[140:143], a[120:123], v[88:91]
  v_rcp_f32 v184, v184
  v_rcp_f32 v185, v185
  v_mfma_f32_16x16x32_bf16 v[92:95], v[140:143], a[124:127], v[92:95]
  buffer_load_dwordx4 v[140:143], v1, s[4:7], s23 offen offset:1024 sc1
  v_rcp_f32 v186, v186
  v_rcp_f32 v187, v187
  s_waitcnt vmcnt(15)
  v_mfma_f32_16x16x32_bf16 v[80:83], v[144:147], a[128:131], v[80:83]
  v_mul_f32 v56, v56, v184
  v_mul_f32 v57, v57, v185
  v_mul_f32 v58, v58, v186
  v_mul_f32 v59, v59, v187
  v_mfma_f32_16x16x32_bf16 v[84:87], v[144:147], a[132:135], v[84:87]
  v_cvt_pk_bf16_f32 v196, v56, v57
  v_cvt_pk_bf16_f32 v197, v58, v59
  ds_write_b64 v6, v[196:197] offset:2048
  v_mul_f32 v188, v60, v60
  v_mfma_f32_16x16x32_bf16 v[88:91], v[144:147], a[136:139], v[88:91]
  v_mul_f32 v189, v61, v61
  v_mul_f32 v190, v62, v62
  v_mul_f32 v191, v63, v63
  v_fmaak_f32 v188, v188, v4, 0xc0135761
  v_fmaak_f32 v189, v189, v4, 0xc0135761
  v_mfma_f32_16x16x32_bf16 v[92:95], v[144:147], a[140:143], v[92:95]
  buffer_load_dwordx4 v[144:147], v1, s[4:7], s23 offen offset:2048 sc1
  s_add_u32 s23, s23, 0xc00
  v_fmaak_f32 v190, v190, v4, 0xc0135761
  v_fmaak_f32 v191, v191, v4, 0xc0135761
  v_mul_f32 v188, v188, v60
  s_waitcnt vmcnt(15)
  v_mfma_f32_16x16x32_bf16 v[80:83], v[148:151], a[144:147], v[80:83]
  v_mul_f32 v189, v189, v61
  v_mul_f32 v190, v190, v62
  v_mul_f32 v191, v191, v63
  v_exp_f32 v188, v188
  v_mfma_f32_16x16x32_bf16 v[84:87], v[148:151], a[148:151], v[84:87]
  v_mul_f32 v60, v60, v76
  v_exp_f32 v189, v189
  v_mul_f32 v61, v61, v77
  v_mfma_f32_16x16x32_bf16 v[88:91], v[148:151], a[152:155], v[88:91]
  v_exp_f32 v190, v190
  v_mul_f32 v62, v62, v78
  v_exp_f32 v191, v191
  v_mul_f32 v63, v63, v79
  v_mfma_f32_16x16x32_bf16 v[92:95], v[148:151], a[156:159], v[92:95]
  buffer_load_dwordx4 v[148:151], v1, s[4:7], s23 offen sc1
  v_add_f32 v188, 1.0, v188
  v_add_f32 v189, 1.0, v189
  s_waitcnt vmcnt(15)
  v_mfma_f32_16x16x32_bf16 v[80:83], v[152:155], a[160:163], v[80:83]
  v_add_f32 v190, 1.0, v190
  v_add_f32 v191, 1.0, v191
  v_rcp_f32 v188, v188
  v_rcp_f32 v189, v189
  v_mfma_f32_16x16x32_bf16 v[84:87], v[152:155], a[164:167], v[84:87]
  v_rcp_f32 v190, v190
  v_rcp_f32 v191, v191
  v_mfma_f32_16x16x32_bf16 v[88:91], v[152:155], a[168:171], v[88:91]
  v_mul_f32 v60, v60, v188
  v_mul_f32 v61, v61, v189
  v_mul_f32 v62, v62, v190
  v_mul_f32 v63, v63, v191
  v_cvt_pk_bf16_f32 v198, v60, v61
  v_mfma_f32_16x16x32_bf16 v[92:95], v[152:155], a[172:175], v[92:95]
  s_cmp_lg_u32 s3, 0
  s_cbranch_scc1 res_sk1
  s_add_u32 m0, s50, 4096
  s_nop 0
  buffer_load_dwordx4 v1, s[4:7], s23 offen offset:1024 sc1 lds
res_sk1:
  v_cvt_pk_bf16_f32 v199, v62, v63
  ds_write_b64 v6, v[198:199] offset:3072
  s_waitcnt vmcnt(14)
  v_mfma_f32_16x16x32_bf16 v[80:83], v[156:159], a[176:179], v[80:83]
  s_waitcnt lgkmcnt(0)
  s_barrier
  v_mfma_f32_16x16x32_bf16 v[84:87], v[156:159], a[180:183], v[84:87]
  ds_read_b128 a[224:227], v3 offset:20480
  ds_read_b128 a[228:231], v3 offset:21504
  v_mfma_f32_16x16x32_bf16 v[88:91], v[156:159], a[184:187], v[88:91]
  ds_read_b128 a[232:235], v3 offset:22528
  ds_read_b128 a[236:239], v3 offset:23552
  v_mfma_f32_16x16x32_bf16 v[92:95], v[156:159], a[188:191], v[92:95]
  buffer_load_dwordx4 v[156:159], v1, s[4:7], s23 offen offset:2048 sc1
  s_add_u32 s23, s23, 0xc00
  ds_read_b128 a[240:243], v3 offset:24576
  ds_read_b128 a[244:247], v3 offset:25600
  s_waitcnt vmcnt(14)
  v_mfma_f32_16x16x32_bf16 v[80:83], v[160:163], a[192:195], v[80:83]
  ds_read_b128 a[248:251], v3 offset:26624
  ds_read_b128 a[252:255], v3 offset:27648
  v_mfma_f32_16x16x32_bf16 v[84:87], v[160:163], a[196:199], v[84:87]
  ds_read_b128 v[16:19], v3 offset:28672
  ds_read_b128 v[20:23], v3 offset:29696
  v_mfma_f32_16x16x32_bf16 v[88:91], v[160:163], a[200:203], v[88:91]
  ds_read_b128 v[24:27], v3 offset:30720
  ds_read_b128 v[28:31], v3 offset:31744
  v_mfma_f32_16x16x32_bf16 v[92:95], v[160:163], a[204:207], v[92:95]
  buffer_load_dwordx4 v[160:163], v1, s[4:7], s23 offen sc1
  ds_read_b128 v[32:35], v3 offset:32768
  ds_read_b128 v[36:39], v3 offset:33792
  s_waitcnt vmcnt(14)
  v_mfma_f32_16x16x32_bf16 v[80:83], v[164:167], a[208:211], v[80:83]
  ds_read_b128 v[40:43], v3 offset:34816
  ds_read_b128 v[44:47], v3 offset:35840
  v_mfma_f32_16x16x32_bf16 v[84:87], v[164:167], a[212:215], v[84:87]
  v_mfma_f32_16x16x32_bf16 v[88:91], v[164:167], a[216:219], v[88:91]
  v_mfma_f32_16x16x32_bf16 v[92:95], v[164:167], a[220:223], v[92:95]
  buffer_load_dwordx4 v[164:167], v1, s[4:7], s23 offen offset:1024 sc1
  s_waitcnt lgkmcnt(0)
  s_waitcnt vmcnt(14)
  v_mfma_f32_16x16x32_bf16 v[80:83], v[168:171], a[224:227], v[80:83]
  v_mfma_f32_16x16x32_bf16 v[84:87], v[168:171], a[228:231], v[84:87]
  v_mfma_f32_16x16x32_bf16 v[88:91], v[168:171], a[232:235], v[88:91]
  v_mfma_f32_16x16x32_bf16 v[92:95], v[168:171], a[236:239], v[92:95]
  s_add_u32 s23, s23, 0xc00
  s_waitcnt vmcnt(13)
  v_mfma_f32_16x16x32_bf16 v[80:83], v[172:175], a[240:243], v[80:83]
  v_mfma_f32_16x16x32_bf16 v[84:87], v[172:175], a[244:247], v[84:87]
  v_mfma_f32_16x16x32_bf16 v[88:91], v[172:175], a[248:251], v[88:91]
  v_mfma_f32_16x16x32_bf16 v[92:95], v[172:175], a[252:255], v[92:95]
  buffer_load_dwordx4 v[172:175], v1, s[4:7], s23 offen sc1
  s_waitcnt vmcnt(13)
  v_mfma_f32_16x16x32_bf16 v[80:83], v[176:179], v[16:19], v[80:83]
  v_mfma_f32_16x16x32_bf16 v[84:87], v[176:179], v[20:23], v[84:87]
  v_mfma_f32_16x16x32_bf16 v[88:91], v[176:179], v[24:27], v[88:91]
  v_mfma_f32_16x16x32_bf16 v[92:95], v[176:179], v[28:31], v[92:95]
  buffer_load_dwordx4 v[176:179], v1, s[4:7], s23 offen offset:1024 sc1
  s_waitcnt vmcnt(13)
  v_mfma_f32_16x16x32_bf16 v[80:83], v[180:183], v[32:35], v[80:83]
  v_mfma_f32_16x16x32_bf16 v[84:87], v[180:183], v[36:39], v[84:87]
  s_waitcnt vmcnt(11)
  ds_read_b128 v[120:123], v5 offset:0
  v_mfma_f32_16x16x32_bf16 v[88:91], v[180:183], v[40:43], v[88:91]
  v_mfma_f32_16x16x32_bf16 v[92:95], v[180:183], v[44:47], v[92:95]
  buffer_load_dwordx4 v[180:183], v1, s[4:7], s23 offen offset:2048 sc1
  s_add_u32 s23, s23, 0xc00
  s_waitcnt vmcnt(13)
  v_mfma_f32_16x16x32_bf16 v[96:99], v[112:115], a[0:3], 0
  v_mfma_f32_16x16x32_bf16 v[100:103], v[112:115], a[4:7], 0
  v_mfma_f32_16x16x32_bf16 v[104:107], v[112:115], a[8:11], 0
  v_mfma_f32_16x16x32_bf16 v[108:111], v[112:115], a[12:15], 0
  s_cmp_lg_u32 s3, 0
  s_cbranch_scc1 res_sk2
  s_add_u32 m0, s50, 6144
  s_nop 0
  buffer_load_dwordx4 v1, s[4:7], s23 offen sc1 lds
res_sk2:
  s_waitcnt vmcnt(12)
  v_mfma_f32_16x16x32_bf16 v[96:99], v[116:119], a[16:19], v[96:99]
  v_cvt_pk_bf16_f32 v192, v80, v81
  v_cvt_pk_bf16_f32 v193, v82, v83
  v_mfma_f32_16x16x32_bf16 v[100:103], v[116:119], a[20:23], v[100:103]
  v_cvt_pk_bf16_f32 v194, v84, v85
  v_mfma_f32_16x16x32_bf16 v[104:107], v[116:119], a[24:27], v[104:107]
  v_cvt_pk_bf16_f32 v195, v86, v87
  v_cvt_pk_bf16_f32 v196, v88, v89
  v_mfma_f32_16x16x32_bf16 v[108:111], v[116:119], a[28:31], v[108:111]
  buffer_load_dwordx4 v[116:119], v1, s[4:7], s23 offen offset:1024 sc1
  s_waitcnt lgkmcnt(0)
  v_mfma_f32_16x16x32_bf16 v[96:99], v[120:123], a[32:35], v[96:99]
  v_cvt_pk_bf16_f32 v197, v90, v91
  v_mfma_f32_16x16x32_bf16 v[100:103], v[120:123], a[36:39], v[100:103]
  v_cvt_pk_bf16_f32 v198, v92, v93
  v_cvt_pk_bf16_f32 v199, v94, v95
  v_mfma_f32_16x16x32_bf16 v[104:107], v[120:123], a[40:43], v[104:107]
  v_mfma_f32_16x16x32_bf16 v[108:111], v[120:123], a[44:47], v[108:111]
  buffer_load_dwordx4 v[120:123], v1, s[4:7], s23 offen offset:2048 sc1
  s_add_u32 s23, s23, 0xc00
  s_waitcnt vmcnt(13)
  v_mfma_f32_16x16x32_bf16 v[96:99], v[124:127], a[48:51], v[96:99]
  v_permlane16_swap_b32 v192, v194
  v_mfma_f32_16x16x32_bf16 v[100:103], v[124:127], a[52:55], v[100:103]
  v_permlane16_swap_b32 v193, v195
  v_permlane16_swap_b32 v196, v198
  v_mfma_f32_16x16x32_bf16 v[104:107], v[124:127], a[56:59], v[104:107]
  v_permlane16_swap_b32 v197, v199
  v_mfma_f32_16x16x32_bf16 v[108:111], v[124:127], a[60:63], v[108:111]
  buffer_load_dwordx4 v[124:127], v1, s[4:7], s23 offen sc1
  s_waitcnt vmcnt(13)
  v_mfma_f32_16x16x32_bf16 v[96:99], v[128:131], a[64:67], v[96:99]
  v_mfma_f32_16x16x32_bf16 v[100:103], v[128:131], a[68:71], v[100:103]
  buffer_store_dwordx4 v[192:195], v7, s[16:19], s27 offen sc1
  v_mfma_f32_16x16x32_bf16 v[104:107], v[128:131], a[72:75], v[104:107]
  v_mfma_f32_16x16x32_bf16 v[108:111], v[128:131], a[76:79], v[108:111]
  s_waitcnt vmcnt(13)
  v_mfma_f32_16x16x32_bf16 v[96:99], v[132:135], a[80:83], v[96:99]
  v_mfma_f32_16x16x32_bf16 v[100:103], v[132:135], a[84:87], v[100:103]
  v_mfma_f32_16x16x32_bf16 v[104:107], v[132:135], a[88:91], v[104:107]
  v_mfma_f32_16x16x32_bf16 v[108:111], v[132:135], a[92:95], v[108:111]
  buffer_load_dwordx4 v[132:135], v1, s[4:7], s23 offen offset:2048 sc1
  s_add_u32 s23, s23, 0xc00
  v_mfma_f32_16x16x32_bf16 v[96:99], v[200:203], a[96:99], v[96:99]
  v_mfma_f32_16x16x32_bf16 v[100:103], v[200:203], a[100:103], v[100:103]
  v_mfma_f32_16x16x32_bf16 v[104:107], v[200:203], a[104:107], v[104:107]
  v_mfma_f32_16x16x32_bf16 v[108:111], v[200:203], a[108:111], v[108:111]
  buffer_load_dwordx4 v[136:139], v1, s[4:7], s23 offen sc1
  s_waitcnt vmcnt(14)
  v_mfma_f32_16x16x32_bf16 v[96:99], v[140:143], a[112:115], v[96:99]
  v_mfma_f32_16x16x32_bf16 v[100:103], v[140:143], a[116:119], v[100:103]
  s_waitcnt vmcnt(12)
  ds_read_b128 v[152:155], v5 offset:1024
  v_mfma_f32_16x16x32_bf16 v[104:107], v[140:143], a[120:123], v[104:107]
  v_mfma_f32_16x16x32_bf16 v[108:111], v[140:143], a[124:127], v[108:111]
  buffer_load_dwordx4 v[140:143], v1, s[4:7], s23 offen offset:1024 sc1
  s_waitcnt vmcnt(14)
  v_mfma_f32_16x16x32_bf16 v[96:99], v[144:147], a[128:131], v[96:99]
  v_mfma_f32_16x16x32_bf16 v[100:103], v[144:147], a[132:135], v[100:103]
  v_mfma_f32_16x16x32_bf16 v[104:107], v[144:147], a[136:139], v[104:107]
  v_mfma_f32_16x16x32_bf16 v[108:111], v[144:147], a[140:143], v[108:111]
  s_cmp_lg_u32 s3, 0
  s_cbranch_scc1 res_sk3
  s_add_u32 m0, s50, 5120
  s_nop 0
  buffer_load_dwordx4 v1, s[4:7], s23 offen offset:2048 sc1 lds
res_sk3:
  s_add_u32 s23, s23, 0xc00
  s_waitcnt vmcnt(13)
  v_mfma_f32_16x16x32_bf16 v[96:99], v[148:151], a[144:147], v[96:99]
  v_mfma_f32_16x16x32_bf16 v[100:103], v[148:151], a[148:151], v[100:103]
  v_mfma_f32_16x16x32_bf16 v[104:107], v[148:151], a[152:155], v[104:107]
  v_mfma_f32_16x16x32_bf16 v[108:111], v[148:151], a[156:159], v[108:111]
  buffer_load_dwordx4 v[148:151], v1, s[4:7], s23 offen sc1
  s_waitcnt lgkmcnt(0)
  v_mfma_f32_16x16x32_bf16 v[96:99], v[152:155], a[160:163], v[96:99]
  v_mfma_f32_16x16x32_bf16 v[100:103], v[152:155], a[164:167], v[100:103]
  buffer_store_dwordx4 v[196:199], v7, s[16:19], s27 offen offset:512 sc1
  s_add_u32 s27, s27, 0x2000
  v_mfma_f32_16x16x32_bf16 v[104:107], v[152:155], a[168:171], v[104:107]
  v_mfma_f32_16x16x32_bf16 v[108:111], v[152:155], a[172:175], v[108:111]
  buffer_load_dwordx4 v[152:155], v1, s[4:7], s23 offen offset:1024 sc1
  s_waitcnt vmcnt(15)
  v_mfma_f32_16x16x32_bf16 v[96:99], v[156:159], a[176:179], v[96:99]
  v_mfma_f32_16x16x32_bf16 v[100:103], v[156:159], a[180:183], v[100:103]
  v_mfma_f32_16x16x32_bf16 v[104:107], v[156:159], a[184:187], v[104:107]
  v_mfma_f32_16x16x32_bf16 v[108:111], v[156:159], a[188:191], v[108:111]
  buffer_load_dwordx4 v[156:159], v1, s[4:7], s23 offen offset:2048 sc1
  s_add_u32 s23, s23, 0xc00
  s_waitcnt vmcnt(15)
  v_mfma_f32_16x16x32_bf16 v[96:99], v[160:163], a[192:195], v[96:99]
  v_mfma_f32_16x16x32_bf16 v[100:103], v[160:163], a[196:199], v[100:103]
  v_mfma_f32_16x16x32_bf16 v[104:107], v[160:163], a[200:203], v[104:107]
  v_mfma_f32_16x16x32_bf16 v[108:111], v[160:163], a[204:207], v[108:111]
  s_waitcnt vmcnt(14)
  v_mfma_f32_16x16x32_bf16 v[96:99], v[164:167], a[208:211], v[96:99]
  v_mfma_f32_16x16x32_bf16 v[100:103], v[164:167], a[212:215], v[100:103]
  v_mfma_f32_16x16x32_bf16 v[104:107], v[164:167], a[216:219], v[104:107]
  v_mfma_f32_16x16x32_bf16 v[108:111], v[164:167], a[220:223], v[108:111]
  buffer_load_dwordx4 v[164:167], v1, s[4:7], s23 offen offset:1024 sc1
  v_mfma_f32_16x16x32_bf16 v[96:99], v[204:207], a[224:227], v[96:99]
  v_mfma_f32_16x16x32_bf16 v[100:103], v[204:207], a[228:231], v[100:103]
  v_mfma_f32_16x16x32_bf16 v[104:107], v[204:207], a[232:235], v[104:107]
  v_mfma_f32_16x16x32_bf16 v[108:111], v[204:207], a[236:239], v[108:111]
  buffer_load_dwordx4 v[168:171], v1, s[4:7], s23 offen offset:2048 sc1
  s_add_u32 s23, s23, 0xc00
  s_waitcnt vmcnt(15)
  v_mfma_f32_16x16x32_bf16 v[96:99], v[172:175], a[240:243], v[96:99]
  v_mfma_f32_16x16x32_bf16 v[100:103], v[172:175], a[244:247], v[100:103]
  s_waitcnt vmcnt(13)
  ds_read_b128 v[112:115], v5 offset:2048
  v_mfma_f32_16x16x32_bf16 v[104:107], v[172:175], a[248:251], v[104:107]
  v_mfma_f32_16x16x32_bf16 v[108:111], v[172:175], a[252:255], v[108:111]
  buffer_load_dwordx4 v[172:175], v1, s[4:7], s23 offen sc1
  s_waitcnt vmcnt(15)
  v_mfma_f32_16x16x32_bf16 v[96:99], v[176:179], v[16:19], v[96:99]
  v_mfma_f32_16x16x32_bf16 v[100:103], v[176:179], v[20:23], v[100:103]
  v_mfma_f32_16x16x32_bf16 v[104:107], v[176:179], v[24:27], v[104:107]
  v_mfma_f32_16x16x32_bf16 v[108:111], v[176:179], v[28:31], v[108:111]
  s_cmp_lg_u32 s3, 0
  s_cbranch_scc1 res_sk4
  s_add_u32 m0, s50, 7168
  s_nop 0
  buffer_load_dwordx4 v1, s[4:7], s23 offen offset:1024 sc1 lds
res_sk4:
  s_waitcnt vmcnt(14)
  v_mfma_f32_16x16x32_bf16 v[96:99], v[180:183], v[32:35], v[96:99]
  v_mfma_f32_16x16x32_bf16 v[100:103], v[180:183], v[36:39], v[100:103]
  v_mfma_f32_16x16x32_bf16 v[104:107], v[180:183], v[40:43], v[104:107]
  v_mfma_f32_16x16x32_bf16 v[108:111], v[180:183], v[44:47], v[108:111]
  buffer_load_dwordx4 v[180:183], v1, s[4:7], s23 offen offset:2048 sc1
  s_add_u32 s23, s23, 0xc00
  s_waitcnt lgkmcnt(0)
  v_mfma_f32_16x16x32_bf16 v[80:83], v[112:115], a[0:3], 0
  v_mfma_f32_16x16x32_bf16 v[84:87], v[112:115], a[4:7], 0
  v_mfma_f32_16x16x32_bf16 v[88:91], v[112:115], a[8:11], 0
  v_mfma_f32_16x16x32_bf16 v[92:95], v[112:115], a[12:15], 0
  buffer_load_dwordx4 v[112:115], v1, s[4:7], s23 offen sc1
  s_waitcnt vmcnt(15)
  v_mfma_f32_16x16x32_bf16 v[80:83], v[116:119], a[16:19], v[80:83]
  v_cvt_pk_bf16_f32 v192, v96, v97
  v_cvt_pk_bf16_f32 v193, v98, v99
  v_mfma_f32_16x16x32_bf16 v[84:87], v[116:119], a[20:23], v[84:87]
  v_cvt_pk_bf16_f32 v194, v100, v101
  v_mfma_f32_16x16x32_bf16 v[88:91], v[116:119], a[24:27], v[88:91]
  v_cvt_pk_bf16_f32 v195, v102, v103
  v_cvt_pk_bf16_f32 v196, v104, v105
  v_mfma_f32_16x16x32_bf16 v[92:95], v[116:119], a[28:31], v[92:95]
  buffer_load_dwordx4 v[116:119], v1, s[4:7], s23 offen offset:1024 sc1
  s_waitcnt vmcnt(15)
  v_mfma_f32_16x16x32_bf16 v[80:83], v[120:123], a[32:35], v[80:83]
  v_cvt_pk_bf16_f32 v197, v106, v107
  v_mfma_f32_16x16x32_bf16 v[84:87], v[120:123], a[36:39], v[84:87]
  v_cvt_pk_bf16_f32 v198, v108, v109
  v_cvt_pk_bf16_f32 v199, v110, v111
  v_mfma_f32_16x16x32_bf16 v[88:91], v[120:123], a[40:43], v[88:91]
  v_mfma_f32_16x16x32_bf16 v[92:95], v[120:123], a[44:47], v[92:95]
  s_add_u32 s23, s23, 0xc00
  s_waitcnt vmcnt(14)
  v_mfma_f32_16x16x32_bf16 v[80:83], v[124:127], a[48:51], v[80:83]
  v_permlane16_swap_b32 v192, v194
  v_mfma_f32_16x16x32_bf16 v[84:87], v[124:127], a[52:55], v[84:87]
  v_permlane16_swap_b32 v193, v195
  v_permlane16_swap_b32 v196, v198
  v_mfma_f32_16x16x32_bf16 v[88:91], v[124:127], a[56:59], v[88:91]
  v_permlane16_swap_b32 v197, v199
  v_mfma_f32_16x16x32_bf16 v[92:95], v[124:127], a[60:63], v[92:95]
  buffer_load_dwordx4 v[124:127], v1, s[4:7], s23 offen sc1
  v_mfma_f32_16x16x32_bf16 v[80:83], v[208:211], a[64:67], v[80:83]
  v_mfma_f32_16x16x32_bf16 v[84:87], v[208:211], a[68:71], v[84:87]
  buffer_store_dwordx4 v[192:195], v7, s[16:19], s27 offen sc1
  v_mfma_f32_16x16x32_bf16 v[88:91], v[208:211], a[72:75], v[88:91]
  v_mfma_f32_16x16x32_bf16 v[92:95], v[208:211], a[76:79], v[92:95]
  buffer_load_dwordx4 v[128:131], v1, s[4:7], s23 offen offset:1024 sc1
  s_waitcnt vmcnt(15)
  v_mfma_f32_16x16x32_bf16 v[80:83], v[132:135], a[80:83], v[80:83]
  v_mfma_f32_16x16x32_bf16 v[84:87], v[132:135], a[84:87], v[84:87]
  s_waitcnt vmcnt(13)
  ds_read_b128 v[144:147], v5 offset:3072
  v_mfma_f32_16x16x32_bf16 v[88:91], v[132:135], a[88:91], v[88:91]
  v_mfma_f32_16x16x32_bf16 v[92:95], v[132:135], a[92:95], v[92:95]
  buffer_load_dwordx4 v[132:135], v1, s[4:7], s23 offen offset:2048 sc1
  s_add_u32 s23, s23, 0xc00
  s_waitcnt vmcnt(15)
  v_mfma_f32_16x16x32_bf16 v[80:83], v[136:139], a[96:99], v[80:83]
  v_mfma_f32_16x16x32_bf16 v[84:87], v[136:139], a[100:103], v[84:87]
  v_mfma_f32_16x16x32_bf16 v[88:91], v[136:139], a[104:107], v[88:91]
  v_mfma_f32_16x16x32_bf16 v[92:95], v[136:139], a[108:111], v[92:95]
  s_cmp_lg_u32 s3, 0
  s_cbranch_scc1 res_sk5
  s_add_u32 m0, s50, 9216
  s_nop 0
  buffer_load_dwordx4 v1, s[4:7], s23 offen sc1 lds
res_sk5:
  s_waitcnt vmcnt(14)
  v_mfma_f32_16x16x32_bf16 v[80:83], v[140:143], a[112:115], v[80:83]
  v_mfma_f32_16x16x32_bf16 v[84:87], v[140:143], a[116:119], v[84:87]
  v_mfma_f32_16x16x32_bf16 v[88:91], v[140:143], a[120:123], v[88:91]
  v_mfma_f32_16x16x32_bf16 v[92:95], v[140:143], a[124:127], v[92:95]
  buffer_load_dwordx4 v[140:143], v1, s[4:7], s23 offen offset:1024 sc1
  s_waitcnt lgkmcnt(0)
  v_mfma_f32_16x16x32_bf16 v[80:83], v[144:147], a[128:131], v[80:83]
  v_mfma_f32_16x16x32_bf16 v[84:87], v[144:147], a[132:135], v[84:87]
  v_mfma_f32_16x16x32_bf16 v[88:91], v[144:147], a[136:139], v[88:91]
  v_mfma_f32_16x16x32_bf16 v[92:95], v[144:147], a[140:143], v[92:95]
  buffer_load_dwordx4 v[144:147], v1, s[4:7], s23 offen offset:2048 sc1
  s_add_u32 s23, s23, 0xc00
  s_waitcnt vmcnt(15)
  v_mfma_f32_16x16x32_bf16 v[80:83], v[148:151], a[144:147], v[80:83]
  v_mfma_f32_16x16x32_bf16 v[84:87], v[148:151], a[148:151], v[84:87]
  v_mfma_f32_16x16x32_bf16 v[88:91], v[148:151], a[152:155], v[88:91]
  v_mfma_f32_16x16x32_bf16 v[92:95], v[148:151], a[156:159], v[92:95]
  buffer_load_dwordx4 v[148:151], v1, s[4:7], s23 offen sc1
  s_waitcnt vmcnt(14)
  v_mfma_f32_16x16x32_bf16 v[80:83], v[152:155], a[160:163], v[80:83]
  v_mfma_f32_16x16x32_bf16 v[84:87], v[152:155], a[164:167], v[84:87]
  buffer_store_dwordx4 v[196:199], v7, s[16:19], s27 offen offset:512 sc1
  s_add_u32 s27, s27, 0x2000
  v_mfma_f32_16x16x32_bf16 v[88:91], v[152:155], a[168:171], v[88:91]
  v_mfma_f32_16x16x32_bf16 v[92:95], v[152:155], a[172:175], v[92:95]
  s_waitcnt vmcnt(14)
  v_mfma_f32_16x16x32_bf16 v[80:83], v[156:159], a[176:179], v[80:83]
  v_mfma_f32_16x16x32_bf16 v[84:87], v[156:159], a[180:183], v[84:87]
  v_mfma_f32_16x16x32_bf16 v[88:91], v[156:159], a[184:187], v[88:91]
  v_mfma_f32_16x16x32_bf16 v[92:95], v[156:159], a[188:191], v[92:95]
  buffer_load_dwordx4 v[156:159], v1, s[4:7], s23 offen offset:2048 sc1
  s_add_u32 s23, s23, 0xc00
  v_mfma_f32_16x16x32_bf16 v[80:83], v[212:215], a[192:195], v[80:83]
  v_mfma_f32_16x16x32_bf16 v[84:87], v[212:215], a[196:199], v[84:87]
  v_mfma_f32_16x16x32_bf16 v[88:91], v[212:215], a[200:203], v[88:91]
  v_mfma_f32_16x16x32_bf16 v[92:95], v[212:215], a[204:207], v[92:95]
  buffer_load_dwordx4 v[160:163], v1, s[4:7], s23 offen sc1
  s_waitcnt vmcnt(15)
  v_mfma_f32_16x16x32_bf16 v[80:83], v[164:167], a[208:211], v[80:83]
  v_mfma_f32_16x16x32_bf16 v[84:87], v[164:167], a[212:215], v[84:87]
  s_waitcnt vmcnt(13)
  ds_read_b128 v[176:179], v5 offset:4096
  v_mfma_f32_16x16x32_bf16 v[88:91], v[164:167], a[216:219], v[88:91]
  v_mfma_f32_16x16x32_bf16 v[92:95], v[164:167], a[220:223], v[92:95]
  buffer_load_dwordx4 v[164:167], v1, s[4:7], s23 offen offset:1024 sc1
  s_waitcnt vmcnt(15)
  v_mfma_f32_16x16x32_bf16 v[80:83], v[168:171], a[224:227], v[80:83]
  v_mfma_f32_16x16x32_bf16 v[84:87], v[168:171], a[228:231], v[84:87]
  v_mfma_f32_16x16x32_bf16 v[88:91], v[168:171], a[232:235], v[88:91]
  v_mfma_f32_16x16x32_bf16 v[92:95], v[168:171], a[236:239], v[92:95]
  s_cmp_lg_u32 s3, 0
  s_cbranch_scc1 res_sk6
  s_add_u32 m0, s50, 8192
  s_nop 0
  buffer_load_dwordx4 v1, s[4:7], s23 offen offset:2048 sc1 lds
res_sk6:
  s_add_u32 s23, s23, 0xc00
  s_waitcnt vmcnt(14)
  v_mfma_f32_16x16x32_bf16 v[80:83], v[172:175], a[240:243], v[80:83]
  v_mfma_f32_16x16x32_bf16 v[84:87], v[172:175], a[244:247], v[84:87]
  v_mfma_f32_16x16x32_bf16 v[88:91], v[172:175], a[248:251], v[88:91]
  v_mfma_f32_16x16x32_bf16 v[92:95], v[172:175], a[252:255], v[92:95]
  buffer_load_dwordx4 v[172:175], v1, s[4:7], s23 offen sc1
  s_waitcnt lgkmcnt(0)
  v_mfma_f32_16x16x32_bf16 v[80:83], v[176:179], v[16:19], v[80:83]
  v_mfma_f32_16x16x32_bf16 v[84:87], v[176:179], v[20:23], v[84:87]
  v_mfma_f32_16x16x32_bf16 v[88:91], v[176:179], v[24:27], v[88:91]
  v_mfma_f32_16x16x32_bf16 v[92:95], v[176:179], v[28:31], v[92:95]
  buffer_load_dwordx4 v[176:179], v1, s[4:7], s23 offen offset:1024 sc1
  s_waitcnt vmcnt(15)
  v_mfma_f32_16x16x32_bf16 v[80:83], v[180:183], v[32:35], v[80:83]
  v_mfma_f32_16x16x32_bf16 v[84:87], v[180:183], v[36:39], v[84:87]
  v_mfma_f32_16x16x32_bf16 v[88:91], v[180:183], v[40:43], v[88:91]
  v_mfma_f32_16x16x32_bf16 v[92:95], v[180:183], v[44:47], v[92:95]
  buffer_load_dwordx4 v[180:183], v1, s[4:7], s23 offen offset:2048 sc1
  s_add_u32 s23, s23, 0xc00
  s_waitcnt vmcnt(15)
  v_mfma_f32_16x16x32_bf16 v[96:99], v[112:115], a[0:3], 0
  v_mfma_f32_16x16x32_bf16 v[100:103], v[112:115], a[4:7], 0
  v_mfma_f32_16x16x32_bf16 v[104:107], v[112:115], a[8:11], 0
  v_mfma_f32_16x16x32_bf16 v[108:111], v[112:115], a[12:15], 0
  s_waitcnt vmcnt(14)
  v_mfma_f32_16x16x32_bf16 v[96:99], v[116:119], a[16:19], v[96:99]
  v_cvt_pk_bf16_f32 v192, v80, v81
  v_cvt_pk_bf16_f32 v193, v82, v83
  v_mfma_f32_16x16x32_bf16 v[100:103], v[116:119], a[20:23], v[100:103]
  v_cvt_pk_bf16_f32 v194, v84, v85
  v_mfma_f32_16x16x32_bf16 v[104:107], v[116:119], a[24:27], v[104:107]
  v_cvt_pk_bf16_f32 v195, v86, v87
  v_cvt_pk_bf16_f32 v196, v88, v89
  v_mfma_f32_16x16x32_bf16 v[108:111], v[116:119], a[28:31], v[108:111]
  buffer_load_dwordx4 v[116:119], v1, s[4:7], s23 offen offset:1024 sc1
  v_mfma_f32_16x16x32_bf16 v[96:99], v[216:219], a[32:35], v[96:99]
  v_cvt_pk_bf16_f32 v197, v90, v91
  v_mfma_f32_16x16x32_bf16 v[100:103], v[216:219], a[36:39], v[100:103]
  v_cvt_pk_bf16_f32 v198, v92, v93
  v_cvt_pk_bf16_f32 v199, v94, v95
  v_mfma_f32_16x16x32_bf16 v[104:107], v[216:219], a[40:43], v[104:107]
  v_mfma_f32_16x16x32_bf16 v[108:111], v[216:219], a[44:47], v[108:111]
  buffer_load_dwordx4 v[120:123], v1, s[4:7], s23 offen offset:2048 sc1
  s_add_u32 s23, s23, 0xc00
  s_waitcnt vmcnt(15)
  v_mfma_f32_16x16x32_bf16 v[96:99], v[124:127], a[48:51], v[96:99]
  v_permlane16_swap_b32 v192, v194
  v_mfma_f32_16x16x32_bf16 v[100:103], v[124:127], a[52:55], v[100:103]
  s_waitcnt vmcnt(12)
  ds_read_b128 v[136:139], v5 offset:5120
  v_permlane16_swap_b32 v193, v195
  v_permlane16_swap_b32 v196, v198
  v_mfma_f32_16x16x32_bf16 v[104:107], v[124:127], a[56:59], v[104:107]
  v_permlane16_swap_b32 v197, v199
  v_mfma_f32_16x16x32_bf16 v[108:111], v[124:127], a[60:63], v[108:111]
  buffer_load_dwordx4 v[124:127], v1, s[4:7], s23 offen sc1
  s_waitcnt vmcnt(14)
  v_mfma_f32_16x16x32_bf16 v[96:99], v[128:131], a[64:67], v[96:99]
  v_mfma_f32_16x16x32_bf16 v[100:103], v[128:131], a[68:71], v[100:103]
  buffer_store_dwordx4 v[192:195], v7, s[16:19], s27 offen sc1
  v_mfma_f32_16x16x32_bf16 v[104:107], v[128:131], a[72:75], v[104:107]
  v_mfma_f32_16x16x32_bf16 v[108:111], v[128:131], a[76:79], v[108:111]
  s_cmp_lg_u32 s3, 0
  s_cbranch_scc1 res_sk7
  s_add_u32 m0, s50, 10240
  s_nop 0
  buffer_load_dwordx4 v1, s[4:7], s23 offen offset:1024 sc1 lds
res_sk7:
  s_waitcnt vmcnt(14)
  v_mfma_f32_16x16x32_bf16 v[96:99], v[132:135], a[80:83], v[96:99]
  v_mfma_f32_16x16x32_bf16 v[100:103], v[132:135], a[84:87], v[100:103]
  v_mfma_f32_16x16x32_bf16 v[104:107], v[132:135], a[88:91], v[104:107]
  v_mfma_f32_16x16x32_bf16 v[108:111], v[132:135], a[92:95], v[108:111]
  buffer_load_dwordx4 v[132:135], v1, s[4:7], s23 offen offset:2048 sc1
  s_add_u32 s23, s23, 0xc00
  s_waitcnt lgkmcnt(0)
  v_mfma_f32_16x16x32_bf16 v[96:99], v[136:139], a[96:99], v[96:99]
  v_mfma_f32_16x16x32_bf16 v[100:103], v[136:139], a[100:103], v[100:103]
  v_mfma_f32_16x16x32_bf16 v[104:107], v[136:139], a[104:107], v[104:107]
  v_mfma_f32_16x16x32_bf16 v[108:111], v[136:139], a[108:111], v[108:111]
  buffer_load_dwordx4 v[136:139], v1, s[4:7], s23 offen sc1
  s_waitcnt vmcnt(15)
  v_mfma_f32_16x16x32_bf16 v[96:99], v[140:143], a[112:115], v[96:99]
  v_mfma_f32_16x16x32_bf16 v[100:103], v[140:143], a[116:119], v[100:103]
  v_mfma_f32_16x16x32_bf16 v[104:107], v[140:143], a[120:123], v[104:107]
  v_mfma_f32_16x16x32_bf16 v[108:111], v[140:143], a[124:127], v[108:111]
  buffer_load_dwordx4 v[140:143], v1, s[4:7], s23 offen offset:1024 sc1
  s_waitcnt vmcnt(15)
  v_mfma_f32_16x16x32_bf16 v[96:99], v[144:147], a[128:131], v[96:99]
  v_mfma_f32_16x16x32_bf16 v[100:103], v[144:147], a[132:135], v[100:103]
  v_mfma_f32_16x16x32_bf16 v[104:107], v[144:147], a[136:139], v[104:107]
  v_mfma_f32_16x16x32_bf16 v[108:111], v[144:147], a[140:143], v[108:111]
  s_add_u32 s23, s23, 0xc00
  s_waitcnt vmcnt(14)
  v_mfma_f32_16x16x32_bf16 v[96:99], v[148:151], a[144:147], v[96:99]
  v_mfma_f32_16x16x32_bf16 v[100:103], v[148:151], a[148:151], v[100:103]
  v_mfma_f32_16x16x32_bf16 v[104:107], v[148:151], a[152:155], v[104:107]
  v_mfma_f32_16x16x32_bf16 v[108:111], v[148:151], a[156:159], v[108:111]
  buffer_load_dwordx4 v[148:151], v1, s[4:7], s23 offen sc1
  v_mfma_f32_16x16x32_bf16 v[96:99], v[220:223], a[160:163], v[96:99]
  v_mfma_f32_16x16x32_bf16 v[100:103], v[220:223], a[164:167], v[100:103]
  buffer_store_dwordx4 v[196:199], v7, s[16:19], s27 offen offset:512 sc1
  s_add_u32 s27, s27, 0x2000
  v_mfma_f32_16x16x32_bf16 v[104:107], v[220:223], a[168:171], v[104:107]
  v_mfma_f32_16x16x32_bf16 v[108:111], v[220:223], a[172:175], v[108:111]
  buffer_load_dwordx4 v[152:155], v1, s[4:7], s23 offen offset:1024 sc1
  s_waitcnt vmcnt(15)
  v_mfma_f32_16x16x32_bf16 v[96:99], v[156:159], a[176:179], v[96:99]
  v_mfma_f32_16x16x32_bf16 v[100:103], v[156:159], a[180:183], v[100:103]
  s_waitcnt vmcnt(13)
  ds_read_b128 v[168:171], v5 offset:6144
  v_mfma_f32_16x16x32_bf16 v[104:107], v[156:159], a[184:187], v[104:107]
  v_mfma_f32_16x16x32_bf16 v[108:111], v[156:159], a[188:191], v[108:111]
  buffer_load_dwordx4 v[156:159], v1, s[4:7], s23 offen offset:2048 sc1
  s_add_u32 s23, s23, 0xc00
  s_waitcnt vmcnt(15)
  v_mfma_f32_16x16x32_bf16 v[96:99], v[160:163], a[192:195], v[96:99]
  v_mfma_f32_16x16x32_bf16 v[100:103], v[160:163], a[196:199], v[100:103]
  v_mfma_f32_16x16x32_bf16 v[104:107], v[160:163], a[200:203], v[104:107]
  v_mfma_f32_16x16x32_bf16 v[108:111], v[160:163], a[204:207], v[108:111]
  s_cmp_lg_u32 s3, 0
  s_cbranch_scc1 res_sk8
  s_add_u32 m0, s50, 12288
  s_nop 0
  buffer_load_dwordx4 v1, s[4:7], s23 offen sc1 lds
res_sk8:
  s_waitcnt vmcnt(14)
  v_mfma_f32_16x16x32_bf16 v[96:99], v[164:167], a[208:211], v[96:99]
  v_mfma_f32_16x16x32_bf16 v[100:103], v[164:167], a[212:215], v[100:103]
  v_mfma_f32_16x16x32_bf16 v[104:107], v[164:167], a[216:219], v[104:107]
  v_mfma_f32_16x16x32_bf16 v[108:111], v[164:167], a[220:223], v[108:111]
  buffer_load_dwordx4 v[164:167], v1, s[4:7], s23 offen offset:1024 sc1
  s_waitcnt lgkmcnt(0)
  v_mfma_f32_16x16x32_bf16 v[96:99], v[168:171], a[224:227], v[96:99]
  v_mfma_f32_16x16x32_bf16 v[100:103], v[168:171], a[228:231], v[100:103]
  v_mfma_f32_16x16x32_bf16 v[104:107], v[168:171], a[232:235], v[104:107]
  v_mfma_f32_16x16x32_bf16 v[108:111], v[168:171], a[236:239], v[108:111]
  buffer_load_dwordx4 v[168:171], v1, s[4:7], s23 offen offset:2048 sc1
  s_add_u32 s23, s23, 0xc00
  s_waitcnt vmcnt(15)
  v_mfma_f32_16x16x32_bf16 v[96:99], v[172:175], a[240:243], v[96:99]
  v_mfma_f32_16x16x32_bf16 v[100:103], v[172:175], a[244:247], v[100:103]
  v_mfma_f32_16x16x32_bf16 v[104:107], v[172:175], a[248:251], v[104:107]
  v_mfma_f32_16x16x32_bf16 v[108:111], v[172:175], a[252:255], v[108:111]
  buffer_load_dwordx4 v[172:175], v1, s[4:7], s23 offen sc1
  s_waitcnt vmcnt(15)
  v_mfma_f32_16x16x32_bf16 v[96:99], v[176:179], v[16:19], v[96:99]
  v_mfma_f32_16x16x32_bf16 v[100:103], v[176:179], v[20:23], v[100:103]
  v_mfma_f32_16x16x32_bf16 v[104:107], v[176:179], v[24:27], v[104:107]
  v_mfma_f32_16x16x32_bf16 v[108:111], v[176:179], v[28:31], v[108:111]
  s_waitcnt vmcnt(14)
  v_mfma_f32_16x16x32_bf16 v[96:99], v[180:183], v[32:35], v[96:99]
  v_mfma_f32_16x16x32_bf16 v[100:103], v[180:183], v[36:39], v[100:103]
  v_mfma_f32_16x16x32_bf16 v[104:107], v[180:183], v[40:43], v[104:107]
  v_mfma_f32_16x16x32_bf16 v[108:111], v[180:183], v[44:47], v[108:111]
  buffer_load_dwordx4 v[180:183], v1, s[4:7], s23 offen offset:2048 sc1
  s_add_u32 s23, s23, 0xc00
  v_mfma_f32_16x16x32_bf16 v[80:83], v[224:227], a[0:3], 0
  v_mfma_f32_16x16x32_bf16 v[84:87], v[224:227], a[4:7], 0
  v_mfma_f32_16x16x32_bf16 v[88:91], v[224:227], a[8:11], 0
  v_mfma_f32_16x16x32_bf16 v[92:95], v[224:227], a[12:15], 0
  buffer_load_dwordx4 v[112:115], v1, s[4:7], s23 offen sc1
  s_waitcnt vmcnt(15)
  v_mfma_f32_16x16x32_bf16 v[80:83], v[116:119], a[16:19], v[80:83]
  v_cvt_pk_bf16_f32 v192, v96, v97
  v_cvt_pk_bf16_f32 v193, v98, v99
  v_mfma_f32_16x16x32_bf16 v[84:87], v[116:119], a[20:23], v[84:87]
  s_waitcnt vmcnt(12)
  ds_read_b128 v[128:131], v5 offset:7168
  v_cvt_pk_bf16_f32 v194, v100, v101
  v_mfma_f32_16x16x32_bf16 v[88:91], v[116:119], a[24:27], v[88:91]
  v_cvt_pk_bf16_f32 v195, v102, v103
  v_cvt_pk_bf16_f32 v196, v104, v105
  v_mfma_f32_16x16x32_bf16 v[92:95], v[116:119], a[28:31], v[92:95]
  buffer_load_dwordx4 v[116:119], v1, s[4:7], s23 offen offset:1024 sc1
  s_waitcnt vmcnt(15)
  v_mfma_f32_16x16x32_bf16 v[80:83], v[120:123], a[32:35], v[80:83]
  v_cvt_pk_bf16_f32 v197, v106, v107
  v_mfma_f32_16x16x32_bf16 v[84:87], v[120:123], a[36:39], v[84:87]
  v_cvt_pk_bf16_f32 v198, v108, v109
  v_cvt_pk_bf16_f32 v199, v110, v111
  v_mfma_f32_16x16x32_bf16 v[88:91], v[120:123], a[40:43], v[88:91]
  v_mfma_f32_16x16x32_bf16 v[92:95], v[120:123], a[44:47], v[92:95]
  s_cmp_lg_u32 s3, 0
  s_cbranch_scc1 res_sk9
  s_add_u32 m0, s50, 11264
  s_nop 0
  buffer_load_dwordx4 v1, s[4:7], s23 offen offset:2048 sc1 lds
res_sk9:
  s_add_u32 s23, s23, 0xc00
  s_waitcnt vmcnt(14)
  v_mfma_f32_16x16x32_bf16 v[80:83], v[124:127], a[48:51], v[80:83]
  v_permlane16_swap_b32 v192, v194
  v_mfma_f32_16x16x32_bf16 v[84:87], v[124:127], a[52:55], v[84:87]
  v_permlane16_swap_b32 v193, v195
  v_permlane16_swap_b32 v196, v198
  v_mfma_f32_16x16x32_bf16 v[88:91], v[124:127], a[56:59], v[88:91]
  v_permlane16_swap_b32 v197, v199
  v_mfma_f32_16x16x32_bf16 v[92:95], v[124:127], a[60:63], v[92:95]
  buffer_load_dwordx4 v[124:127], v1, s[4:7], s23 offen sc1
  s_waitcnt lgkmcnt(0)
  v_mfma_f32_16x16x32_bf16 v[80:83], v[128:131], a[64:67], v[80:83]
  v_mfma_f32_16x16x32_bf16 v[84:87], v[128:131], a[68:71], v[84:87]
  buffer_store_dwordx4 v[192:195], v7, s[16:19], s27 offen sc1
  v_mfma_f32_16x16x32_bf16 v[88:91], v[128:131], a[72:75], v[88:91]
  v_mfma_f32_16x16x32_bf16 v[92:95], v[128:131], a[76:79], v[92:95]
  buffer_load_dwordx4 v[128:131], v1, s[4:7], s23 offen offset:1024 sc1
  s_waitcnt vmcnt(15)
  v_mfma_f32_16x16x32_bf16 v[80:83], v[132:135], a[80:83], v[80:83]
  v_mfma_f32_16x16x32_bf16 v[84:87], v[132:135], a[84:87], v[84:87]
  v_mfma_f32_16x16x32_bf16 v[88:91], v[132:135], a[88:91], v[88:91]
  v_mfma_f32_16x16x32_bf16 v[92:95], v[132:135], a[92:95], v[92:95]
  buffer_load_dwordx4 v[132:135], v1, s[4:7], s23 offen offset:2048 sc1
  s_add_u32 s23, s23, 0xc00
  s_waitcnt vmcnt(15)
  v_mfma_f32_16x16x32_bf16 v[80:83], v[136:139], a[96:99], v[80:83]
  v_mfma_f32_16x16x32_bf16 v[84:87], v[136:139], a[100:103], v[84:87]
  v_mfma_f32_16x16x32_bf16 v[88:91], v[136:139], a[104:107], v[88:91]
  v_mfma_f32_16x16x32_bf16 v[92:95], v[136:139], a[108:111], v[92:95]
  s_waitcnt vmcnt(14)
  v_mfma_f32_16x16x32_bf16 v[80:83], v[140:143], a[112:115], v[80:83]
  v_mfma_f32_16x16x32_bf16 v[84:87], v[140:143], a[116:119], v[84:87]
  v_mfma_f32_16x16x32_bf16 v[88:91], v[140:143], a[120:123], v[88:91]
  v_mfma_f32_16x16x32_bf16 v[92:95], v[140:143], a[124:127], v[92:95]
  buffer_load_dwordx4 v[140:143], v1, s[4:7], s23 offen offset:1024 sc1
  v_mfma_f32_16x16x32_bf16 v[80:83], v[228:231], a[128:131], v[80:83]
  v_mfma_f32_16x16x32_bf16 v[84:87], v[228:231], a[132:135], v[84:87]
  v_mfma_f32_16x16x32_bf16 v[88:91], v[228:231], a[136:139], v[88:91]
  v_mfma_f32_16x16x32_bf16 v[92:95], v[228:231], a[140:143], v[92:95]
  buffer_load_dwordx4 v[144:147], v1, s[4:7], s23 offen offset:2048 sc1
  s_add_u32 s23, s23, 0xc00
  s_waitcnt vmcnt(15)
  v_mfma_f32_16x16x32_bf16 v[80:83], v[148:151], a[144:147], v[80:83]
  v_mfma_f32_16x16x32_bf16 v[84:87], v[148:151], a[148:151], v[84:87]
  s_waitcnt vmcnt(12)
  ds_read_b128 v[160:163], v5 offset:8192
  v_mfma_f32_16x16x32_bf16 v[88:91], v[148:151], a[152:155], v[88:91]
  v_mfma_f32_16x16x32_bf16 v[92:95], v[148:151], a[156:159], v[92:95]
  buffer_load_dwordx4 v[148:151], v1, s[4:7], s23 offen sc1
  s_waitcnt vmcnt(14)
  v_mfma_f32_16x16x32_bf16 v[80:83], v[152:155], a[160:163], v[80:83]
  v_mfma_f32_16x16x32_bf16 v[84:87], v[152:155], a[164:167], v[84:87]
  buffer_store_dwordx4 v[196:199], v7, s[16:19], s27 offen offset:512 sc1
  s_add_u32 s27, s27, 0x2000
  v_mfma_f32_16x16x32_bf16 v[88:91], v[152:155], a[168:171], v[88:91]
  v_mfma_f32_16x16x32_bf16 v[92:95], v[152:155], a[172:175], v[92:95]
  s_cmp_lg_u32 s3, 0
  s_cbranch_scc1 res_sk10
  s_add_u32 m0, s50, 13312
  s_nop 0
  buffer_load_dwordx4 v1, s[4:7], s23 offen offset:1024 sc1 lds
res_sk10:
  s_waitcnt vmcnt(14)
  v_mfma_f32_16x16x32_bf16 v[80:83], v[156:159], a[176:179], v[80:83]
  v_mfma_f32_16x16x32_bf16 v[84:87], v[156:159], a[180:183], v[84:87]
  v_mfma_f32_16x16x32_bf16 v[88:91], v[156:159], a[184:187], v[88:91]
  v_mfma_f32_16x16x32_bf16 v[92:95], v[156:159], a[188:191], v[92:95]
  buffer_load_dwordx4 v[156:159], v1, s[4:7], s23 offen offset:2048 sc1
  s_add_u32 s23, s23, 0xc00
  s_waitcnt lgkmcnt(0)
  v_mfma_f32_16x16x32_bf16 v[80:83], v[160:163], a[192:195], v[80:83]
  v_mfma_f32_16x16x32_bf16 v[84:87], v[160:163], a[196:199], v[84:87]
  v_mfma_f32_16x16x32_bf16 v[88:91], v[160:163], a[200:203], v[88:91]
  v_mfma_f32_16x16x32_bf16 v[92:95], v[160:163], a[204:207], v[92:95]
  buffer_load_dwordx4 v[160:163], v1, s[4:7], s23 offen sc1
  s_waitcnt vmcnt(15)
  v_mfma_f32_16x16x32_bf16 v[80:83], v[164:167], a[208:211], v[80:83]
  v_mfma_f32_16x16x32_bf16 v[84:87], v[164:167], a[212:215], v[84:87]
  v_mfma_f32_16x16x32_bf16 v[88:91], v[164:167], a[216:219], v[88:91]
  v_mfma_f32_16x16x32_bf16 v[92:95], v[164:167], a[220:223], v[92:95]
  buffer_load_dwordx4 v[164:167], v1, s[4:7], s23 offen offset:1024 sc1
  s_waitcnt vmcnt(15)
  v_mfma_f32_16x16x32_bf16 v[80:83], v[168:171], a[224:227], v[80:83]
  v_mfma_f32_16x16x32_bf16 v[84:87], v[168:171], a[228:231], v[84:87]
  v_mfma_f32_16x16x32_bf16 v[88:91], v[168:171], a[232:235], v[88:91]
  v_mfma_f32_16x16x32_bf16 v[92:95], v[168:171], a[236:239], v[92:95]
  s_add_u32 s23, s23, 0xc00
  s_waitcnt vmcnt(14)
  v_mfma_f32_16x16x32_bf16 v[80:83], v[172:175], a[240:243], v[80:83]
  v_mfma_f32_16x16x32_bf16 v[84:87], v[172:175], a[244:247], v[84:87]
  v_mfma_f32_16x16x32_bf16 v[88:91], v[172:175], a[248:251], v[88:91]
  v_mfma_f32_16x16x32_bf16 v[92:95], v[172:175], a[252:255], v[92:95]
  buffer_load_dwordx4 v[172:175], v1, s[4:7], s23 offen sc1
  v_mfma_f32_16x16x32_bf16 v[80:83], v[232:235], v[16:19], v[80:83]
  v_mfma_f32_16x16x32_bf16 v[84:87], v[232:235], v[20:23], v[84:87]
  v_mfma_f32_16x16x32_bf16 v[88:91], v[232:235], v[24:27], v[88:91]
  v_mfma_f32_16x16x32_bf16 v[92:95], v[232:235], v[28:31], v[92:95]
  buffer_load_dwordx4 v[176:179], v1, s[4:7], s23 offen offset:1024 sc1
  s_waitcnt vmcnt(15)
  v_mfma_f32_16x16x32_bf16 v[80:83], v[180:183], v[32:35], v[80:83]
  v_mfma_f32_16x16x32_bf16 v[84:87], v[180:183], v[36:39], v[84:87]
  s_waitcnt vmcnt(13)
  ds_read_b128 v[120:123], v5 offset:9216
  v_mfma_f32_16x16x32_bf16 v[88:91], v[180:183], v[40:43], v[88:91]
  v_mfma_f32_16x16x32_bf16 v[92:95], v[180:183], v[44:47], v[92:95]
  buffer_load_dwordx4 v[180:183], v1, s[4:7], s23 offen offset:2048 sc1
  s_add_u32 s23, s23, 0xc00
  s_waitcnt vmcnt(15)
  v_mfma_f32_16x16x32_bf16 v[96:99], v[112:115], a[0:3], 0
  v_mfma_f32_16x16x32_bf16 v[100:103], v[112:115], a[4:7], 0
  v_mfma_f32_16x16x32_bf16 v[104:107], v[112:115], a[8:11], 0
  v_mfma_f32_16x16x32_bf16 v[108:111], v[112:115], a[12:15], 0
  s_cmp_lg_u32 s3, 0
  s_cbranch_scc1 res_sk11
  s_add_u32 m0, s50, 15360
  s_nop 0
  buffer_load_dwordx4 v1, s[4:7], s23 offen sc1 lds
res_sk11:
  s_waitcnt vmcnt(14)
  v_mfma_f32_16x16x32_bf16 v[96:99], v[116:119], a[16:19], v[96:99]
  v_cvt_pk_bf16_f32 v192, v80, v81
  v_cvt_pk_bf16_f32 v193, v82, v83
  v_mfma_f32_16x16x32_bf16 v[100:103], v[116:119], a[20:23], v[100:103]
  v_cvt_pk_bf16_f32 v194, v84, v85
  v_mfma_f32_16x16x32_bf16 v[104:107], v[116:119], a[24:27], v[104:107]
  v_cvt_pk_bf16_f32 v195, v86, v87
  v_cvt_pk_bf16_f32 v196, v88, v89
  v_mfma_f32_16x16x32_bf16 v[108:111], v[116:119], a[28:31], v[108:111]
  buffer_load_dwordx4 v[116:119], v1, s[4:7], s23 offen offset:1024 sc1
  s_waitcnt lgkmcnt(0)
  v_mfma_f32_16x16x32_bf16 v[96:99], v[120:123], a[32:35], v[96:99]
  v_cvt_pk_bf16_f32 v197, v90, v91
  v_mfma_f32_16x16x32_bf16 v[100:103], v[120:123], a[36:39], v[100:103]
  v_cvt_pk_bf16_f32 v198, v92, v93
  v_cvt_pk_bf16_f32 v199, v94, v95
  v_mfma_f32_16x16x32_bf16 v[104:107], v[120:123], a[40:43], v[104:107]
  v_mfma_f32_16x16x32_bf16 v[108:111], v[120:123], a[44:47], v[108:111]
  buffer_load_dwordx4 v[120:123], v1, s[4:7], s23 offen offset:2048 sc1
  s_add_u32 s23, s23, 0xc00
  s_waitcnt vmcnt(15)
  v_mfma_f32_16x16x32_bf16 v[96:99], v[124:127], a[48:51], v[96:99]
  v_permlane16_swap_b32 v192, v194
  v_mfma_f32_16x16x32_bf16 v[100:103], v[124:127], a[52:55], v[100:103]
  v_permlane16_swap_b32 v193, v195
  v_permlane16_swap_b32 v196, v198
  v_mfma_f32_16x16x32_bf16 v[104:107], v[124:127], a[56:59], v[104:107]
  v_permlane16_swap_b32 v197, v199
  v_mfma_f32_16x16x32_bf16 v[108:111], v[124:127], a[60:63], v[108:111]
  buffer_load_dwordx4 v[124:127], v1, s[4:7], s23 offen sc1
  s_waitcnt vmcnt(14)
  v_mfma_f32_16x16x32_bf16 v[96:99], v[128:131], a[64:67], v[96:99]
  v_mfma_f32_16x16x32_bf16 v[100:103], v[128:131], a[68:71], v[100:103]
  buffer_store_dwordx4 v[192:195], v7, s[16:19], s27 offen sc1
  v_mfma_f32_16x16x32_bf16 v[104:107], v[128:131], a[72:75], v[104:107]
  v_mfma_f32_16x16x32_bf16 v[108:111], v[128:131], a[76:79], v[108:111]
  s_waitcnt vmcnt(14)
  v_mfma_f32_16x16x32_bf16 v[96:99], v[132:135], a[80:83], v[96:99]
  v_mfma_f32_16x16x32_bf16 v[100:103], v[132:135], a[84:87], v[100:103]
  v_mfma_f32_16x16x32_bf16 v[104:107], v[132:135], a[88:91], v[104:107]
  v_mfma_f32_16x16x32_bf16 v[108:111], v[132:135], a[92:95], v[108:111]
  buffer_load_dwordx4 v[132:135], v1, s[4:7], s23 offen offset:2048 sc1
  s_add_u32 s23, s23, 0xc00
  v_mfma_f32_16x16x32_bf16 v[96:99], v[236:239], a[96:99], v[96:99]
  v_mfma_f32_16x16x32_bf16 v[100:103], v[236:239], a[100:103], v[100:103]
  v_mfma_f32_16x16x32_bf16 v[104:107], v[236:239], a[104:107], v[104:107]
  v_mfma_f32_16x16x32_bf16 v[108:111], v[236:239], a[108:111], v[108:111]
  buffer_load_dwordx4 v[136:139], v1, s[4:7], s23 offen sc1
  s_waitcnt vmcnt(15)
  v_mfma_f32_16x16x32_bf16 v[96:99], v[140:143], a[112:115], v[96:99]
  v_mfma_f32_16x16x32_bf16 v[100:103], v[140:143], a[116:119], v[100:103]
  s_waitcnt vmcnt(12)
  ds_read_b128 v[152:155], v5 offset:10240
  v_mfma_f32_16x16x32_bf16 v[104:107], v[140:143], a[120:123], v[104:107]
  v_mfma_f32_16x16x32_bf16 v[108:111], v[140:143], a[124:127], v[108:111]
  buffer_load_dwordx4 v[140:143], v1, s[4:7], s23 offen offset:1024 sc1
  s_waitcnt vmcnt(15)
  v_mfma_f32_16x16x32_bf16 v[96:99], v[144:147], a[128:131], v[96:99]
  v_mfma_f32_16x16x32_bf16 v[100:103], v[144:147], a[132:135], v[100:103]
  v_mfma_f32_16x16x32_bf16 v[104:107], v[144:147], a[136:139], v[104:107]
  v_mfma_f32_16x16x32_bf16 v[108:111], v[144:147], a[140:143], v[108:111]
  s_cmp_lg_u32 s3, 0
  s_cbranch_scc1 res_sk12
  s_add_u32 m0, s50, 14336
  s_nop 0
  buffer_load_dwordx4 v1, s[4:7], s23 offen offset:2048 sc1 lds
res_sk12:
  s_add_u32 s23, s23, 0xc00
  s_waitcnt vmcnt(14)
  v_mfma_f32_16x16x32_bf16 v[96:99], v[148:151], a[144:147], v[96:99]
  v_mfma_f32_16x16x32_bf16 v[100:103], v[148:151], a[148:151], v[100:103]
  v_mfma_f32_16x16x32_bf16 v[104:107], v[148:151], a[152:155], v[104:107]
  v_mfma_f32_16x16x32_bf16 v[108:111], v[148:151], a[156:159], v[108:111]
  buffer_load_dwordx4 v[148:151], v1, s[4:7], s23 offen sc1
  s_waitcnt lgkmcnt(0)
  v_mfma_f32_16x16x32_bf16 v[96:99], v[152:155], a[160:163], v[96:99]
  v_mfma_f32_16x16x32_bf16 v[100:103], v[152:155], a[164:167], v[100:103]
  buffer_store_dwordx4 v[196:199], v7, s[16:19], s27 offen offset:512 sc1
  s_add_u32 s27, s27, 0x2000
  v_mfma_f32_16x16x32_bf16 v[104:107], v[152:155], a[168:171], v[104:107]
  v_mfma_f32_16x16x32_bf16 v[108:111], v[152:155], a[172:175], v[108:111]
  buffer_load_dwordx4 v[152:155], v1, s[4:7], s23 offen offset:1024 sc1
  s_waitcnt vmcnt(15)
  s_mov_b64 exec, 1
  v_mov_b32 v9, 0
  v_mov_b32 v10, s90
  v_mov_b32 v11, s91
  buffer_store_dwordx2 v[10:11], v9, s[92:95], s30 offen sc1
  s_mov_b64 exec, -1
  v_mfma_f32_16x16x32_bf16 v[96:99], v[156:159], a[176:179], v[96:99]
  v_mfma_f32_16x16x32_bf16 v[100:103], v[156:159], a[180:183], v[100:103]
  v_mfma_f32_16x16x32_bf16 v[104:107], v[156:159], a[184:187], v[104:107]
  v_mfma_f32_16x16x32_bf16 v[108:111], v[156:159], a[188:191], v[108:111]
  buffer_load_dwordx4 v[156:159], v1, s[4:7], s23 offen offset:2048 sc1
  s_add_u32 s23, s23, 0xc00
  s_waitcnt vmcnt(16)
  v_mfma_f32_16x16x32_bf16 v[96:99], v[160:163], a[192:195], v[96:99]
  v_mfma_f32_16x16x32_bf16 v[100:103], v[160:163], a[196:199], v[100:103]
  v_mfma_f32_16x16x32_bf16 v[104:107], v[160:163], a[200:203], v[104:107]
  v_mfma_f32_16x16x32_bf16 v[108:111], v[160:163], a[204:207], v[108:111]
  s_waitcnt vmcnt(15)
  v_mfma_f32_16x16x32_bf16 v[96:99], v[164:167], a[208:211], v[96:99]
  v_mfma_f32_16x16x32_bf16 v[100:103], v[164:167], a[212:215], v[100:103]
  v_mfma_f32_16x16x32_bf16 v[104:107], v[164:167], a[216:219], v[104:107]
  v_mfma_f32_16x16x32_bf16 v[108:111], v[164:167], a[220:223], v[108:111]
  buffer_load_dwordx4 v[164:167], v1, s[4:7], s23 offen offset:1024 sc1
  v_mfma_f32_16x16x32_bf16 v[96:99], v[240:243], a[224:227], v[96:99]
  v_mfma_f32_16x16x32_bf16 v[100:103], v[240:243], a[228:231], v[100:103]
  v_mfma_f32_16x16x32_bf16 v[104:107], v[240:243], a[232:235], v[104:107]
  v_mfma_f32_16x16x32_bf16 v[108:111], v[240:243], a[236:239], v[108:111]
  buffer_load_dwordx4 v[168:171], v1, s[4:7], s23 offen offset:2048 sc1
  s_add_u32 s23, s23, 0xc00
  s_waitcnt vmcnt(16)
  v_mfma_f32_16x16x32_bf16 v[96:99], v[172:175], a[240:243], v[96:99]
  v_mfma_f32_16x16x32_bf16 v[100:103], v[172:175], a[244:247], v[100:103]
  s_waitcnt vmcnt(14)
  ds_read_b128 v[112:115], v5 offset:11264
  v_mfma_f32_16x16x32_bf16 v[104:107], v[172:175], a[248:251], v[104:107]
  v_mfma_f32_16x16x32_bf16 v[108:111], v[172:175], a[252:255], v[108:111]
  buffer_load_dwordx4 v[172:175], v1, s[4:7], s23 offen sc1
  s_waitcnt vmcnt(16)
  v_mfma_f32_16x16x32_bf16 v[96:99], v[176:179], v[16:19], v[96:99]
  v_mfma_f32_16x16x32_bf16 v[100:103], v[176:179], v[20:23], v[100:103]
  v_mfma_f32_16x16x32_bf16 v[104:107], v[176:179], v[24:27], v[104:107]
  v_mfma_f32_16x16x32_bf16 v[108:111], v[176:179], v[28:31], v[108:111]
  s_cmp_lg_u32 s3, 0
  s_cbranch_scc1 res_sk13
  s_add_u32 m0, s50, 16384
  s_nop 0
  buffer_load_dwordx4 v1, s[4:7], s23 offen offset:1024 sc1 lds
res_sk13:
  s_waitcnt vmcnt(15)
  v_mfma_f32_16x16x32_bf16 v[96:99], v[180:183], v[32:35], v[96:99]
  v_mfma_f32_16x16x32_bf16 v[100:103], v[180:183], v[36:39], v[100:103]
  v_mfma_f32_16x16x32_bf16 v[104:107], v[180:183], v[40:43], v[104:107]
  v_mfma_f32_16x16x32_bf16 v[108:111], v[180:183], v[44:47], v[108:111]
  buffer_load_dwordx4 v[180:183], v1, s[4:7], s23 offen offset:2048 sc1
  s_add_u32 s23, s23, 0xc00
  s_waitcnt lgkmcnt(0)
  v_mfma_f32_16x16x32_bf16 v[80:83], v[112:115], a[0:3], 0
  v_mfma_f32_16x16x32_bf16 v[84:87], v[112:115], a[4:7], 0
  v_mfma_f32_16x16x32_bf16 v[88:91], v[112:115], a[8:11], 0
  v_mfma_f32_16x16x32_bf16 v[92:95], v[112:115], a[12:15], 0
  buffer_load_dwordx4 v[112:115], v1, s[4:7], s23 offen sc1
  s_waitcnt vmcnt(16)
  v_mfma_f32_16x16x32_bf16 v[80:83], v[116:119], a[16:19], v[80:83]
  v_cvt_pk_bf16_f32 v192, v96, v97
  v_cvt_pk_bf16_f32 v193, v98, v99
  v_mfma_f32_16x16x32_bf16 v[84:87], v[116:119], a[20:23], v[84:87]
  v_cvt_pk_bf16_f32 v194, v100, v101
  v_mfma_f32_16x16x32_bf16 v[88:91], v[116:119], a[24:27], v[88:91]
  v_cvt_pk_bf16_f32 v195, v102, v103
  v_cvt_pk_bf16_f32 v196, v104, v105
  v_mfma_f32_16x16x32_bf16 v[92:95], v[116:119], a[28:31], v[92:95]
  buffer_load_dwordx4 v[116:119], v1, s[4:7], s23 offen offset:1024 sc1
  s_waitcnt vmcnt(16)
  v_mfma_f32_16x16x32_bf16 v[80:83], v[120:123], a[32:35], v[80:83]
  v_cvt_pk_bf16_f32 v197, v106, v107
  v_mfma_f32_16x16x32_bf16 v[84:87], v[120:123], a[36:39], v[84:87]
  v_cvt_pk_bf16_f32 v198, v108, v109
  v_cvt_pk_bf16_f32 v199, v110, v111
  v_mfma_f32_16x16x32_bf16 v[88:91], v[120:123], a[40:43], v[88:91]
  v_mfma_f32_16x16x32_bf16 v[92:95], v[120:123], a[44:47], v[92:95]
  s_add_u32 s23, s23, 0xc00
  s_waitcnt vmcnt(15)
  v_mfma_f32_16x16x32_bf16 v[80:83], v[124:127], a[48:51], v[80:83]
  v_permlane16_swap_b32 v192, v194
  v_mfma_f32_16x16x32_bf16 v[84:87], v[124:127], a[52:55], v[84:87]
  v_permlane16_swap_b32 v193, v195
  v_permlane16_swap_b32 v196, v198
  v_mfma_f32_16x16x32_bf16 v[88:91], v[124:127], a[56:59], v[88:91]
  v_permlane16_swap_b32 v197, v199
  v_mfma_f32_16x16x32_bf16 v[92:95], v[124:127], a[60:63], v[92:95]
  buffer_load_dwordx4 v[124:127], v1, s[4:7], s23 offen sc1
  v_mfma_f32_16x16x32_bf16 v[80:83], v[244:247], a[64:67], v[80:83]
  v_mfma_f32_16x16x32_bf16 v[84:87], v[244:247], a[68:71], v[84:87]
  buffer_store_dwordx4 v[192:195], v7, s[16:19], s27 offen sc1
  v_mfma_f32_16x16x32_bf16 v[88:91], v[244:247], a[72:75], v[88:91]
  v_mfma_f32_16x16x32_bf16 v[92:95], v[244:247], a[76:79], v[92:95]
  buffer_load_dwordx4 v[128:131], v1, s[4:7], s23 offen offset:1024 sc1
  s_waitcnt vmcnt(16)
  v_mfma_f32_16x16x32_bf16 v[80:83], v[132:135], a[80:83], v[80:83]
  v_mfma_f32_16x16x32_bf16 v[84:87], v[132:135], a[84:87], v[84:87]
  s_waitcnt vmcnt(14)
  ds_read_b128 v[144:147], v5 offset:12288
  v_mfma_f32_16x16x32_bf16 v[88:91], v[132:135], a[88:91], v[88:91]
  v_mfma_f32_16x16x32_bf16 v[92:95], v[132:135], a[92:95], v[92:95]
  buffer_load_dwordx4 v[132:135], v1, s[4:7], s23 offen offset:2048 sc1
  s_add_u32 s23, s23, 0xc00
  s_waitcnt vmcnt(16)
  v_mfma_f32_16x16x32_bf16 v[80:83], v[136:139], a[96:99], v[80:83]
  v_mfma_f32_16x16x32_bf16 v[84:87], v[136:139], a[100:103], v[84:87]
  v_mfma_f32_16x16x32_bf16 v[88:91], v[136:139], a[104:107], v[88:91]
  v_mfma_f32_16x16x32_bf16 v[92:95], v[136:139], a[108:111], v[92:95]
  s_cmp_lg_u32 s3, 0
  s_cbranch_scc1 res_sk14
  s_add_u32 m0, s50, 18432
  s_nop 0
  buffer_load_dwordx4 v1, s[4:7], s23 offen sc1 lds
res_sk14:
  s_waitcnt vmcnt(15)
  v_mfma_f32_16x16x32_bf16 v[80:83], v[140:143], a[112:115], v[80:83]
  v_mfma_f32_16x16x32_bf16 v[84:87], v[140:143], a[116:119], v[84:87]
  v_mfma_f32_16x16x32_bf16 v[88:91], v[140:143], a[120:123], v[88:91]
  v_mfma_f32_16x16x32_bf16 v[92:95], v[140:143], a[124:127], v[92:95]
  buffer_load_dwordx4 v[140:143], v1, s[4:7], s23 offen offset:1024 sc1
  s_waitcnt lgkmcnt(0)
  v_mfma_f32_16x16x32_bf16 v[80:83], v[144:147], a[128:131], v[80:83]
  v_mfma_f32_16x16x32_bf16 v[84:87], v[144:147], a[132:135], v[84:87]
  v_mfma_f32_16x16x32_bf16 v[88:91], v[144:147], a[136:139], v[88:91]
  v_mfma_f32_16x16x32_bf16 v[92:95], v[144:147], a[140:143], v[92:95]
  buffer_load_dwordx4 v[144:147], v1, s[4:7], s23 offen offset:2048 sc1
  s_add_u32 s23, s23, 0xc00
  s_waitcnt vmcnt(16)
  v_mfma_f32_16x16x32_bf16 v[80:83], v[148:151], a[144:147], v[80:83]
  v_mfma_f32_16x16x32_bf16 v[84:87], v[148:151], a[148:151], v[84:87]
  v_mfma_f32_16x16x32_bf16 v[88:91], v[148:151], a[152:155], v[88:91]
  v_mfma_f32_16x16x32_bf16 v[92:95], v[148:151], a[156:159], v[92:95]
  buffer_load_dwordx4 v[148:151], v1, s[4:7], s23 offen sc1
  s_waitcnt vmcnt(15)
  v_mfma_f32_16x16x32_bf16 v[80:83], v[152:155], a[160:163], v[80:83]
  v_mfma_f32_16x16x32_bf16 v[84:87], v[152:155], a[164:167], v[84:87]
  buffer_store_dwordx4 v[196:199], v7, s[16:19], s27 offen offset:512 sc1
  s_add_u32 s27, s27, 0x2000
  v_mfma_f32_16x16x32_bf16 v[88:91], v[152:155], a[168:171], v[88:91]
  v_mfma_f32_16x16x32_bf16 v[92:95], v[152:155], a[172:175], v[92:95]
  buffer_load_dwordx4 v[152:155], v1, s[4:7], s23 offen offset:1024 sc1
  s_waitcnt vmcnt(15)
  v_mfma_f32_16x16x32_bf16 v[80:83], v[156:159], a[176:179], v[80:83]
  v_mfma_f32_16x16x32_bf16 v[84:87], v[156:159], a[180:183], v[84:87]
  v_mfma_f32_16x16x32_bf16 v[88:91], v[156:159], a[184:187], v[88:91]
  v_mfma_f32_16x16x32_bf16 v[92:95], v[156:159], a[188:191], v[92:95]
  buffer_load_dwordx4 v[156:159], v1, s[4:7], s23 offen offset:2048 sc1
  s_add_u32 s23, s23, 0xc00
  v_mfma_f32_16x16x32_bf16 v[80:83], v[248:251], a[192:195], v[80:83]
  v_mfma_f32_16x16x32_bf16 v[84:87], v[248:251], a[196:199], v[84:87]
  v_mfma_f32_16x16x32_bf16 v[88:91], v[248:251], a[200:203], v[88:91]
  v_mfma_f32_16x16x32_bf16 v[92:95], v[248:251], a[204:207], v[92:95]
  buffer_load_dwordx4 v[160:163], v1, s[4:7], s23 offen sc1
  s_waitcnt vmcnt(16)
  v_mfma_f32_16x16x32_bf16 v[80:83], v[164:167], a[208:211], v[80:83]
  v_mfma_f32_16x16x32_bf16 v[84:87], v[164:167], a[212:215], v[84:87]
  s_waitcnt vmcnt(14)
  ds_read_b128 v[176:179], v5 offset:13312
  v_mfma_f32_16x16x32_bf16 v[88:91], v[164:167], a[216:219], v[88:91]
  v_mfma_f32_16x16x32_bf16 v[92:95], v[164:167], a[220:223], v[92:95]
  buffer_load_dwordx4 v[164:167], v1, s[4:7], s23 offen offset:1024 sc1
  s_waitcnt vmcnt(16)
  v_mfma_f32_16x16x32_bf16 v[80:83], v[168:171], a[224:227], v[80:83]
  v_mfma_f32_16x16x32_bf16 v[84:87], v[168:171], a[228:231], v[84:87]
  v_mfma_f32_16x16x32_bf16 v[88:91], v[168:171], a[232:235], v[88:91]
  v_mfma_f32_16x16x32_bf16 v[92:95], v[168:171], a[236:239], v[92:95]
  s_cmp_lg_u32 s3, 0
  s_cbranch_scc1 res_sk15
  s_add_u32 m0, s50, 17408
  s_nop 0
  buffer_load_dwordx4 v1, s[4:7], s23 offen offset:2048 sc1 lds
res_sk15:
  s_add_u32 s23, s23, 0xc00
  s_waitcnt vmcnt(15)
  v_mfma_f32_16x16x32_bf16 v[80:83], v[172:175], a[240:243], v[80:83]
  v_mfma_f32_16x16x32_bf16 v[84:87], v[172:175], a[244:247], v[84:87]
  v_mfma_f32_16x16x32_bf16 v[88:91], v[172:175], a[248:251], v[88:91]
  v_mfma_f32_16x16x32_bf16 v[92:95], v[172:175], a[252:255], v[92:95]
  buffer_load_dwordx4 v[172:175], v1, s[4:7], s23 offen sc1
  s_waitcnt lgkmcnt(0)
  v_mfma_f32_16x16x32_bf16 v[80:83], v[176:179], v[16:19], v[80:83]
  v_mfma_f32_16x16x32_bf16 v[84:87], v[176:179], v[20:23], v[84:87]
  v_mfma_f32_16x16x32_bf16 v[88:91], v[176:179], v[24:27], v[88:91]
  v_mfma_f32_16x16x32_bf16 v[92:95], v[176:179], v[28:31], v[92:95]
  buffer_load_dwordx4 v[176:179], v1, s[4:7], s23 offen offset:1024 sc1
  s_waitcnt vmcnt(16)
  v_mfma_f32_16x16x32_bf16 v[80:83], v[180:183], v[32:35], v[80:83]
  v_mfma_f32_16x16x32_bf16 v[84:87], v[180:183], v[36:39], v[84:87]
  v_mfma_f32_16x16x32_bf16 v[88:91], v[180:183], v[40:43], v[88:91]
  v_mfma_f32_16x16x32_bf16 v[92:95], v[180:183], v[44:47], v[92:95]
  buffer_load_dwordx4 v[180:183], v1, s[4:7], s23 offen offset:2048 sc1
  s_add_u32 s23, s23, 0xc00
  s_waitcnt vmcnt(16)
  v_mfma_f32_16x16x32_bf16 v[96:99], v[112:115], a[0:3], 0
  v_mfma_f32_16x16x32_bf16 v[100:103], v[112:115], a[4:7], 0
  v_mfma_f32_16x16x32_bf16 v[104:107], v[112:115], a[8:11], 0
  v_mfma_f32_16x16x32_bf16 v[108:111], v[112:115], a[12:15], 0
  buffer_load_dwordx4 v[112:115], v1, s[4:7], s23 offen sc1
  s_waitcnt vmcnt(16)
  v_mfma_f32_16x16x32_bf16 v[96:99], v[116:119], a[16:19], v[96:99]
  v_cvt_pk_bf16_f32 v192, v80, v81
  v_cvt_pk_bf16_f32 v193, v82, v83
  v_mfma_f32_16x16x32_bf16 v[100:103], v[116:119], a[20:23], v[100:103]
  v_cvt_pk_bf16_f32 v194, v84, v85
  v_mfma_f32_16x16x32_bf16 v[104:107], v[116:119], a[24:27], v[104:107]
  v_cvt_pk_bf16_f32 v195, v86, v87
  v_cvt_pk_bf16_f32 v196, v88, v89
  v_mfma_f32_16x16x32_bf16 v[108:111], v[116:119], a[28:31], v[108:111]
  buffer_load_dwordx4 v[116:119], v1, s[4:7], s23 offen offset:1024 sc1
  v_mfma_f32_16x16x32_bf16 v[96:99], v[252:255], a[32:35], v[96:99]
  v_cvt_pk_bf16_f32 v197, v90, v91
  v_mfma_f32_16x16x32_bf16 v[100:103], v[252:255], a[36:39], v[100:103]
  v_cvt_pk_bf16_f32 v198, v92, v93
  v_cvt_pk_bf16_f32 v199, v94, v95
  v_mfma_f32_16x16x32_bf16 v[104:107], v[252:255], a[40:43], v[104:107]
  v_mfma_f32_16x16x32_bf16 v[108:111], v[252:255], a[44:47], v[108:111]
  buffer_load_dwordx4 v[120:123], v1, s[4:7], s23 offen offset:2048 sc1
  s_add_u32 s23, s23, 0xc00
  s_waitcnt vmcnt(17)
  v_mfma_f32_16x16x32_bf16 v[96:99], v[124:127], a[48:51], v[96:99]
  v_permlane16_swap_b32 v192, v194
  v_mfma_f32_16x16x32_bf16 v[100:103], v[124:127], a[52:55], v[100:103]
  s_waitcnt vmcnt(14)
  ds_read_b128 v[136:139], v5 offset:14336
  v_permlane16_swap_b32 v193, v195
  v_permlane16_swap_b32 v196, v198
  v_mfma_f32_16x16x32_bf16 v[104:107], v[124:127], a[56:59], v[104:107]
  v_permlane16_swap_b32 v197, v199
  v_mfma_f32_16x16x32_bf16 v[108:111], v[124:127], a[60:63], v[108:111]
  buffer_load_dwordx4 v[124:127], v1, s[4:7], s23 offen sc1
  s_waitcnt vmcnt(16)
  v_mfma_f32_16x16x32_bf16 v[96:99], v[128:131], a[64:67], v[96:99]
  v_mfma_f32_16x16x32_bf16 v[100:103], v[128:131], a[68:71], v[100:103]
  buffer_store_dwordx4 v[192:195], v7, s[16:19], s27 offen sc1
  v_mfma_f32_16x16x32_bf16 v[104:107], v[128:131], a[72:75], v[104:107]
  v_mfma_f32_16x16x32_bf16 v[108:111], v[128:131], a[76:79], v[108:111]
  s_cmp_lg_u32 s3, 0
  s_cbranch_scc1 res_sk16
  s_add_u32 m0, s50, 19456
  s_nop 0
  buffer_load_dwordx4 v1, s[4:7], s23 offen offset:1024 sc1 lds
res_sk16:
  s_waitcnt vmcnt(16)
  v_mfma_f32_16x16x32_bf16 v[96:99], v[132:135], a[80:83], v[96:99]
  v_mfma_f32_16x16x32_bf16 v[100:103], v[132:135], a[84:87], v[100:103]
  v_mfma_f32_16x16x32_bf16 v[104:107], v[132:135], a[88:91], v[104:107]
  v_mfma_f32_16x16x32_bf16 v[108:111], v[132:135], a[92:95], v[108:111]
  buffer_load_dwordx4 v[132:135], v1, s[4:7], s23 offen offset:2048 sc1
  s_add_u32 s23, s23, 0xc00
  s_waitcnt lgkmcnt(0)
  v_mfma_f32_16x16x32_bf16 v[96:99], v[136:139], a[96:99], v[96:99]
  v_mfma_f32_16x16x32_bf16 v[100:103], v[136:139], a[100:103], v[100:103]
  v_mfma_f32_16x16x32_bf16 v[104:107], v[136:139], a[104:107], v[104:107]
  v_mfma_f32_16x16x32_bf16 v[108:111], v[136:139], a[108:111], v[108:111]
  buffer_load_dwordx4 v[136:139], v1, s[4:7], s23 offen sc1
  s_waitcnt vmcnt(17)
  v_mfma_f32_16x16x32_bf16 v[96:99], v[140:143], a[112:115], v[96:99]
  v_mfma_f32_16x16x32_bf16 v[100:103], v[140:143], a[116:119], v[100:103]
  v_mfma_f32_16x16x32_bf16 v[104:107], v[140:143], a[120:123], v[104:107]
  v_mfma_f32_16x16x32_bf16 v[108:111], v[140:143], a[124:127], v[108:111]
  buffer_load_dwordx4 v[140:143], v1, s[4:7], s23 offen offset:1024 sc1
  s_waitcnt vmcnt(17)
  v_mfma_f32_16x16x32_bf16 v[96:99], v[144:147], a[128:131], v[96:99]
  v_mfma_f32_16x16x32_bf16 v[100:103], v[144:147], a[132:135], v[100:103]
  v_mfma_f32_16x16x32_bf16 v[104:107], v[144:147], a[136:139], v[104:107]
  v_mfma_f32_16x16x32_bf16 v[108:111], v[144:147], a[140:143], v[108:111]
  buffer_load_dwordx4 v[144:147], v1, s[4:7], s23 offen offset:2048 sc1
  s_add_u32 s23, s23, 0xc00
  s_waitcnt vmcnt(17)
  v_mfma_f32_16x16x32_bf16 v[96:99], v[148:151], a[144:147], v[96:99]
  v_mfma_f32_16x16x32_bf16 v[100:103], v[148:151], a[148:151], v[100:103]
  v_mfma_f32_16x16x32_bf16 v[104:107], v[148:151], a[152:155], v[104:107]
  v_mfma_f32_16x16x32_bf16 v[108:111], v[148:151], a[156:159], v[108:111]
  buffer_load_dwordx4 v[148:151], v1, s[4:7], s23 offen sc1
  s_waitcnt vmcnt(16)
  v_mfma_f32_16x16x32_bf16 v[96:99], v[152:155], a[160:163], v[96:99]
  v_mfma_f32_16x16x32_bf16 v[100:103], v[152:155], a[164:167], v[100:103]
  buffer_store_dwordx4 v[196:199], v7, s[16:19], s27 offen offset:512 sc1
  s_add_u32 s27, s27, 0x2000
  v_mfma_f32_16x16x32_bf16 v[104:107], v[152:155], a[168:171], v[104:107]
  v_mfma_f32_16x16x32_bf16 v[108:111], v[152:155], a[172:175], v[108:111]
  buffer_load_dwordx4 v[152:155], v1, s[4:7], s23 offen offset:1024 sc1
  s_waitcnt vmcnt(17)
  v_mfma_f32_16x16x32_bf16 v[96:99], v[156:159], a[176:179], v[96:99]
  v_mfma_f32_16x16x32_bf16 v[100:103], v[156:159], a[180:183], v[100:103]
  s_waitcnt vmcnt(15)
  ds_read_b128 v[168:171], v5 offset:15360
  v_mfma_f32_16x16x32_bf16 v[104:107], v[156:159], a[184:187], v[104:107]
  v_mfma_f32_16x16x32_bf16 v[108:111], v[156:159], a[188:191], v[108:111]
  buffer_load_dwordx4 v[156:159], v1, s[4:7], s23 offen offset:2048 sc1
  s_add_u32 s23, s23, 0xc00
  s_waitcnt vmcnt(17)
  v_mfma_f32_16x16x32_bf16 v[96:99], v[160:163], a[192:195], v[96:99]
  v_mfma_f32_16x16x32_bf16 v[100:103], v[160:163], a[196:199], v[100:103]
  v_mfma_f32_16x16x32_bf16 v[104:107], v[160:163], a[200:203], v[104:107]
  v_mfma_f32_16x16x32_bf16 v[108:111], v[160:163], a[204:207], v[108:111]
  buffer_load_dwordx4 v[160:163], v1, s[4:7], s23 offen sc1
  s_waitcnt vmcnt(17)
  v_mfma_f32_16x16x32_bf16 v[96:99], v[164:167], a[208:211], v[96:99]
  v_mfma_f32_16x16x32_bf16 v[100:103], v[164:167], a[212:215], v[100:103]
  v_mfma_f32_16x16x32_bf16 v[104:107], v[164:167], a[216:219], v[104:107]
  v_mfma_f32_16x16x32_bf16 v[108:111], v[164:167], a[220:223], v[108:111]
  buffer_load_dwordx4 v[164:167], v1, s[4:7], s23 offen offset:1024 sc1
  s_waitcnt lgkmcnt(0)
  v_mfma_f32_16x16x32_bf16 v[96:99], v[168:171], a[224:227], v[96:99]
  v_mfma_f32_16x16x32_bf16 v[100:103], v[168:171], a[228:231], v[100:103]
  v_mfma_f32_16x16x32_bf16 v[104:107], v[168:171], a[232:235], v[104:107]
  v_mfma_f32_16x16x32_bf16 v[108:111], v[168:171], a[236:239], v[108:111]
  buffer_load_dwordx4 v[168:171], v1, s[4:7], s23 offen offset:2048 sc1
  s_add_u32 s23, s23, 0xc00
  s_waitcnt vmcnt(18)
  v_mfma_f32_16x16x32_bf16 v[96:99], v[172:175], a[240:243], v[96:99]
  v_mfma_f32_16x16x32_bf16 v[100:103], v[172:175], a[244:247], v[100:103]
  v_mfma_f32_16x16x32_bf16 v[104:107], v[172:175], a[248:251], v[104:107]
  v_mfma_f32_16x16x32_bf16 v[108:111], v[172:175], a[252:255], v[108:111]
  buffer_load_dwordx4 v[172:175], v1, s[4:7], s23 offen sc1
  s_waitcnt vmcnt(18)
  v_mfma_f32_16x16x32_bf16 v[96:99], v[176:179], v[16:19], v[96:99]
  v_mfma_f32_16x16x32_bf16 v[100:103], v[176:179], v[20:23], v[100:103]
  v_mfma_f32_16x16x32_bf16 v[104:107], v[176:179], v[24:27], v[104:107]
  v_mfma_f32_16x16x32_bf16 v[108:111], v[176:179], v[28:31], v[108:111]
  buffer_load_dwordx4 v[176:179], v1, s[4:7], s23 offen offset:1024 sc1
  s_waitcnt vmcnt(18)
  v_mfma_f32_16x16x32_bf16 v[96:99], v[180:183], v[32:35], v[96:99]
  v_mfma_f32_16x16x32_bf16 v[100:103], v[180:183], v[36:39], v[100:103]
  v_mfma_f32_16x16x32_bf16 v[104:107], v[180:183], v[40:43], v[104:107]
  v_mfma_f32_16x16x32_bf16 v[108:111], v[180:183], v[44:47], v[108:111]
  buffer_load_dwordx4 v[180:183], v1, s[4:7], s23 offen offset:2048 sc1
  s_add_u32 s23, s23, 0xc00
  s_waitcnt vmcnt(18)
  v_mfma_f32_16x16x32_bf16 v[80:83], v[112:115], a[0:3], 0
  v_mfma_f32_16x16x32_bf16 v[84:87], v[112:115], a[4:7], 0
  v_mfma_f32_16x16x32_bf16 v[88:91], v[112:115], a[8:11], 0
  v_mfma_f32_16x16x32_bf16 v[92:95], v[112:115], a[12:15], 0
  s_waitcnt vmcnt(17)
  v_mfma_f32_16x16x32_bf16 v[80:83], v[116:119], a[16:19], v[80:83]
  v_cvt_pk_bf16_f32 v192, v96, v97
  v_cvt_pk_bf16_f32 v193, v98, v99
  v_mfma_f32_16x16x32_bf16 v[84:87], v[116:119], a[20:23], v[84:87]
  s_waitcnt vmcnt(14)
  ds_read_b128 v[128:131], v5 offset:16384
  v_cvt_pk_bf16_f32 v194, v100, v101
  v_mfma_f32_16x16x32_bf16 v[88:91], v[116:119], a[24:27], v[88:91]
  v_cvt_pk_bf16_f32 v195, v102, v103
  v_cvt_pk_bf16_f32 v196, v104, v105
  v_mfma_f32_16x16x32_bf16 v[92:95], v[116:119], a[28:31], v[92:95]
  s_waitcnt vmcnt(16)
  v_mfma_f32_16x16x32_bf16 v[80:83], v[120:123], a[32:35], v[80:83]
  v_cvt_pk_bf16_f32 v197, v106, v107
  v_mfma_f32_16x16x32_bf16 v[84:87], v[120:123], a[36:39], v[84:87]
  v_cvt_pk_bf16_f32 v198, v108, v109
  v_cvt_pk_bf16_f32 v199, v110, v111
  v_mfma_f32_16x16x32_bf16 v[88:91], v[120:123], a[40:43], v[88:91]
  v_mfma_f32_16x16x32_bf16 v[92:95], v[120:123], a[44:47], v[92:95]
  s_waitcnt vmcnt(15)
  v_mfma_f32_16x16x32_bf16 v[80:83], v[124:127], a[48:51], v[80:83]
  v_permlane16_swap_b32 v192, v194
  v_mfma_f32_16x16x32_bf16 v[84:87], v[124:127], a[52:55], v[84:87]
  v_permlane16_swap_b32 v193, v195
  v_permlane16_swap_b32 v196, v198
  v_mfma_f32_16x16x32_bf16 v[88:91], v[124:127], a[56:59], v[88:91]
  v_permlane16_swap_b32 v197, v199
  v_mfma_f32_16x16x32_bf16 v[92:95], v[124:127], a[60:63], v[92:95]
  s_waitcnt lgkmcnt(0)
  v_mfma_f32_16x16x32_bf16 v[80:83], v[128:131], a[64:67], v[80:83]
  v_mfma_f32_16x16x32_bf16 v[84:87], v[128:131], a[68:71], v[84:87]
  buffer_store_dwordx4 v[192:195], v7, s[16:19], s27 offen sc1
  v_mfma_f32_16x16x32_bf16 v[88:91], v[128:131], a[72:75], v[88:91]
  v_mfma_f32_16x16x32_bf16 v[92:95], v[128:131], a[76:79], v[92:95]
  s_waitcnt vmcnt(14)
  v_mfma_f32_16x16x32_bf16 v[80:83], v[132:135], a[80:83], v[80:83]
  v_mfma_f32_16x16x32_bf16 v[84:87], v[132:135], a[84:87], v[84:87]
  v_mfma_f32_16x16x32_bf16 v[88:91], v[132:135], a[88:91], v[88:91]
  v_mfma_f32_16x16x32_bf16 v[92:95], v[132:135], a[92:95], v[92:95]
  s_waitcnt vmcnt(13)
  v_mfma_f32_16x16x32_bf16 v[80:83], v[136:139], a[96:99], v[80:83]
  v_mfma_f32_16x16x32_bf16 v[84:87], v[136:139], a[100:103], v[84:87]
  v_mfma_f32_16x16x32_bf16 v[88:91], v[136:139], a[104:107], v[88:91]
  v_mfma_f32_16x16x32_bf16 v[92:95], v[136:139], a[108:111], v[92:95]
  s_waitcnt vmcnt(12)
  v_mfma_f32_16x16x32_bf16 v[80:83], v[140:143], a[112:115], v[80:83]
  v_mfma_f32_16x16x32_bf16 v[84:87], v[140:143], a[116:119], v[84:87]
  v_mfma_f32_16x16x32_bf16 v[88:91], v[140:143], a[120:123], v[88:91]
  v_mfma_f32_16x16x32_bf16 v[92:95], v[140:143], a[124:127], v[92:95]
  s_waitcnt vmcnt(11)
  v_mfma_f32_16x16x32_bf16 v[80:83], v[144:147], a[128:131], v[80:83]
  v_mfma_f32_16x16x32_bf16 v[84:87], v[144:147], a[132:135], v[84:87]
  v_mfma_f32_16x16x32_bf16 v[88:91], v[144:147], a[136:139], v[88:91]
  v_mfma_f32_16x16x32_bf16 v[92:95], v[144:147], a[140:143], v[92:95]
  s_waitcnt vmcnt(10)
  v_mfma_f32_16x16x32_bf16 v[80:83], v[148:151], a[144:147], v[80:83]
  v_mfma_f32_16x16x32_bf16 v[84:87], v[148:151], a[148:151], v[84:87]
  v_mfma_f32_16x16x32_bf16 v[88:91], v[148:151], a[152:155], v[88:91]
  v_mfma_f32_16x16x32_bf16 v[92:95], v[148:151], a[156:159], v[92:95]
  s_waitcnt vmcnt(8)
  s_mov_b64 exec, 1
  v_mov_b32 v9, 0
  v_mov_b32 v10, s90
  v_mov_b32 v11, s91
  buffer_store_dwordx2 v[10:11], v9, s[92:95], s30 offen offset:256 sc1
  s_mov_b64 exec, -1
  v_mfma_f32_16x16x32_bf16 v[80:83], v[152:155], a[160:163], v[80:83]
  v_mfma_f32_16x16x32_bf16 v[84:87], v[152:155], a[164:167], v[84:87]
  buffer_store_dwordx4 v[196:199], v7, s[16:19], s27 offen offset:512 sc1
  s_add_u32 s27, s27, 0x2000
  v_mfma_f32_16x16x32_bf16 v[88:91], v[152:155], a[168:171], v[88:91]
  v_mfma_f32_16x16x32_bf16 v[92:95], v[152:155], a[172:175], v[92:95]
  s_waitcnt vmcnt(9)
  v_mfma_f32_16x16x32_bf16 v[80:83], v[156:159], a[176:179], v[80:83]
  v_mfma_f32_16x16x32_bf16 v[84:87], v[156:159], a[180:183], v[84:87]
  v_mfma_f32_16x16x32_bf16 v[88:91], v[156:159], a[184:187], v[88:91]
  v_mfma_f32_16x16x32_bf16 v[92:95], v[156:159], a[188:191], v[92:95]
  s_waitcnt vmcnt(8)
  v_mfma_f32_16x16x32_bf16 v[80:83], v[160:163], a[192:195], v[80:83]
  v_mfma_f32_16x16x32_bf16 v[84:87], v[160:163], a[196:199], v[84:87]
  v_mfma_f32_16x16x32_bf16 v[88:91], v[160:163], a[200:203], v[88:91]
  v_mfma_f32_16x16x32_bf16 v[92:95], v[160:163], a[204:207], v[92:95]
  s_waitcnt vmcnt(7)
  v_mfma_f32_16x16x32_bf16 v[80:83], v[164:167], a[208:211], v[80:83]
  v_mfma_f32_16x16x32_bf16 v[84:87], v[164:167], a[212:215], v[84:87]
  v_mfma_f32_16x16x32_bf16 v[88:91], v[164:167], a[216:219], v[88:91]
  v_mfma_f32_16x16x32_bf16 v[92:95], v[164:167], a[220:223], v[92:95]
  s_waitcnt vmcnt(6)
  v_mfma_f32_16x16x32_bf16 v[80:83], v[168:171], a[224:227], v[80:83]
  v_mfma_f32_16x16x32_bf16 v[84:87], v[168:171], a[228:231], v[84:87]
  v_mfma_f32_16x16x32_bf16 v[88:91], v[168:171], a[232:235], v[88:91]
  v_mfma_f32_16x16x32_bf16 v[92:95], v[168:171], a[236:239], v[92:95]
  s_waitcnt vmcnt(5)
  v_mfma_f32_16x16x32_bf16 v[80:83], v[172:175], a[240:243], v[80:83]
  v_mfma_f32_16x16x32_bf16 v[84:87], v[172:175], a[244:247], v[84:87]
  v_mfma_f32_16x16x32_bf16 v[88:91], v[172:175], a[248:251], v[88:91]
  v_mfma_f32_16x16x32_bf16 v[92:95], v[172:175], a[252:255], v[92:95]
  s_waitcnt vmcnt(4)
  v_mfma_f32_16x16x32_bf16 v[80:83], v[176:179], v[16:19], v[80:83]
  v_mfma_f32_16x16x32_bf16 v[84:87], v[176:179], v[20:23], v[84:87]
  v_mfma_f32_16x16x32_bf16 v[88:91], v[176:179], v[24:27], v[88:91]
  v_mfma_f32_16x16x32_bf16 v[92:95], v[176:179], v[28:31], v[92:95]
  s_waitcnt vmcnt(3)
  v_mfma_f32_16x16x32_bf16 v[80:83], v[180:183], v[32:35], v[80:83]
  v_mfma_f32_16x16x32_bf16 v[84:87], v[180:183], v[36:39], v[84:87]
  v_mfma_f32_16x16x32_bf16 v[88:91], v[180:183], v[40:43], v[88:91]
  v_mfma_f32_16x16x32_bf16 v[92:95], v[180:183], v[44:47], v[92:95]
  s_nop 7
  v_cvt_pk_bf16_f32 v192, v80, v81
  v_cvt_pk_bf16_f32 v193, v82, v83
  v_cvt_pk_bf16_f32 v194, v84, v85
  v_cvt_pk_bf16_f32 v195, v86, v87
  v_cvt_pk_bf16_f32 v196, v88, v89
  v_cvt_pk_bf16_f32 v197, v90, v91
  v_cvt_pk_bf16_f32 v198, v92, v93
  v_cvt_pk_bf16_f32 v199, v94, v95
  s_nop 1
  v_permlane16_swap_b32 v192, v194
  v_permlane16_swap_b32 v193, v195
  v_permlane16_swap_b32 v196, v198
  v_permlane16_swap_b32 v197, v199
  buffer_store_dwordx4 v[192:195], v7, s[16:19], s27 offen sc1
  buffer_store_dwordx4 v[196:199], v7, s[16:19], s27 offen offset:512 sc1
  s_add_u32 s27, s27, 0x2000
  s_lshl_b32 s23, s22, 3
  v_and_b32 v6, 7, v0
  v_add_u32 v6, s23, v6
  v_lshrrev_b32 v7, 3, v0
  s_lshl_b32 s24, s20, 3
  v_add_u32 v7, s24, v7
  v_lshlrev_b32 v2, 4, v6
  v_lshl_add_u32 v2, v7, 10, v2
  v_mul_u32_u24 v4, 1152, v6
  v_lshl_add_u32 v4, v7, 4, v4
  v_lshrrev_b32 v7, 5, v0
  s_lshl_b32 s24, s20, 1
  v_add_u32 v7, s24, v7
  v_add_u32 v8, s23, v7
  v_bfe_u32 v9, v0, 2, 3
  v_bfe_u32 v10, v0, 3, 2
  v_and_b32 v11, 3, v0
  s_cmp_eq_u32 s3, 0
  s_cselect_b64 vcc, -1, 0
  v_cndmask_b32 v6, v8, v6, vcc
  v_cndmask_b32 v7, v9, v7, vcc
  v_cndmask_b32 v10, v11, v10, vcc
  v_add_u32 v7, 64, v7
  v_lshlrev_b32 v3, 4, v6
  v_lshl_add_u32 v3, v7, 10, v3
  v_mul_u32_u24 v5, 1152, v6
  v_lshl_add_u32 v5, v7, 4, v5
  v_lshl_add_u32 v3, v10, 2, v3
  v_lshl_add_u32 v5, v10, 2, v5
  s_mul_i32 s24, s21, 73728
  s_add_u32 s25, s24, s3
  s_add_u32 s4, s96, s25
  s_addc_u32 s5, s97, 0
  s_mov_b32 s6, 0x025d2000
  s_mov_b32 s7, 0x00020000
  s_add_u32 s8, s4, 0x00e00000
  s_addc_u32 s9, s5, 0
  s_add_u32 s26, s100, s24
  s_addc_u32 s27, s101, 0
  s_cmp_eq_u32 s3, 0
  s_cselect_b32 s8, s8, s26
  s_cselect_b32 s9, s9, s27
  s_mov_b32 s28, 512
  s_cselect_b32 s28, 0x8000, s28
  s_cselect_b64 vcc, -1, 0
  s_mov_b32 s10, 0x00012000
  s_mov_b32 s11, 0x00020000
  v_cndmask_b32 v4, v4, v2, vcc
  v_cndmask_b32 v5, v5, v3, vcc
  v_lshlrev_b32 v9, 3, v0
  buffer_load_dwordx2 v[10:11], v9, s[92:95], s31 offen sc1
  s_mov_b32 s32, 0x00003f80
  s_mov_b32 s33, 0x3f800000
  v_mov_b32 v110, 0
  v_mov_b32 v111, 0
  v_mov_b32 v112, 0
  v_mov_b32 v113, 0
  v_mov_b32 v114, 0
  v_mov_b32 v115, 0
  v_mov_b32 v116, 0
  v_mov_b32 v117, 0
  v_mov_b32 v118, 0
  v_mov_b32 v119, 0
  v_mov_b32 v120, 0
  v_mov_b32 v121, 0
  v_mov_b32 v122, 0
  v_mov_b32 v123, 0
  v_mov_b32 v124, 0
  v_mov_b32 v125, 0
  v_mov_b32 v126, 0
  v_mov_b32 v127, 0
  s_waitcnt vmcnt(0)
  v_cmp_ne_u64 vcc, s[90:91], v[10:11]
  s_nop 3
  s_cmp_eq_u32 vcc_lo, 0
  s_cselect_b32 s34, 1, 0
  s_cmp_eq_u32 vcc_hi, 0
  s_cselect_b32 s35, 1, 0
  s_cmp_eq_u32 s20, 3
  s_cselect_b32 s35, 0, s35
  s_waitcnt vmcnt(0)
  s_barrier
  s_cmp_lg_u32 s20, 0
  s_cbranch_scc1 pub10
  s_lshl_b32 s23, s21, 3
  s_add_u32 s23, s23, s22
  s_lshl_b32 s23, s23, 6
  s_add_u32 s23, s23, 65536
  s_add_u32 s23, s23, s14
  s_mov_b64 exec, 1
  v_mov_b32 v9, 0
  v_mov_b32 v10, s90
  v_mov_b32 v11, s91
  buffer_store_dwordx2 v[10:11], v9, s[92:95], s23 offen sc1
  s_mov_b64 exec, -1
pub10:
  s_cmp_eq_u32 s34, 0
  s_cbranch_scc1 red_noearly
  s_mov_b32 s25, 0x01100000
  buffer_load_dwordx4 v[16:19], v2, s[4:7], s25 offen sc1
  s_add_u32 s25, s25, 0x00240000
  buffer_load_dwordx4 v[26:29], v2, s[4:7], s25 offen sc1
  s_add_u32 s25, s25, 0x00240000
  buffer_load_dwordx4 v[36:39], v2, s[4:7], s25 offen sc1
  s_add_u32 s25, s25, 0x00240000
  buffer_load_dwordx4 v[46:49], v2, s[4:7], s25 offen sc1
  s_add_u32 s25, s25, 0x00240000
  buffer_load_dwordx4 v[56:59], v2, s[4:7], s25 offen sc1
  s_add_u32 s25, s25, 0x00240000
  buffer_load_dwordx4 v[66:69], v2, s[4:7], s25 offen sc1
  s_add_u32 s25, s25, 0x00240000
  buffer_load_dwordx4 v[76:79], v2, s[4:7], s25 offen sc1
  s_add_u32 s25, s25, 0x00240000
  buffer_load_dwordx4 v[86:89], v2, s[4:7], s25 offen sc1
red_noearly:
  s_mov_b32 s25, 0x00b00000
  buffer_load_dwordx4 v[96:99], v2, s[4:7], s25 offen sc1
  s_add_u32 s26, s25, 0x8000
  buffer_load_dwordx4 v[100:103], v2, s[4:7], s26 offen sc1
  buffer_load_dword v104, v3, s[4:7], s25 offen sc1
  s_cmp_eq_u32 s35, 0
  s_cbranch_scc1 red_noearly1
  s_mov_b32 s25, 0x01100000
  s_add_u32 s26, s25, 0x8000
  buffer_load_dwordx4 v[20:23], v2, s[4:7], s26 offen sc1
  s_add_u32 s25, s25, 0x00240000
  s_add_u32 s26, s25, 0x8000
  buffer_load_dwordx4 v[30:33], v2, s[4:7], s26 offen sc1
  s_add_u32 s25, s25, 0x00240000
  s_add_u32 s26, s25, 0x8000
  buffer_load_dwordx4 v[40:43], v2, s[4:7], s26 offen sc1
  s_add_u32 s25, s25, 0x00240000
  s_add_u32 s26, s25, 0x8000
  buffer_load_dwordx4 v[50:53], v2, s[4:7], s26 offen sc1
  s_add_u32 s25, s25, 0x00240000
  s_add_u32 s26, s25, 0x8000
  buffer_load_dwordx4 v[60:63], v2, s[4:7], s26 offen sc1
  s_add_u32 s25, s25, 0x00240000
  s_add_u32 s26, s25, 0x8000
  buffer_load_dwordx4 v[70:73], v2, s[4:7], s26 offen sc1
  s_add_u32 s25, s25, 0x00240000
  s_add_u32 s26, s25, 0x8000
  buffer_load_dwordx4 v[80:83], v2, s[4:7], s26 offen sc1
  s_add_u32 s25, s25, 0x00240000
  s_add_u32 s26, s25, 0x8000
  buffer_load_dwordx4 v[90:93], v2, s[4:7], s26 offen sc1
red_noearly1:
  s_cmp_lg_u32 s3, 0
  s_cbranch_scc1 red_noa
  s_and_b32 s45, s2, 7
  s_lshr_b32 s46, s2, 3
  s_and_b32 s37, s45, 1
  s_lshl_b32 s37, s37, 2
  s_and_b32 s47, s46, 3
  s_add_u32 s37, s37, s47
  s_lshr_b32 s44, s46, 2
  s_lshr_b32 s36, s45, 1
  s_lshl_b32 s36, s36, 3
  s_add_u32 s36, s36, s44
  s_lshl_b32 s38, s37, 2
  s_add_u32 s38, s38, s20
  s_mul_i32 s38, s38, 73728
  s_add_u32 s38, s38, 0x06000000
  s_add_u32 s76, s96, s38
  s_addc_u32 s77, s97, 0
  s_mov_b32 s78, 0x00012000
  s_mov_b32 s79, 0x00020000
  s_mov_b32 s80, 0
  s_cmp_eq_u32 s20, 3
  s_cbranch_scc1 red_noa
  buffer_load_dwordx4 a[0:3], v1, s[76:79], s80 offen sc1
  buffer_load_dwordx4 a[4:7], v1, s[76:79], s80 offen offset:1024 sc1
  buffer_load_dwordx4 a[8:11], v1, s[76:79], s80 offen offset:2048 sc1
  buffer_load_dwordx4 a[12:15], v1, s[76:79], s80 offen offset:3072 sc1
  s_add_u32 s80, s80, 0x1000
  buffer_load_dwordx4 a[16:19], v1, s[76:79], s80 offen sc1
  buffer_load_dwordx4 a[20:23], v1, s[76:79], s80 offen offset:1024 sc1
  buffer_load_dwordx4 a[24:27], v1, s[76:79], s80 offen offset:2048 sc1
  buffer_load_dwordx4 a[28:31], v1, s[76:79], s80 offen offset:3072 sc1
  s_add_u32 s80, s80, 0x1000
  buffer_load_dwordx4 a[32:35], v1, s[76:79], s80 offen sc1
  buffer_load_dwordx4 a[36:39], v1, s[76:79], s80 offen offset:1024 sc1
  buffer_load_dwordx4 a[40:43], v1, s[76:79], s80 offen offset:2048 sc1
  buffer_load_dwordx4 a[44:47], v1, s[76:79], s80 offen offset:3072 sc1
  s_add_u32 s80, s80, 0x1000
  buffer_load_dwordx4 a[48:51], v1, s[76:79], s80 offen sc1
  buffer_load_dwordx4 a[52:55], v1, s[76:79], s80 offen offset:1024 sc1
  buffer_load_dwordx4 a[56:59], v1, s[76:79], s80 offen offset:2048 sc1
  buffer_load_dwordx4 a[60:63], v1, s[76:79], s80 offen offset:3072 sc1
  s_add_u32 s80, s80, 0x1000
  buffer_load_dwordx4 a[64:67], v1, s[76:79], s80 offen sc1
  buffer_load_dwordx4 a[68:71], v1, s[76:79], s80 offen offset:1024 sc1
  buffer_load_dwordx4 a[72:75], v1, s[76:79], s80 offen offset:2048 sc1
  buffer_load_dwordx4 a[76:79], v1, s[76:79], s80 offen offset:3072 sc1
  s_add_u32 s80, s80, 0x1000
red_noa:
  s_cmp_lg_u32 s20, 3
  s_cbranch_scc1 wt11_d
  v_and_b32 v9, 7, v0
  s_lshl_b32 s23, s21, 3
  v_add_u32 v9, s23, v9
  v_lshlrev_b32 v9, 6, v9
  s_add_u32 s23, s14, 0x00010000
  v_add_u32 v9, s23, v9
  s_mov_b32 s23, 0x10000
wt11_l:
  buffer_load_dwordx2 v[10:11], v9, s[92:95], 0 offen sc1
  s_waitcnt vmcnt(0)
  v_cmp_ne_u64 vcc, s[90:91], v[10:11]
  s_sub_u32 s23, s23, 1
  s_cselect_b64 s[24:25], 0, -1
  s_nop 1
  s_and_b64 vcc, vcc, s[24:25]
  s_cbranch_vccnz wt11_l
wt11_d:
  s_barrier
  s_cmp_lg_u32 s3, 0
  s_cbranch_scc1 red_noa2
  s_cmp_lg_u32 s20, 3
  s_cbranch_scc1 red_noa2
  buffer_load_dwordx4 a[0:3], v1, s[76:79], s80 offen sc1
  buffer_load_dwordx4 a[4:7], v1, s[76:79], s80 offen offset:1024 sc1
  buffer_load_dwordx4 a[8:11], v1, s[76:79], s80 offen offset:2048 sc1
  buffer_load_dwordx4 a[12:15], v1, s[76:79], s80 offen offset:3072 sc1
  s_add_u32 s80, s80, 0x1000
  buffer_load_dwordx4 a[16:19], v1, s[76:79], s80 offen sc1
  buffer_load_dwordx4 a[20:23], v1, s[76:79], s80 offen offset:1024 sc1
  buffer_load_dwordx4 a[24:27], v1, s[76:79], s80 offen offset:2048 sc1
  buffer_load_dwordx4 a[28:31], v1, s[76:79], s80 offen offset:3072 sc1
  s_add_u32 s80, s80, 0x1000
  buffer_load_dwordx4 a[32:35], v1, s[76:79], s80 offen sc1
  buffer_load_dwordx4 a[36:39], v1, s[76:79], s80 offen offset:1024 sc1
  buffer_load_dwordx4 a[40:43], v1, s[76:79], s80 offen offset:2048 sc1
  buffer_load_dwordx4 a[44:47], v1, s[76:79], s80 offen offset:3072 sc1
  s_add_u32 s80, s80, 0x1000
  buffer_load_dwordx4 a[48:51], v1, s[76:79], s80 offen sc1
  buffer_load_dwordx4 a[52:55], v1, s[76:79], s80 offen offset:1024 sc1
  buffer_load_dwordx4 a[56:59], v1, s[76:79], s80 offen offset:2048 sc1
  buffer_load_dwordx4 a[60:63], v1, s[76:79], s80 offen offset:3072 sc1
  s_add_u32 s80, s80, 0x1000
  buffer_load_dwordx4 a[64:67], v1, s[76:79], s80 offen sc1
  buffer_load_dwordx4 a[68:71], v1, s[76:79], s80 offen offset:1024 sc1
  buffer_load_dwordx4 a[72:75], v1, s[76:79], s80 offen offset:2048 sc1
  buffer_load_dwordx4 a[76:79], v1, s[76:79], s80 offen offset:3072 sc1
  s_add_u32 s80, s80, 0x1000
red_noa2:
  s_mov_b32 s25, 0x01100000
  buffer_load_dword v24, v3, s[4:7], s25 offen sc1
  s_add_u32 s25, s25, 0x00240000
  buffer_load_dword v34, v3, s[4:7], s25 offen sc1
  s_add_u32 s25, s25, 0x00240000
  buffer_load_dword v44, v3, s[4:7], s25 offen sc1
  s_add_u32 s25, s25, 0x00240000
  buffer_load_dword v54, v3, s[4:7], s25 offen sc1
  s_add_u32 s25, s25, 0x00240000
  buffer_load_dword v64, v3, s[4:7], s25 offen sc1
  s_add_u32 s25, s25, 0x00240000
  buffer_load_dword v74, v3, s[4:7], s25 offen sc1
  s_add_u32 s25, s25, 0x00240000
  buffer_load_dword v84, v3, s[4:7], s25 offen sc1
  s_add_u32 s25, s25, 0x00240000
  buffer_load_dword v94, v3, s[4:7], s25 offen sc1
  s_cmp_lg_u32 s35, 0
  s_cbranch_scc1 red_haveearly1
  s_mov_b32 s25, 0x01100000
  s_add_u32 s26, s25, 0x8000
  buffer_load_dwordx4 v[20:23], v2, s[4:7], s26 offen sc1
  s_add_u32 s25, s25, 0x00240000
  s_add_u32 s26, s25, 0x8000
  buffer_load_dwordx4 v[30:33], v2, s[4:7], s26 offen sc1
  s_add_u32 s25, s25, 0x00240000
  s_add_u32 s26, s25, 0x8000
  buffer_load_dwordx4 v[40:43], v2, s[4:7], s26 offen sc1
  s_add_u32 s25, s25, 0x00240000
  s_add_u32 s26, s25, 0x8000
  buffer_load_dwordx4 v[50:53], v2, s[4:7], s26 offen sc1
  s_add_u32 s25, s25, 0x00240000
  s_add_u32 s26, s25, 0x8000
  buffer_load_dwordx4 v[60:63], v2, s[4:7], s26 offen sc1
  s_add_u32 s25, s25, 0x00240000
  s_add_u32 s26, s25, 0x8000
  buffer_load_dwordx4 v[70:73], v2, s[4:7], s26 offen sc1
  s_add_u32 s25, s25, 0x00240000
  s_add_u32 s26, s25, 0x8000
  buffer_load_dwordx4 v[80:83], v2, s[4:7], s26 offen sc1
  s_add_u32 s25, s25, 0x00240000
  s_add_u32 s26, s25, 0x8000
  buffer_load_dwordx4 v[90:93], v2, s[4:7], s26 offen sc1
red_haveearly1:
  s_cmp_lg_u32 s34, 0
  s_cbranch_scc1 red_haveearly
  s_mov_b32 s25, 0x01100000
  buffer_load_dwordx4 v[16:19], v2, s[4:7], s25 offen sc1
  s_add_u32 s25, s25, 0x00240000
  buffer_load_dwordx4 v[26:29], v2, s[4:7], s25 offen sc1
  s_add_u32 s25, s25, 0x00240000
  buffer_load_dwordx4 v[36:39], v2, s[4:7], s25 offen sc1
  s_add_u32 s25, s25, 0x00240000
  buffer_load_dwordx4 v[46:49], v2, s[4:7], s25 offen sc1
  s_add_u32 s25, s25, 0x00240000
  buffer_load_dwordx4 v[56:59], v2, s[4:7], s25 offen sc1
  s_add_u32 s25, s25, 0x00240000
  buffer_load_dwordx4 v[66:69], v2, s[4:7], s25 offen sc1
  s_add_u32 s25, s25, 0x00240000
  buffer_load_dwordx4 v[76:79], v2, s[4:7], s25 offen sc1
  s_add_u32 s25, s25, 0x00240000
  buffer_load_dwordx4 v[86:89], v2, s[4:7], s25 offen sc1
  s_waitcnt vmcnt(0)
red_haveearly:
  s_waitcnt vmcnt(16)
  s_cmp_eq_u32 s35, 0
  s_cbranch_scc1 red_w
  s_waitcnt vmcnt(8)
red_w:
  v_dot2c_f32_bf16 v110, s32, v16
  v_dot2c_f32_bf16 v111, s33, v16
  v_dot2c_f32_bf16 v112, s32, v17
  v_dot2c_f32_bf16 v113, s33, v17
  v_dot2c_f32_bf16 v114, s32, v18
  v_dot2c_f32_bf16 v115, s33, v18
  v_dot2c_f32_bf16 v116, s32, v19
  v_dot2c_f32_bf16 v117, s33, v19
  v_dot2c_f32_bf16 v110, s32, v26
  v_dot2c_f32_bf16 v111, s33, v26
  v_dot2c_f32_bf16 v112, s32, v27
  v_dot2c_f32_bf16 v113, s33, v27
  v_dot2c_f32_bf16 v114, s32, v28
  v_dot2c_f32_bf16 v115, s33, v28
  v_dot2c_f32_bf16 v116, s32, v29
  v_dot2c_f32_bf16 v117, s33, v29
  v_dot2c_f32_bf16 v110, s32, v36
  v_dot2c_f32_bf16 v111, s33, v36
  v_dot2c_f32_bf16 v112, s32, v37
  v_dot2c_f32_bf16 v113, s33, v37
  v_dot2c_f32_bf16 v114, s32, v38
  v_dot2c_f32_bf16 v115, s33, v38
  v_dot2c_f32_bf16 v116, s32, v39
  v_dot2c_f32_bf16 v117, s33, v39
  v_dot2c_f32_bf16 v110, s32, v46
  v_dot2c_f32_bf16 v111, s33, v46
  v_dot2c_f32_bf16 v112, s32, v47
  v_dot2c_f32_bf16 v113, s33, v47
  v_dot2c_f32_bf16 v114, s32, v48
  v_dot2c_f32_bf16 v115, s33, v48
  v_dot2c_f32_bf16 v116, s32, v49
  v_dot2c_f32_bf16 v117, s33, v49
  v_dot2c_f32_bf16 v110, s32, v56
  v_dot2c_f32_bf16 v111, s33, v56
  v_dot2c_f32_bf16 v112, s32, v57
  v_dot2c_f32_bf16 v113, s33, v57
  v_dot2c_f32_bf16 v114, s32, v58
  v_dot2c_f32_bf16 v115, s33, v58
  v_dot2c_f32_bf16 v116, s32, v59
  v_dot2c_f32_bf16 v117, s33, v59
  v_dot2c_f32_bf16 v110, s32, v66
  v_dot2c_f32_bf16 v111, s33, v66
  v_dot2c_f32_bf16 v112, s32, v67
  v_dot2c_f32_bf16 v113, s33, v67
  v_dot2c_f32_bf16 v114, s32, v68
  v_dot2c_f32_bf16 v115, s33, v68
  v_dot2c_f32_bf16 v116, s32, v69
  v_dot2c_f32_bf16 v117, s33, v69
  v_dot2c_f32_bf16 v110, s32, v76
  v_dot2c_f32_bf16 v111, s33, v76
  v_dot2c_f32_bf16 v112, s32, v77
  v_dot2c_f32_bf16 v113, s33, v77
  v_dot2c_f32_bf16 v114, s32, v78
  v_dot2c_f32_bf16 v115, s33, v78
  v_dot2c_f32_bf16 v116, s32, v79
  v_dot2c_f32_bf16 v117, s33, v79
  v_dot2c_f32_bf16 v110, s32, v86
  v_dot2c_f32_bf16 v111, s33, v86
  v_dot2c_f32_bf16 v112, s32, v87
  v_dot2c_f32_bf16 v113, s33, v87
  v_dot2c_f32_bf16 v114, s32, v88
  v_dot2c_f32_bf16 v115, s33, v88
  v_dot2c_f32_bf16 v116, s32, v89
  v_dot2c_f32_bf16 v117, s33, v89
  v_dot2c_f32_bf16 v110, s32, v96
  v_dot2c_f32_bf16 v111, s33, v96
  v_dot2c_f32_bf16 v112, s32, v97
  v_dot2c_f32_bf16 v113, s33, v97
  v_dot2c_f32_bf16 v114, s32, v98
  v_dot2c_f32_bf16 v115, s33, v98
  v_dot2c_f32_bf16 v116, s32, v99
  v_dot2c_f32_bf16 v117, s33, v99
  v_dot2c_f32_bf16 v118, s32, v100
  v_dot2c_f32_bf16 v119, s33, v100
  v_dot2c_f32_bf16 v120, s32, v101
  v_dot2c_f32_bf16 v121, s33, v101
  v_dot2c_f32_bf16 v122, s32, v102
  v_dot2c_f32_bf16 v123, s33, v102
  v_dot2c_f32_bf16 v124, s32, v103
  v_dot2c_f32_bf16 v125, s33, v103
  v_dot2c_f32_bf16 v126, s32, v104
  v_dot2c_f32_bf16 v127, s33, v104
  s_waitcnt vmcnt(0)
  v_dot2c_f32_bf16 v118, s32, v20
  v_dot2c_f32_bf16 v119, s33, v20
  v_dot2c_f32_bf16 v120, s32, v21
  v_dot2c_f32_bf16 v121, s33, v21
  v_dot2c_f32_bf16 v122, s32, v22
  v_dot2c_f32_bf16 v123, s33, v22
  v_dot2c_f32_bf16 v124, s32, v23
  v_dot2c_f32_bf16 v125, s33, v23
  v_dot2c_f32_bf16 v126, s32, v24
  v_dot2c_f32_bf16 v127, s33, v24
  v_dot2c_f32_bf16 v118, s32, v30
  v_dot2c_f32_bf16 v119, s33, v30
  v_dot2c_f32_bf16 v120, s32, v31
  v_dot2c_f32_bf16 v121, s33, v31
  v_dot2c_f32_bf16 v122, s32, v32
  v_dot2c_f32_bf16 v123, s33, v32
  v_dot2c_f32_bf16 v124, s32, v33
  v_dot2c_f32_bf16 v125, s33, v33
  v_dot2c_f32_bf16 v126, s32, v34
  v_dot2c_f32_bf16 v127, s33, v34
  v_dot2c_f32_bf16 v118, s32, v40
  v_dot2c_f32_bf16 v119, s33, v40
  v_dot2c_f32_bf16 v120, s32, v41
  v_dot2c_f32_bf16 v121, s33, v41
  v_dot2c_f32_bf16 v122, s32, v42
  v_dot2c_f32_bf16 v123, s33, v42
  v_dot2c_f32_bf16 v124, s32, v43
  v_dot2c_f32_bf16 v125, s33, v43
  v_dot2c_f32_bf16 v126, s32, v44
  v_dot2c_f32_bf16 v127, s33, v44
  v_dot2c_f32_bf16 v118, s32, v50
  v_dot2c_f32_bf16 v119, s33, v50
  v_dot2c_f32_bf16 v120, s32, v51
  v_dot2c_f32_bf16 v121, s33, v51
  v_dot2c_f32_bf16 v122, s32, v52
  v_dot2c_f32_bf16 v123, s33, v52
  v_dot2c_f32_bf16 v124, s32, v53
  v_dot2c_f32_bf16 v125, s33, v53
  v_dot2c_f32_bf16 v126, s32, v54
  v_dot2c_f32_bf16 v127, s33, v54
  v_dot2c_f32_bf16 v118, s32, v60
  v_dot2c_f32_bf16 v119, s33, v60
  v_dot2c_f32_bf16 v120, s32, v61
  v_dot2c_f32_bf16 v121, s33, v61
  v_dot2c_f32_bf16 v122, s32, v62
  v_dot2c_f32_bf16 v123, s33, v62
  v_dot2c_f32_bf16 v124, s32, v63
  v_dot2c_f32_bf16 v125, s33, v63
  v_dot2c_f32_bf16 v126, s32, v64
  v_dot2c_f32_bf16 v127, s33, v64
  v_dot2c_f32_bf16 v118, s32, v70
  v_dot2c_f32_bf16 v119, s33, v70
  v_dot2c_f32_bf16 v120, s32, v71
  v_dot2c_f32_bf16 v121, s33, v71
  v_dot2c_f32_bf16 v122, s32, v72
  v_dot2c_f32_bf16 v123, s33, v72
  v_dot2c_f32_bf16 v124, s32, v73
  v_dot2c_f32_bf16 v125, s33, v73
  v_dot2c_f32_bf16 v126, s32, v74
  v_dot2c_f32_bf16 v127, s33, v74
  v_dot2c_f32_bf16 v118, s32, v80
  v_dot2c_f32_bf16 v119, s33, v80
  v_dot2c_f32_bf16 v120, s32, v81
  v_dot2c_f32_bf16 v121, s33, v81
  v_dot2c_f32_bf16 v122, s32, v82
  v_dot2c_f32_bf16 v123, s33, v82
  v_dot2c_f32_bf16 v124, s32, v83
  v_dot2c_f32_bf16 v125, s33, v83
  v_dot2c_f32_bf16 v126, s32, v84
  v_dot2c_f32_bf16 v127, s33, v84
  v_dot2c_f32_bf16 v118, s32, v90
  v_dot2c_f32_bf16 v119, s33, v90
  v_dot2c_f32_bf16 v120, s32, v91
  v_dot2c_f32_bf16 v121, s33, v91
  v_dot2c_f32_bf16 v122, s32, v92
  v_dot2c_f32_bf16 v123, s33, v92
  v_dot2c_f32_bf16 v124, s32, v93
  v_dot2c_f32_bf16 v125, s33, v93
  v_dot2c_f32_bf16 v126, s32, v94
  v_dot2c_f32_bf16 v127, s33, v94
  s_nop 2
  v_cvt_pk_bf16_f32 v16, v110, v111
  v_cvt_pk_bf16_f32 v17, v112, v113
  v_cvt_pk_bf16_f32 v18, v114, v115
  v_cvt_pk_bf16_f32 v19, v116, v117
  v_cvt_pk_bf16_f32 v20, v118, v119
  v_cvt_pk_bf16_f32 v21, v120, v121
  v_cvt_pk_bf16_f32 v22, v122, v123
  v_cvt_pk_bf16_f32 v23, v124, v125
  v_cvt_pk_bf16_f32 v24, v126, v127
  buffer_store_dwordx4 v[16:19], v4, s[8:11], 0 offen sc1
  buffer_store_dwordx4 v[20:23], v4, s[8:11], s28 offen sc1
  buffer_store_dword v24, v5, s[8:11], 0 offen sc1
  s_cmp_lg_u32 s3, 0
  s_cbranch_scc1 mega_end
  v_mov_b32 v130, 0
  v_mov_b32 v132, 0
  s_mov_b32 s29, 0x3f803f80
  v_dot2c_f32_bf16 v130, s29, v16
  v_dot2c_f32_bf16 v132, v16, v16
  v_dot2c_f32_bf16 v130, s29, v17
  v_dot2c_f32_bf16 v132, v17, v17
  v_dot2c_f32_bf16 v130, s29, v18
  v_dot2c_f32_bf16 v132, v18, v18
  v_dot2c_f32_bf16 v130, s29, v19
  v_dot2c_f32_bf16 v132, v19, v19
  v_dot2c_f32_bf16 v130, s29, v20
  v_dot2c_f32_bf16 v132, v20, v20
  v_dot2c_f32_bf16 v130, s29, v21
  v_dot2c_f32_bf16 v132, v21, v21
  v_dot2c_f32_bf16 v130, s29, v22
  v_dot2c_f32_bf16 v132, v22, v22
  v_dot2c_f32_bf16 v130, s29, v23
  v_dot2c_f32_bf16 v132, v23, v23
  v_dot2c_f32_bf16 v130, s29, v24
  v_dot2c_f32_bf16 v132, v24, v24
  s_nop 1
  s_nop 1
  v_add_f32_dpp v130, v130, v130 row_ror:8 row_mask:0xf bank_mask:0xf
  v_add_f32_dpp v132, v132, v132 row_ror:8 row_mask:0xf bank_mask:0xf
  v_mov_b32 v131, v130
  v_mov_b32 v133, v132
  s_nop 1
  v_permlane16_swap_b32 v130, v131
  v_permlane16_swap_b32 v132, v133
  s_nop 1
  v_add_f32 v130, v130, v131
  v_add_f32 v132, v132, v133
  v_mov_b32 v131, v130
  v_mov_b32 v133, v132
  s_nop 1
  v_permlane32_swap_b32 v130, v131
  v_permlane32_swap_b32 v132, v133
  s_nop 1
  v_add_f32 v130, v130, v131
  v_add_f32 v132, v132, v133
  v_and_b32 v138, 7, v0
  v_lshlrev_b32 v138, 3, v138
  v_add_u32 v138, 73728, v138
  s_lshl_b32 s23, s20, 6
  v_add_u32 v139, s23, v138
  v_mov_b32 v131, v132
  ds_write_b64 v139, v[130:131]
  s_waitcnt lgkmcnt(0)
  s_barrier
  ds_read_b64 v[140:141], v138 offset:0
  ds_read_b64 v[142:143], v138 offset:64
  ds_read_b64 v[144:145], v138 offset:128
  ds_read_b64 v[146:147], v138 offset:192
  s_add_u32 s8, s4, 0x02400000
  s_addc_u32 s9, s5, 0
  v_lshlrev_b32 v110, 16, v16
  v_and_b32 v111, 0xffff0000, v16
  v_lshlrev_b32 v112, 16, v17
  v_and_b32 v113, 0xffff0000, v17
  v_lshlrev_b32 v114, 16, v18
  v_and_b32 v115, 0xffff0000, v18
  v_lshlrev_b32 v116, 16, v19
  v_and_b32 v117, 0xffff0000, v19
  v_lshlrev_b32 v118, 16, v20
  v_and_b32 v119, 0xffff0000, v20
  v_lshlrev_b32 v120, 16, v21
  v_and_b32 v121, 0xffff0000, v21
  v_lshlrev_b32 v122, 16, v22
  v_and_b32 v123, 0xffff0000, v22
  v_lshlrev_b32 v124, 16, v23
  v_and_b32 v125, 0xffff0000, v23
  v_lshlrev_b32 v126, 16, v24
  v_and_b32 v127, 0xffff0000, v24
  s_waitcnt lgkmcnt(0)
  v_add_f32 v130, v140, v142
  v_add_f32 v132, v141, v143
  v_add_f32 v144, v144, v146
  v_add_f32 v145, v145, v147
  v_add_f32 v130, v130, v144
  v_add_f32 v132, v132, v145
  v_mul_f32 v130, 0x3ae38e39, v130
  v_mul_f32 v132, 0x3ae38e39, v132
  v_fma_f32 v132, -v130, v130, v132
  v_max_f32 v132, 0, v132
  v_add_f32 v132, 0x3727c5ac, v132
  v_rsq_f32 v134, v132
  s_nop 0
  v_mul_f32 v136, v130, v134
  v_sub_f32 v136, 0, v136
  v_pk_fma_f32 v[110:111], v[110:111], v[134:135], v[136:137] op_sel_hi:[1,0,0]
  v_pk_fma_f32 v[112:113], v[112:113], v[134:135], v[136:137] op_sel_hi:[1,0,0]
  v_pk_fma_f32 v[114:115], v[114:115], v[134:135], v[136:137] op_sel_hi:[1,0,0]
  v_pk_fma_f32 v[116:117], v[116:117], v[134:135], v[136:137] op_sel_hi:[1,0,0]
  v_pk_fma_f32 v[118:119], v[118:119], v[134:135], v[136:137] op_sel_hi:[1,0,0]
  v_pk_fma_f32 v[120:121], v[120:121], v[134:135], v[136:137] op_sel_hi:[1,0,0]
  v_pk_fma_f32 v[122:123], v[122:123], v[134:135], v[136:137] op_sel_hi:[1,0,0]
  v_pk_fma_f32 v[124:125], v[124:125], v[134:135], v[136:137] op_sel_hi:[1,0,0]
  v_pk_fma_f32 v[126:127], v[126:127], v[134:135], v[136:137] op_sel_hi:[1,0,0]
  v_cvt_pk_bf16_f32 v28, v110, v111
  v_cvt_pk_bf16_f32 v29, v112, v113
  v_cvt_pk_bf16_f32 v30, v114, v115
  v_cvt_pk_bf16_f32 v31, v116, v117
  v_cvt_pk_bf16_f32 v32, v118, v119
  v_cvt_pk_bf16_f32 v33, v120, v121
  v_cvt_pk_bf16_f32 v34, v122, v123
  v_cvt_pk_bf16_f32 v35, v124, v125
  v_cvt_pk_bf16_f32 v36, v126, v127
  buffer_store_dwordx4 v[28:31], v4, s[8:11], 0 offen sc1
  buffer_store_dwordx4 v[32:35], v4, s[8:11], s28 offen sc1
  buffer_store_dword v36, v5, s[8:11], 0 offen sc1
  s_and_b32 s45, s2, 7
  s_lshr_b32 s46, s2, 3
  s_and_b32 s35, s45, 1
  s_lshl_b32 s35, s35, 2
  s_and_b32 s47, s46, 3
  s_add_u32 s35, s35, s47
  s_lshr_b32 s44, s46, 2
  s_lshr_b32 s34, s45, 1
  s_lshl_b32 s34, s34, 3
  s_add_u32 s34, s34, s44
  s_lshl_b32 s38, s35, 2
  s_add_u32 s38, s38, s20
  s_mul_i32 s38, s38, 73728
  s_add_u32 s38, s38, 0x06000000
  s_add_u32 s4, s96, s38
  s_addc_u32 s5, s97, 0
  s_mov_b32 s6, 0x00012000
  s_mov_b32 s7, 0x00020000
  s_mov_b32 s26, 20480
  buffer_load_dwordx4 a[80:83], v1, s[4:7], s26 offen sc1
  buffer_load_dwordx4 a[84:87], v1, s[4:7], s26 offen offset:1024 sc1
  buffer_load_dwordx4 a[88:91], v1, s[4:7], s26 offen offset:2048 sc1
  buffer_load_dwordx4 a[92:95], v1, s[4:7], s26 offen offset:3072 sc1
  s_add_u32 s26, s26, 0x1000
  buffer_load_dwordx4 a[96:99], v1, s[4:7], s26 offen sc1
  buffer_load_dwordx4 a[100:103], v1, s[4:7], s26 offen offset:1024 sc1
  buffer_load_dwordx4 a[104:107], v1, s[4:7], s26 offen offset:2048 sc1
  buffer_load_dwordx4 a[108:111], v1, s[4:7], s26 offen offset:3072 sc1
  s_add_u32 s26, s26, 0x1000
  s_waitcnt vmcnt(8)
  s_barrier
  s_cmp_lg_u32 s20, 0
  s_cbranch_scc1 pub12
  s_lshl_b32 s23, s21, 3
  s_add_u32 s23, s23, s22
  s_lshl_b32 s23, s23, 6
  s_add_u32 s23, s23, 81920
  s_add_u32 s23, s23, s14
  s_mov_b64 exec, 1
  v_mov_b32 v9, 0
  v_mov_b32 v10, s90
  v_mov_b32 v11, s91
  buffer_store_dwordx2 v[10:11], v9, s[92:95], s23 offen sc1
  s_mov_b64 exec, -1
pub12:
  s_mov_b32 s3, 0x02800000
  s_mov_b32 s14, 81920
  s_branch layer1
mega_end:
  s_endpgm
att_full:
  s_mov_b32 s15, 1
  s_waitcnt vmcnt(0)
  v_mov_b32 v17, v16
  v_mov_b32 v19, v18
  v_mfma_f32_32x32x16_bf16 v[104:119], a[52:55], v[28:31], 0
  v_mfma_f32_32x32x16_bf16 v[104:119], a[48:51], v[232:235], v[104:119]
  v_mfma_f32_32x32x16_bf16 v[120:135], a[8:11], v[24:27], 0
  v_mfma_f32_32x32x16_bf16 v[120:135], a[0:3], v[228:231], v[120:135]
  v_mfma_f32_32x32x16_bf16 v[136:151], a[16:19], v[24:27], 0
  v_mfma_f32_32x32x16_bf16 v[136:151], a[12:15], v[224:227], v[136:151]
  v_mfma_f32_32x32x16_bf16 v[152:167], a[16:19], v[28:31], 0
  v_mfma_f32_32x32x16_bf16 v[152:167], a[12:15], v[232:235], v[152:167]
  s_nop 11
  v_max3_f32 v18, v104, v105, v18
  v_max3_f32 v19, v106, v107, v19
  v_max3_f32 v18, v108, v109, v18
  v_max3_f32 v19, v110, v111, v19
  v_max3_f32 v18, v112, v113, v18
  v_max3_f32 v19, v114, v115, v19
  v_max3_f32 v18, v116, v117, v18
  v_max3_f32 v19, v118, v119, v19
  v_max3_f32 v16, v120, v121, v16
  v_max3_f32 v17, v122, v123, v17
  v_max3_f32 v16, v124, v125, v16
  v_max3_f32 v17, v126, v127, v17
  v_max3_f32 v16, v128, v129, v16
  v_max3_f32 v17, v130, v131, v17
  v_max3_f32 v16, v132, v133, v16
  v_max3_f32 v17, v134, v135, v17
  v_max3_f32 v16, v136, v137, v16
  v_max3_f32 v17, v138, v139, v17
  v_max3_f32 v16, v140, v141, v16
  v_max3_f32 v17, v142, v143, v17
  v_max3_f32 v16, v144, v145, v16
  v_max3_f32 v17, v146, v147, v17
  v_max3_f32 v16, v148, v149, v16
  v_max3_f32 v17, v150, v151, v17
  v_max3_f32 v18, v152, v153, v18
  v_max3_f32 v19, v154, v155, v19
  v_max3_f32 v18, v156, v157, v18
  v_max3_f32 v19, v158, v159, v19
  v_max3_f32 v18, v160, v161, v18
  v_max3_f32 v19, v162, v163, v19
  v_max3_f32 v18, v164, v165, v18
  v_max3_f32 v19, v166, v167, v19
  v_mfma_f32_32x32x16_bf16 v[104:119], a[20:23], v[24:27], 0
  v_mfma_f32_32x32x16_bf16 v[104:119], a[12:15], v[228:231], v[104:119]
  v_mfma_f32_32x32x16_bf16 v[120:135], a[20:23], v[28:31], 0
  v_mfma_f32_32x32x16_bf16 v[120:135], a[12:15], v[236:239], v[120:135]
  v_mfma_f32_32x32x16_bf16 v[136:151], a[28:31], v[24:27], 0
  v_mfma_f32_32x32x16_bf16 v[136:151], a[24:27], v[224:227], v[136:151]
  v_mfma_f32_32x32x16_bf16 v[152:167], a[28:31], v[28:31], 0
  v_mfma_f32_32x32x16_bf16 v[152:167], a[24:27], v[232:235], v[152:167]
  s_nop 11
  v_max3_f32 v16, v104, v105, v16
  v_max3_f32 v17, v106, v107, v17
  v_max3_f32 v16, v108, v109, v16
  v_max3_f32 v17, v110, v111, v17
  v_max3_f32 v16, v112, v113, v16
  v_max3_f32 v17, v114, v115, v17
  v_max3_f32 v16, v116, v117, v16
  v_max3_f32 v17, v118, v119, v17
  v_max3_f32 v18, v120, v121, v18
  v_max3_f32 v19, v122, v123, v19
  v_max3_f32 v18, v124, v125, v18
  v_max3_f32 v19, v126, v127, v19
  v_max3_f32 v18, v128, v129, v18
  v_max3_f32 v19, v130, v131, v19
  v_max3_f32 v18, v132, v133, v18
  v_max3_f32 v19, v134, v135, v19
  v_max3_f32 v16, v136, v137, v16
  v_max3_f32 v17, v138, v139, v17
  v_max3_f32 v16, v140, v141, v16
  v_max3_f32 v17, v142, v143, v17
  v_max3_f32 v16, v144, v145, v16
  v_max3_f32 v17, v146, v147, v17
  v_max3_f32 v16, v148, v149, v16
  v_max3_f32 v17, v150, v151, v17
  v_max3_f32 v18, v152, v153, v18
  v_max3_f32 v19, v154, v155, v19
  v_max3_f32 v18, v156, v157, v18
  v_max3_f32 v19, v158, v159, v19
  v_max3_f32 v18, v160, v161, v18
  v_max3_f32 v19, v162, v163, v19
  v_max3_f32 v18, v164, v165, v18
  v_max3_f32 v19, v166, v167, v19
  v_mfma_f32_32x32x16_bf16 v[104:119], a[32:35], v[24:27], 0
  v_mfma_f32_32x32x16_bf16 v[104:119], a[24:27], v[228:231], v[104:119]
  v_mfma_f32_32x32x16_bf16 v[120:135], a[32:35], v[28:31], 0
  v_mfma_f32_32x32x16_bf16 v[120:135], a[24:27], v[236:239], v[120:135]
  v_mfma_f32_32x32x16_bf16 v[136:151], a[40:43], v[24:27], 0
  v_mfma_f32_32x32x16_bf16 v[136:151], a[36:39], v[224:227], v[136:151]
  v_mfma_f32_32x32x16_bf16 v[152:167], a[40:43], v[28:31], 0
  v_mfma_f32_32x32x16_bf16 v[152:167], a[36:39], v[232:235], v[152:167]
  s_nop 11
  v_max3_f32 v16, v104, v105, v16
  v_max3_f32 v17, v106, v107, v17
  v_max3_f32 v16, v108, v109, v16
  v_max3_f32 v17, v110, v111, v17
  v_max3_f32 v16, v112, v113, v16
  v_max3_f32 v17, v114, v115, v17
  v_max3_f32 v16, v116, v117, v16
  v_max3_f32 v17, v118, v119, v17
  v_max3_f32 v18, v120, v121, v18
  v_max3_f32 v19, v122, v123, v19
  v_max3_f32 v18, v124, v125, v18
  v_max3_f32 v19, v126, v127, v19
  v_max3_f32 v18, v128, v129, v18
  v_max3_f32 v19, v130, v131, v19
  v_max3_f32 v18, v132, v133, v18
  v_max3_f32 v19, v134, v135, v19
  v_max3_f32 v16, v136, v137, v16
  v_max3_f32 v17, v138, v139, v17
  v_max3_f32 v16, v140, v141, v16
  v_max3_f32 v17, v142, v143, v17
  v_max3_f32 v16, v144, v145, v16
  v_max3_f32 v17, v146, v147, v17
  v_max3_f32 v16, v148, v149, v16
  v_max3_f32 v17, v150, v151, v17
  v_max3_f32 v18, v152, v153, v18
  v_max3_f32 v19, v154, v155, v19
  v_max3_f32 v18, v156, v157, v18
  v_max3_f32 v19, v158, v159, v19
  v_max3_f32 v18, v160, v161, v18
  v_max3_f32 v19, v162, v163, v19
  v_max3_f32 v18, v164, v165, v18
  v_max3_f32 v19, v166, v167, v19
  v_mfma_f32_32x32x16_bf16 v[104:119], a[44:47], v[24:27], 0
  v_mfma_f32_32x32x16_bf16 v[104:119], a[36:39], v[228:231], v[104:119]
  v_mfma_f32_32x32x16_bf16 v[120:135], a[44:47], v[28:31], 0
  v_mfma_f32_32x32x16_bf16 v[120:135], a[36:39], v[236:239], v[120:135]
  s_nop 11
  v_max3_f32 v16, v104, v105, v16
  v_max3_f32 v17, v106, v107, v17
  v_max3_f32 v16, v108, v109, v16
  v_max3_f32 v17, v110, v111, v17
  v_max3_f32 v16, v112, v113, v16
  v_max3_f32 v17, v114, v115, v17
  v_max3_f32 v16, v116, v117, v16
  v_max3_f32 v17, v118, v119, v17
  v_max3_f32 v18, v120, v121, v18
  v_max3_f32 v19, v122, v123, v19
  v_max3_f32 v18, v124, v125, v18
  v_max3_f32 v19, v126, v127, v19
  v_max3_f32 v18, v128, v129, v18
  v_max3_f32 v19, v130, v131, v19
  v_max3_f32 v18, v132, v133, v18
  v_max3_f32 v19, v134, v135, v19
  s_branch att_again
mega_done:
  s_endpgm
.section .rodata,"a"
.p2align 6
.amdhsa_kernel interleave_layers__sliding_block__glu_gated_geglu__prompt_kernel
  .amdhsa_next_free_vgpr 512
  .amdhsa_next_free_sgpr 102
  .amdhsa_accum_offset 256
  .amdhsa_group_segment_fixed_size 0
  .amdhsa_kernarg_size 80
  .amdhsa_user_sgpr_count 2
  .amdhsa_user_sgpr_kernarg_segment_ptr 1
  .amdhsa_system_sgpr_workgroup_id_x 1
  .amdhsa_float_denorm_mode_32 3
.end_amdhsa_kernel
```
